```python
import torch

def _softmax(x, axis=-1):
    return torch.softmax(x, dim=axis)

def _gelu(x):
    return torch.nn.functional.gelu(x, approximate='tanh')

def _silu(x):
    return torch.nn.functional.silu(x)

def _sigmoid(x):
    return torch.sigmoid(x)

def _layernorm(x, axis=-1, eps=1e-05):
    m = x.mean(dim=axis, keepdim=True)
    v = x.var(dim=axis, keepdim=True, unbiased=False)
    return (x - m) / torch.sqrt(v + eps)

def _scatter_add(tgt, idx, src, axis=0):
    return tgt.clone().index_add_(axis, idx, src)

def _segment_sum(src, seg, n):
    out = torch.zeros((n,) + src.shape[1:], dtype=src.dtype)
    return out.index_add_(0, seg, src)

def _pad(x, pw):
    flat = tuple((v for pair in reversed(pw) for v in pair))
    return torch.nn.functional.pad(x, flat)
kernel_name = 'adaLN_cond__grouped_kv_mqa__mixer_gmlp__prompt'

def setup_inputs():

    _w = lambda a: (lambda t: t.to(torch.bfloat16) if t.is_floating_point() else t)(torch.as_tensor(a))

    def _A_setup():
        B, S, D, H = (1, 2048, 512, 32)
        Dh = D // H
        return {'x': _w((lambda *s: torch.randn(*s, dtype=torch.bfloat16) * 0.05)(B, S, D)), 'wq': _w((lambda *s: torch.randn(*s, dtype=torch.bfloat16) * 0.05)(D, H * Dh)), 'wk': _w((lambda *s: torch.randn(*s, dtype=torch.bfloat16) * 0.05)(D, Dh)), 'wv': _w((lambda *s: torch.randn(*s, dtype=torch.bfloat16) * 0.05)(D, Dh)), 'wo': _w((lambda *s: torch.randn(*s, dtype=torch.bfloat16) * 0.05)(H * Dh, D))}
    _A_in = _A_setup()

    def _B_setup():
        B, S, D, F = (1, 2048, 512, 1792)
        Fh = F // 2
        return {'x': _w((lambda *s: torch.randn(*s, dtype=torch.bfloat16) * 0.05)(B, S, D)), 'w_in': _w((lambda *s: torch.randn(*s, dtype=torch.bfloat16) * 0.2)(D, 2 * Fh)), 'w_sp': _w(0.01 * (lambda *s: torch.randn(*s, dtype=torch.bfloat16) * 0.2)(S, S)), 'b_sp': _w(1.0 + 0.01 * (lambda *s: torch.randn(*s, dtype=torch.bfloat16) * 0.05)(S)), 'w_out': _w((lambda *s: torch.randn(*s, dtype=torch.bfloat16) * 0.05)(Fh, D))}
    _B_in = _B_setup()
    return {'A_x': _A_in['x'], 'A_wq': _A_in['wq'], 'A_wk': _A_in['wk'], 'A_wv': _A_in['wv'], 'A_wo': _A_in['wo'], 'B_x': _B_in['x'], 'B_w_in': _B_in['w_in'], 'B_w_sp': _B_in['w_sp'], 'B_b_sp': _B_in['b_sp'], 'B_w_out': _B_in['w_out'], 'c': _w((lambda *s: torch.randn(*s, dtype=torch.bfloat16) * 0.1)(1, 512) * 8.0), 'w_mod': _w((lambda *s: torch.randn(*s, dtype=torch.bfloat16) * 0.1)(512, 6 * 512) * 512 ** (-0.5) * 8.0)}

def reference(A_x, A_wq, A_wk, A_wv, A_wo, B_x, B_w_in, B_w_sp, B_b_sp, B_w_out, c, w_mod):

    def _A_ref(x, wq, wk, wv, wo):
        B, S, D = x.shape
        H = 32
        Dh = D // H
        q = (lambda x, *d: x.permute(*d))((x @ wq).reshape(B, S, H, Dh), 0, 2, 1, 3)
        k = x @ wk
        v = x @ wv
        scores = torch.einsum('bhqd,bkd->bhqk', q, k) * Dh ** (-0.5)
        p = _softmax(scores, axis=-1)
        o = torch.einsum('bhqk,bkd->bhqd', p, v)
        return (lambda x, *d: x.permute(*d))(o, 0, 2, 1, 3).reshape(B, S, H * Dh) @ wo

    def _B_ref(x, w_in, w_sp, b_sp, w_out):
        B, S, D = x.shape
        F = w_in.shape[-1]
        Fh = F // 2
        z = _gelu(torch.einsum('bsd,df->bsf', x, w_in))
        z1 = z[..., :Fh].clone()
        z2 = _layernorm(z[..., Fh:], axis=-1)
        g = torch.einsum('ts,bsf->btf', w_sp, z2) + b_sp[None, :, None]
        return torch.einsum('bsf,fd->bsd', z1 * g, w_out)
    x = A_x
    mod = (_silu(c) @ w_mod).reshape(c.shape[0], 6, 1, -1)
    sa, ca, ga, sb, cb, gb = (mod[:, 0].clone(), mod[:, 1].clone(), mod[:, 2].clone(), mod[:, 3].clone(), mod[:, 4].clone(), mod[:, 5].clone())
    h = _layernorm(x, axis=-1) * (1 + ca) + sa
    x = x + ga * _A_ref(h, A_wq, A_wk, A_wv, A_wo)
    h = _layernorm(x, axis=-1) * (1 + cb) + sb
    x = x + gb * _B_ref(h, B_w_in, B_w_sp, B_b_sp, B_w_out)
    return x
```

```asm
; @launch grid=(256,1,1) block=(256,1,1) lds=163840
.amdgcn_target "amdgcn-amd-amdhsa--gfx950"
.text
.globl adaLN_cond__grouped_kv_mqa__mixer_gmlp__prompt_kernel
.p2align 8
.type adaLN_cond__grouped_kv_mqa__mixer_gmlp__prompt_kernel,@function
adaLN_cond__grouped_kv_mqa__mixer_gmlp__prompt_kernel:
    s_cmp_ge_u32 s2, 256
    s_cbranch_scc1 L_end
    s_getpc_b64 s[64:65]
L_pc:
    s_load_dwordx16 s[16:31], s[0:1], 0
    v_and_b32 v4, 0xfc, v0
    v_lshlrev_b32 v4, 5, v4
    v_mov_b32 v7, s65
    v_add_co_u32 v6, vcc, s64, v4
    s_load_dwordx8 s[32:39], s[0:1], 64
    s_load_dwordx4 s[40:43], s[0:1], 96
    v_addc_co_u32 v7, vcc, 0, v7, vcc
    global_load_dword v26, v[6:7], off
    s_load_dwordx2 s[44:45], s[0:1], 112
    v_lshrrev_b32 v4, 6, v0
    v_and_b32 v0, 63, v0
    v_readfirstlane_b32 s48, v4
    s_and_b32 s52, s2, 7
    s_lshr_b32 s51, s2, 3
    s_mov_b32 s75, 0x20000
    v_lshlrev_b32 v29, 7, v0
    s_cmp_eq_u32 s48, 0
    s_cbranch_scc0 L_t1
    v_bfe_u32 v4, v0, 1, 4
    v_mul_u32_u24 v4, 6144, v4
    v_and_b32 v5, 0x80, v29
    v_add_u32 v4, v4, v5
    s_mul_i32 s70, s51, 98304
    s_lshl_b32 s3, s52, 8
    s_add_u32 s70, s70, s3
    s_mov_b32 s74, 3145728
    s_waitcnt lgkmcnt(0)
    s_mov_b64 s[72:73], s[38:39]
    s_mov_b32 exec_hi, 0
    buffer_load_dword v24, v4, s[72:75], s70 offen
    s_mov_b64 exec, -1
    s_branch L_t9
L_t1:
    s_cmp_eq_u32 s48, 1
    s_cbranch_scc0 L_t2
    s_lshl_b32 s70, s52, 18
    s_lshl_b32 s3, s51, 13
    s_add_u32 s70, s70, s3
    s_mov_b32 s74, 2097152
    s_waitcnt lgkmcnt(0)
    s_mov_b64 s[72:73], s[16:17]
    buffer_load_dword v24, v29, s[72:75], s70 offen
    s_branch L_t9
L_t2:
    s_cmp_eq_u32 s48, 2
    s_cbranch_scc0 L_t3
    s_lshr_b32 s70, s51, 1
    s_lshl_b32 s70, s70, 10
    v_and_b32 v4, 0x380, v29
    s_movk_i32 s74, 16384
    s_bitcmp1_b32 s51, 0
    s_waitcnt lgkmcnt(0)
    s_cselect_b64 s[72:73], s[22:23], s[20:21]
    buffer_load_dword v24, v4, s[72:75], s70 offen
    s_branch L_t9
L_t3:
    s_lshl_b32 s3, s51, 11
    s_add_u32 s3, s3, 8192
    v_and_b32 v6, 0x780, v29
    v_add_u32 v6, s3, v6
    v_min_u32 v6, L_end-L_pc-4, v6
    v_mov_b32 v7, s65
    v_add_co_u32 v6, vcc, s64, v6
    s_nop 1
    v_addc_co_u32 v7, vcc, 0, v7, vcc
    s_mov_b64 exec, 0xffff
    global_load_dword v24, v[6:7], off
    s_mov_b64 exec, -1
L_t9:
    v_and_b32 v1, 15, v0
    v_lshrrev_b32 v2, 4, v0
    v_lshlrev_b32 v3, 4, v0
    s_and_b32 s47, s51, 7
    s_lshr_b32 s3, s51, 3
    s_lshl_b32 s46, s52, 2
    s_add_u32 s46, s46, s3
    s_lshr_b32 s53, s47, 1
    s_getreg_b32 s49, hwreg(HW_REG_XCC_ID, 0, 4)
    s_and_b32 s49, s49, 7
    s_lshl_b32 s54, s46, 2
    s_add_u32 s54, s54, s48
    s_lshl_b32 s55, s54, 14
    s_lshl_b32 s54, s54, 7
    s_add_u32 s54, s54, 32768
    v_lshrrev_b32 v4, 1, v0
    v_and_b32 v5, 19, v4
    v_bfe_u32 v6, v4, 2, 1
    v_lshl_or_b32 v5, v6, 3, v5
    v_bfe_u32 v6, v4, 3, 1
    v_lshl_or_b32 v16, v6, 2, v5
    v_lshrrev_b32 v4, 2, v1
    v_and_b32 v5, 1, v2
    v_lshl_add_u32 v4, v5, 2, v4
    v_lshrrev_b32 v5, 1, v2
    v_lshl_add_u32 v4, v5, 4, v4
    v_lshlrev_b32 v4, 5, v4
    v_and_b32 v5, 3, v1
    v_lshl_add_u32 v17, v5, 3, v4
    v_and_b32 v18, 1, v0
    v_lshlrev_b32 v18, 4, v18
    s_sub_u32 s0, s48, s53
    s_and_b32 s0, s0, 3
    v_mov_b64 v[36:37], 0
    v_mov_b64 v[38:39], 0
    s_and_b32 s69, s2, 15
    s_lshl_b32 s69, s69, 6
    v_lshlrev_b32 v25, 4, v2
    v_lshrrev_b32 v4, 3, v0
    v_and_b32 v5, 7, v0
    v_xor_b32 v5, v5, v2
    v_lshlrev_b32 v5, 4, v5
    v_lshl_add_u32 v22, v4, 10, v5
    v_xor_b32 v23, 64, v22
    v_add_u32 v23, 7168, v23
    s_lshl_b32 s67, s48, 14
    s_add_u32 s67, s67, 28672
    s_movk_i32 s3, 6144
    v_mad_u32_u24 v28, v16, s3, v18
    s_lshl_b32 s68, s52, 3
    s_add_u32 s68, s68, s51
    s_lshl_b32 s66, s68, 5
    s_mov_b32 s6, 1024
    s_mov_b32 s7, 0x20000
    s_mov_b32 s10, 0x1200000
    s_mov_b32 s11, 0x20000
    s_sub_u32 s14, 2097152, s55
    s_mov_b32 s15, 0x20000
    s_mov_b32 s58, 3145728
    s_mov_b32 s59, 0x20000
    s_mov_b32 s62, 16384
    s_mov_b32 s63, 0x20000
    s_waitcnt lgkmcnt(0)
    s_mov_b64 s[56:57], s[38:39]
    s_mov_b64 s[4:5], s[36:37]
    s_mov_b64 s[8:9], s[44:45]
    s_load_dword s42, s[44:45], 253952
    s_add_u32 s12, s16, s55
    s_addc_u32 s13, s17, 0
    s_bitcmp1_b32 s47, 0
    s_cselect_b64 s[60:61], s[22:23], s[20:21]
    s_cmp_eq_u32 s0, 1
    s_cbranch_scc0 Lr2_2
    s_cmp_lt_u32 s51, 8
    s_cbranch_scc0 Lxi_4
    buffer_load_dwordx4 v[32:35], v3, s[4:7], 0 offen
    s_mov_b32 m0, 110592
    s_nop 0
    buffer_load_dwordx4 v28, s[56:59], s66 offen lds
    s_add_u32 s66, s66, 196608
    s_mov_b32 m0, 111616
    s_nop 0
    buffer_load_dwordx4 v28, s[56:59], s66 offen lds
    s_add_u32 s66, s66, 196608
    s_mov_b32 m0, 112640
    s_nop 0
    buffer_load_dwordx4 v28, s[56:59], s66 offen lds
    s_add_u32 s66, s66, 196608
    s_mov_b32 m0, 113664
    s_nop 0
    buffer_load_dwordx4 v28, s[56:59], s66 offen lds
    s_add_u32 s66, s66, 196608
    s_mov_b32 m0, 114688
    s_nop 0
    buffer_load_dwordx4 v28, s[56:59], s66 offen lds
    s_add_u32 s66, s66, 196608
    s_mov_b32 m0, 115712
    s_nop 0
    buffer_load_dwordx4 v28, s[56:59], s66 offen lds
    s_add_u32 s66, s66, 196608
    s_mov_b32 m0, 116736
    s_nop 0
    buffer_load_dwordx4 v28, s[56:59], s66 offen lds
    s_add_u32 s66, s66, 196608
    s_mov_b32 m0, 117760
    s_nop 0
    buffer_load_dwordx4 v28, s[56:59], s66 offen lds
    s_add_u32 s66, s66, 196608
    s_mov_b32 m0, 118784
    s_nop 0
    buffer_load_dwordx4 v28, s[56:59], s66 offen lds
    s_add_u32 s66, s66, 196608
    s_mov_b32 m0, 119808
    s_nop 0
    buffer_load_dwordx4 v28, s[56:59], s66 offen lds
    s_add_u32 s66, s66, 196608
    s_mov_b32 m0, 120832
    s_nop 0
    buffer_load_dwordx4 v28, s[56:59], s66 offen lds
    s_add_u32 s66, s66, 196608
    s_mov_b32 m0, 121856
    s_nop 0
    buffer_load_dwordx4 v28, s[56:59], s66 offen lds
    s_add_u32 s66, s66, 196608
    s_mov_b32 m0, 122880
    s_nop 0
    buffer_load_dwordx4 v28, s[56:59], s66 offen lds
    s_add_u32 s66, s66, 196608
    s_mov_b32 m0, 123904
    s_nop 0
    buffer_load_dwordx4 v28, s[56:59], s66 offen lds
    s_add_u32 s66, s66, 196608
    s_mov_b32 m0, 124928
    s_nop 0
    buffer_load_dwordx4 v28, s[56:59], s66 offen lds
    s_add_u32 s66, s66, 196608
    s_mov_b32 m0, 125952
    s_nop 0
    buffer_load_dwordx4 v28, s[56:59], s66 offen lds
    s_lshl_b32 s3, s68, 9
    s_mov_b64 exec, 0xffffffff
    buffer_store_dwordx4 v[36:39], v3, s[8:11], s3 offen sc1
    s_mov_b64 exec, -1
    s_barrier
    s_waitcnt vmcnt(17)
    v_lshlrev_b32 v40, 16, v32
    v_and_b32 v41, 0xffff0000, v32
    v_lshlrev_b32 v42, 16, v33
    v_and_b32 v43, 0xffff0000, v33
    v_lshlrev_b32 v44, 16, v34
    v_and_b32 v45, 0xffff0000, v34
    v_lshlrev_b32 v46, 16, v35
    v_and_b32 v47, 0xffff0000, v35
    v_mul_f32 v48, 0xbfb8aa3b, v40
    v_mul_f32 v49, 0xbfb8aa3b, v41
    v_mul_f32 v50, 0xbfb8aa3b, v42
    v_mul_f32 v51, 0xbfb8aa3b, v43
    v_mul_f32 v52, 0xbfb8aa3b, v44
    v_mul_f32 v53, 0xbfb8aa3b, v45
    v_mul_f32 v54, 0xbfb8aa3b, v46
    v_mul_f32 v55, 0xbfb8aa3b, v47
    v_exp_f32 v48, v48
    v_exp_f32 v49, v49
    v_exp_f32 v50, v50
    v_exp_f32 v51, v51
    v_exp_f32 v52, v52
    v_exp_f32 v53, v53
    v_exp_f32 v54, v54
    v_exp_f32 v55, v55
    v_add_f32 v48, 1.0, v48
    v_add_f32 v49, 1.0, v49
    v_add_f32 v50, 1.0, v50
    v_add_f32 v51, 1.0, v51
    v_add_f32 v52, 1.0, v52
    v_add_f32 v53, 1.0, v53
    v_add_f32 v54, 1.0, v54
    v_add_f32 v55, 1.0, v55
    v_rcp_f32 v48, v48
    v_rcp_f32 v49, v49
    v_rcp_f32 v50, v50
    v_rcp_f32 v51, v51
    v_rcp_f32 v52, v52
    v_rcp_f32 v53, v53
    v_rcp_f32 v54, v54
    v_rcp_f32 v55, v55
    v_mul_f32 v40, v40, v48
    v_mul_f32 v41, v41, v49
    v_mul_f32 v42, v42, v50
    v_mul_f32 v43, v43, v51
    v_mul_f32 v44, v44, v52
    v_mul_f32 v45, v45, v53
    v_mul_f32 v46, v46, v54
    v_mul_f32 v47, v47, v55
    v_cvt_pk_bf16_f32 v32, v40, v41
    v_cvt_pk_bf16_f32 v33, v42, v43
    v_cvt_pk_bf16_f32 v34, v44, v45
    v_cvt_pk_bf16_f32 v35, v46, v47
    v_add_u32 v6, 126976, v3
    ds_write_b128 v6, v[32:35]
    v_lshlrev_b32 v5, 4, v2
    v_add_u32 v6, 126976, v5
    v_add_u32 v7, 110592, v17
    s_waitcnt lgkmcnt(0)
    ds_read_b128 v[160:163], v6 offset:0
    ds_read_b128 v[164:167], v6 offset:64
    ds_read_b128 v[168:171], v6 offset:128
    ds_read_b128 v[172:175], v6 offset:192
    ds_read_b128 v[176:179], v6 offset:256
    ds_read_b128 v[180:183], v6 offset:320
    ds_read_b128 v[184:187], v6 offset:384
    ds_read_b128 v[188:191], v6 offset:448
    ds_read_b128 v[192:195], v6 offset:512
    ds_read_b128 v[196:199], v6 offset:576
    ds_read_b128 v[200:203], v6 offset:640
    ds_read_b128 v[204:207], v6 offset:704
    ds_read_b128 v[208:211], v6 offset:768
    ds_read_b128 v[212:215], v6 offset:832
    ds_read_b128 v[216:219], v6 offset:896
    ds_read_b128 v[220:223], v6 offset:960
    s_waitcnt vmcnt(0)
    ds_read_b64_tr_b16 v[128:129], v7 offset:0
    ds_read_b64_tr_b16 v[130:131], v7 offset:256
    ds_read_b64_tr_b16 v[132:133], v7 offset:1024
    ds_read_b64_tr_b16 v[134:135], v7 offset:1280
    ds_read_b64_tr_b16 v[136:137], v7 offset:2048
    ds_read_b64_tr_b16 v[138:139], v7 offset:2304
    ds_read_b64_tr_b16 v[140:141], v7 offset:3072
    ds_read_b64_tr_b16 v[142:143], v7 offset:3328
    ds_read_b64_tr_b16 v[144:145], v7 offset:4096
    ds_read_b64_tr_b16 v[146:147], v7 offset:4352
    ds_read_b64_tr_b16 v[148:149], v7 offset:5120
    ds_read_b64_tr_b16 v[150:151], v7 offset:5376
    ds_read_b64_tr_b16 v[152:153], v7 offset:6144
    ds_read_b64_tr_b16 v[154:155], v7 offset:6400
    s_waitcnt lgkmcnt(12)
    v_mfma_f32_16x16x32_bf16 v[32:35], v[128:131], v[160:163], 0
    ds_read_b64_tr_b16 v[156:157], v7 offset:7168
    ds_read_b64_tr_b16 v[158:159], v7 offset:7424
    s_waitcnt lgkmcnt(12)
    v_mfma_f32_16x16x32_bf16 v[32:35], v[132:135], v[164:167], v[32:35]
    ds_read_b64_tr_b16 v[128:129], v7 offset:8192
    ds_read_b64_tr_b16 v[130:131], v7 offset:8448
    s_waitcnt lgkmcnt(12)
    v_mfma_f32_16x16x32_bf16 v[32:35], v[136:139], v[168:171], v[32:35]
    ds_read_b64_tr_b16 v[132:133], v7 offset:9216
    ds_read_b64_tr_b16 v[134:135], v7 offset:9472
    s_waitcnt lgkmcnt(12)
    v_mfma_f32_16x16x32_bf16 v[32:35], v[140:143], v[172:175], v[32:35]
    ds_read_b64_tr_b16 v[136:137], v7 offset:10240
    ds_read_b64_tr_b16 v[138:139], v7 offset:10496
    s_waitcnt lgkmcnt(12)
    v_mfma_f32_16x16x32_bf16 v[32:35], v[144:147], v[176:179], v[32:35]
    ds_read_b64_tr_b16 v[140:141], v7 offset:11264
    ds_read_b64_tr_b16 v[142:143], v7 offset:11520
    s_waitcnt lgkmcnt(12)
    v_mfma_f32_16x16x32_bf16 v[32:35], v[148:151], v[180:183], v[32:35]
    ds_read_b64_tr_b16 v[144:145], v7 offset:12288
    ds_read_b64_tr_b16 v[146:147], v7 offset:12544
    s_waitcnt lgkmcnt(12)
    v_mfma_f32_16x16x32_bf16 v[32:35], v[152:155], v[184:187], v[32:35]
    ds_read_b64_tr_b16 v[148:149], v7 offset:13312
    ds_read_b64_tr_b16 v[150:151], v7 offset:13568
    s_waitcnt lgkmcnt(12)
    v_mfma_f32_16x16x32_bf16 v[32:35], v[156:159], v[188:191], v[32:35]
    ds_read_b64_tr_b16 v[152:153], v7 offset:14336
    ds_read_b64_tr_b16 v[154:155], v7 offset:14592
    s_waitcnt lgkmcnt(12)
    v_mfma_f32_16x16x32_bf16 v[32:35], v[128:131], v[192:195], v[32:35]
    ds_read_b64_tr_b16 v[156:157], v7 offset:15360
    ds_read_b64_tr_b16 v[158:159], v7 offset:15616
    s_waitcnt lgkmcnt(12)
    v_mfma_f32_16x16x32_bf16 v[32:35], v[132:135], v[196:199], v[32:35]
    s_waitcnt lgkmcnt(10)
    v_mfma_f32_16x16x32_bf16 v[32:35], v[136:139], v[200:203], v[32:35]
    s_waitcnt lgkmcnt(8)
    v_mfma_f32_16x16x32_bf16 v[32:35], v[140:143], v[204:207], v[32:35]
    s_waitcnt lgkmcnt(6)
    v_mfma_f32_16x16x32_bf16 v[32:35], v[144:147], v[208:211], v[32:35]
    s_waitcnt lgkmcnt(4)
    v_mfma_f32_16x16x32_bf16 v[32:35], v[148:151], v[212:215], v[32:35]
    s_waitcnt lgkmcnt(2)
    v_mfma_f32_16x16x32_bf16 v[32:35], v[152:155], v[216:219], v[32:35]
    s_waitcnt lgkmcnt(0)
    v_mfma_f32_16x16x32_bf16 v[32:35], v[156:159], v[220:223], v[32:35]
    s_nop 7
    v_cvt_pk_bf16_f32 v33, v32, v33
    v_lshlrev_b32 v32, 16, v33
    v_and_b32 v33, 0xffff0000, v33
    v_cvt_pk_bf16_f32 v35, v34, v35
    v_lshlrev_b32 v34, 16, v35
    v_and_b32 v35, 0xffff0000, v35
    s_bitcmp1_b32 s68, 5
    s_cbranch_scc0 Lno1_8
    v_add_f32 v32, 1.0, v32
    v_add_f32 v33, 1.0, v33
    v_add_f32 v34, 1.0, v34
    v_add_f32 v35, 1.0, v35
    v_cvt_pk_bf16_f32 v33, v32, v33
    v_lshlrev_b32 v32, 16, v33
    v_and_b32 v33, 0xffff0000, v33
    v_cvt_pk_bf16_f32 v35, v34, v35
    v_lshlrev_b32 v34, 16, v35
    v_and_b32 v35, 0xffff0000, v35
Lno1_8:
    s_lshl_b32 s3, s68, 6
    s_add_u32 s3, s3, 241664
    s_mov_b32 exec_lo, 0x00010001
    s_mov_b32 exec_hi, 0x00010001
    s_add_u32 s65, s42, 1
    s_and_b32 s65, s65, 0xffff
    v_or_b32 v36, s65, v32
    v_or_b32 v37, s65, v33
    v_or_b32 v38, s65, v34
    v_or_b32 v39, s65, v35
    buffer_store_dwordx4 v[36:39], v5, s[8:11], s3 offen sc1
    s_mov_b64 exec, -1
    v_add_u32 v6, s69, v6
    ds_read_b128 v[8:11], v6
    s_add_u32 m0, s67, 0
    s_movk_i32 s3, 0
    buffer_load_dwordx4 v22, s[12:15], s3 offen lds
    buffer_load_dwordx4 v23, s[12:15], s3 offen offset:1024 lds
    s_add_u32 m0, s67, 2048
    s_movk_i32 s3, 128
    buffer_load_dwordx4 v22, s[12:15], s3 offen lds
    buffer_load_dwordx4 v23, s[12:15], s3 offen offset:1024 lds
    s_add_u32 m0, s67, 4096
    s_movk_i32 s3, 256
    buffer_load_dwordx4 v22, s[12:15], s3 offen lds
    buffer_load_dwordx4 v23, s[12:15], s3 offen offset:1024 lds
    s_add_u32 m0, s67, 6144
    s_movk_i32 s3, 384
    buffer_load_dwordx4 v22, s[12:15], s3 offen lds
    buffer_load_dwordx4 v23, s[12:15], s3 offen offset:1024 lds
    s_add_u32 m0, s67, 8192
    s_movk_i32 s3, 512
    buffer_load_dwordx4 v22, s[12:15], s3 offen lds
    buffer_load_dwordx4 v23, s[12:15], s3 offen offset:1024 lds
    s_add_u32 m0, s67, 10240
    s_movk_i32 s3, 640
    buffer_load_dwordx4 v22, s[12:15], s3 offen lds
    buffer_load_dwordx4 v23, s[12:15], s3 offen offset:1024 lds
    s_add_u32 m0, s67, 12288
    s_movk_i32 s3, 768
    buffer_load_dwordx4 v22, s[12:15], s3 offen lds
    buffer_load_dwordx4 v23, s[12:15], s3 offen offset:1024 lds
    s_add_u32 m0, s67, 14336
    s_movk_i32 s3, 896
    buffer_load_dwordx4 v22, s[12:15], s3 offen lds
    buffer_load_dwordx4 v23, s[12:15], s3 offen offset:1024 lds
    s_waitcnt vmcnt(0)
    s_branch Lxw_5
Lr2_2:
    s_cmp_eq_u32 s0, 0
    s_cbranch_scc1 Lr0_1
Lxi_4:
    buffer_load_dwordx4 v[8:11], v25, s[4:7], s69 offen
    s_barrier
    s_add_u32 m0, s67, 0
    s_movk_i32 s3, 0
    buffer_load_dwordx4 v22, s[12:15], s3 offen lds
    buffer_load_dwordx4 v23, s[12:15], s3 offen offset:1024 lds
    s_add_u32 m0, s67, 2048
    s_movk_i32 s3, 128
    buffer_load_dwordx4 v22, s[12:15], s3 offen lds
    buffer_load_dwordx4 v23, s[12:15], s3 offen offset:1024 lds
    s_add_u32 m0, s67, 4096
    s_movk_i32 s3, 256
    buffer_load_dwordx4 v22, s[12:15], s3 offen lds
    buffer_load_dwordx4 v23, s[12:15], s3 offen offset:1024 lds
    s_add_u32 m0, s67, 6144
    s_movk_i32 s3, 384
    buffer_load_dwordx4 v22, s[12:15], s3 offen lds
    buffer_load_dwordx4 v23, s[12:15], s3 offen offset:1024 lds
    s_add_u32 m0, s67, 8192
    s_movk_i32 s3, 512
    buffer_load_dwordx4 v22, s[12:15], s3 offen lds
    buffer_load_dwordx4 v23, s[12:15], s3 offen offset:1024 lds
    s_add_u32 m0, s67, 10240
    s_movk_i32 s3, 640
    buffer_load_dwordx4 v22, s[12:15], s3 offen lds
    buffer_load_dwordx4 v23, s[12:15], s3 offen offset:1024 lds
    s_add_u32 m0, s67, 12288
    s_movk_i32 s3, 768
    buffer_load_dwordx4 v22, s[12:15], s3 offen lds
    buffer_load_dwordx4 v23, s[12:15], s3 offen offset:1024 lds
    s_add_u32 m0, s67, 14336
    s_movk_i32 s3, 896
    buffer_load_dwordx4 v22, s[12:15], s3 offen lds
    buffer_load_dwordx4 v23, s[12:15], s3 offen offset:1024 lds
    s_lshl_b32 s66, s47, 7
    s_add_u32 s4, s18, s66
    s_addc_u32 s5, s19, 0
    s_sub_u32 s6, 524288, s66
    s_mov_b32 s7, 0x20000
    s_cmp_lt_u32 s0, 2
    s_cbranch_scc1 Lnw_9
    s_and_b32 s3, s46, 3
    s_lshl_b32 s3, s3, 1
    s_add_u32 s3, s3, s0
    s_sub_u32 s3, s3, 2
    s_lshl_b32 s3, s3, 16
    v_lshlrev_b32 v4, 10, v0
    buffer_load_dword v26, v4, s[4:7], s3 offen
    s_waitcnt vmcnt(17)
    v_lshlrev_b32 v40, 16, v8
    v_and_b32 v41, 0xffff0000, v8
    v_lshlrev_b32 v42, 16, v9
    v_and_b32 v43, 0xffff0000, v9
    v_lshlrev_b32 v44, 16, v10
    v_and_b32 v45, 0xffff0000, v10
    v_lshlrev_b32 v46, 16, v11
    v_and_b32 v47, 0xffff0000, v11
    v_mul_f32 v48, 0xbfb8aa3b, v40
    v_mul_f32 v49, 0xbfb8aa3b, v41
    v_mul_f32 v50, 0xbfb8aa3b, v42
    v_mul_f32 v51, 0xbfb8aa3b, v43
    v_mul_f32 v52, 0xbfb8aa3b, v44
    v_mul_f32 v53, 0xbfb8aa3b, v45
    v_mul_f32 v54, 0xbfb8aa3b, v46
    v_mul_f32 v55, 0xbfb8aa3b, v47
    v_exp_f32 v48, v48
    v_exp_f32 v49, v49
    v_exp_f32 v50, v50
    v_exp_f32 v51, v51
    v_exp_f32 v52, v52
    v_exp_f32 v53, v53
    v_exp_f32 v54, v54
    v_exp_f32 v55, v55
    v_add_f32 v48, 1.0, v48
    v_add_f32 v49, 1.0, v49
    v_add_f32 v50, 1.0, v50
    v_add_f32 v51, 1.0, v51
    v_add_f32 v52, 1.0, v52
    v_add_f32 v53, 1.0, v53
    v_add_f32 v54, 1.0, v54
    v_add_f32 v55, 1.0, v55
    v_rcp_f32 v48, v48
    v_rcp_f32 v49, v49
    v_rcp_f32 v50, v50
    v_rcp_f32 v51, v51
    v_rcp_f32 v52, v52
    v_rcp_f32 v53, v53
    v_rcp_f32 v54, v54
    v_rcp_f32 v55, v55
    v_mul_f32 v40, v40, v48
    v_mul_f32 v41, v41, v49
    v_mul_f32 v42, v42, v50
    v_mul_f32 v43, v43, v51
    v_mul_f32 v44, v44, v52
    v_mul_f32 v45, v45, v53
    v_mul_f32 v46, v46, v54
    v_mul_f32 v47, v47, v55
    v_cvt_pk_bf16_f32 v8, v40, v41
    v_cvt_pk_bf16_f32 v9, v42, v43
    v_cvt_pk_bf16_f32 v10, v44, v45
    v_cvt_pk_bf16_f32 v11, v46, v47
    s_waitcnt vmcnt(1)
    s_branch Lxw_5
Lnw_9:
    s_waitcnt vmcnt(16)
    v_lshlrev_b32 v40, 16, v8
    v_and_b32 v41, 0xffff0000, v8
    v_lshlrev_b32 v42, 16, v9
    v_and_b32 v43, 0xffff0000, v9
    v_lshlrev_b32 v44, 16, v10
    v_and_b32 v45, 0xffff0000, v10
    v_lshlrev_b32 v46, 16, v11
    v_and_b32 v47, 0xffff0000, v11
    v_mul_f32 v48, 0xbfb8aa3b, v40
    v_mul_f32 v49, 0xbfb8aa3b, v41
    v_mul_f32 v50, 0xbfb8aa3b, v42
    v_mul_f32 v51, 0xbfb8aa3b, v43
    v_mul_f32 v52, 0xbfb8aa3b, v44
    v_mul_f32 v53, 0xbfb8aa3b, v45
    v_mul_f32 v54, 0xbfb8aa3b, v46
    v_mul_f32 v55, 0xbfb8aa3b, v47
    v_exp_f32 v48, v48
    v_exp_f32 v49, v49
    v_exp_f32 v50, v50
    v_exp_f32 v51, v51
    v_exp_f32 v52, v52
    v_exp_f32 v53, v53
    v_exp_f32 v54, v54
    v_exp_f32 v55, v55
    v_add_f32 v48, 1.0, v48
    v_add_f32 v49, 1.0, v49
    v_add_f32 v50, 1.0, v50
    v_add_f32 v51, 1.0, v51
    v_add_f32 v52, 1.0, v52
    v_add_f32 v53, 1.0, v53
    v_add_f32 v54, 1.0, v54
    v_add_f32 v55, 1.0, v55
    v_rcp_f32 v48, v48
    v_rcp_f32 v49, v49
    v_rcp_f32 v50, v50
    v_rcp_f32 v51, v51
    v_rcp_f32 v52, v52
    v_rcp_f32 v53, v53
    v_rcp_f32 v54, v54
    v_rcp_f32 v55, v55
    v_mul_f32 v40, v40, v48
    v_mul_f32 v41, v41, v49
    v_mul_f32 v42, v42, v50
    v_mul_f32 v43, v43, v51
    v_mul_f32 v44, v44, v52
    v_mul_f32 v45, v45, v53
    v_mul_f32 v46, v46, v54
    v_mul_f32 v47, v47, v55
    v_cvt_pk_bf16_f32 v8, v40, v41
    v_cvt_pk_bf16_f32 v9, v42, v43
    v_cvt_pk_bf16_f32 v10, v44, v45
    v_cvt_pk_bf16_f32 v11, v46, v47
    s_waitcnt vmcnt(0)
    s_branch Lxw_5
Lr0_1:
    buffer_load_dwordx4 v[8:11], v25, s[4:7], s69 offen
    s_barrier
    s_add_u32 m0, s67, 0
    s_movk_i32 s3, 0
    buffer_load_dwordx4 v22, s[12:15], s3 offen lds
    buffer_load_dwordx4 v23, s[12:15], s3 offen offset:1024 lds
    s_add_u32 m0, s67, 2048
    s_movk_i32 s3, 128
    buffer_load_dwordx4 v22, s[12:15], s3 offen lds
    buffer_load_dwordx4 v23, s[12:15], s3 offen offset:1024 lds
    s_add_u32 m0, s67, 4096
    s_movk_i32 s3, 256
    buffer_load_dwordx4 v22, s[12:15], s3 offen lds
    buffer_load_dwordx4 v23, s[12:15], s3 offen offset:1024 lds
    s_add_u32 m0, s67, 6144
    s_movk_i32 s3, 384
    buffer_load_dwordx4 v22, s[12:15], s3 offen lds
    buffer_load_dwordx4 v23, s[12:15], s3 offen offset:1024 lds
    s_add_u32 m0, s67, 8192
    s_movk_i32 s3, 512
    buffer_load_dwordx4 v22, s[12:15], s3 offen lds
    buffer_load_dwordx4 v23, s[12:15], s3 offen offset:1024 lds
    s_add_u32 m0, s67, 10240
    s_movk_i32 s3, 640
    buffer_load_dwordx4 v22, s[12:15], s3 offen lds
    buffer_load_dwordx4 v23, s[12:15], s3 offen offset:1024 lds
    s_add_u32 m0, s67, 12288
    s_movk_i32 s3, 768
    buffer_load_dwordx4 v22, s[12:15], s3 offen lds
    buffer_load_dwordx4 v23, s[12:15], s3 offen offset:1024 lds
    s_add_u32 m0, s67, 14336
    s_movk_i32 s3, 896
    buffer_load_dwordx4 v22, s[12:15], s3 offen lds
    buffer_load_dwordx4 v23, s[12:15], s3 offen offset:1024 lds
    v_lshl_add_u32 v21, v16, 5, v18
    s_mov_b32 m0, 94208
    s_movk_i32 s3, 0
    buffer_load_dwordx4 v21, s[60:63], s3 offen lds
    s_mov_b32 m0, 95232
    s_movk_i32 s3, 1024
    buffer_load_dwordx4 v21, s[60:63], s3 offen lds
    s_mov_b32 m0, 96256
    s_movk_i32 s3, 2048
    buffer_load_dwordx4 v21, s[60:63], s3 offen lds
    s_mov_b32 m0, 97280
    s_movk_i32 s3, 3072
    buffer_load_dwordx4 v21, s[60:63], s3 offen lds
    s_mov_b32 m0, 98304
    s_movk_i32 s3, 4096
    buffer_load_dwordx4 v21, s[60:63], s3 offen lds
    s_mov_b32 m0, 99328
    s_movk_i32 s3, 5120
    buffer_load_dwordx4 v21, s[60:63], s3 offen lds
    s_mov_b32 m0, 100352
    s_movk_i32 s3, 6144
    buffer_load_dwordx4 v21, s[60:63], s3 offen lds
    s_mov_b32 m0, 101376
    s_movk_i32 s3, 7168
    buffer_load_dwordx4 v21, s[60:63], s3 offen lds
    s_mov_b32 m0, 102400
    s_movk_i32 s3, 8192
    buffer_load_dwordx4 v21, s[60:63], s3 offen lds
    s_mov_b32 m0, 103424
    s_movk_i32 s3, 9216
    buffer_load_dwordx4 v21, s[60:63], s3 offen lds
    s_mov_b32 m0, 104448
    s_movk_i32 s3, 10240
    buffer_load_dwordx4 v21, s[60:63], s3 offen lds
    s_mov_b32 m0, 105472
    s_movk_i32 s3, 11264
    buffer_load_dwordx4 v21, s[60:63], s3 offen lds
    s_mov_b32 m0, 106496
    s_movk_i32 s3, 12288
    buffer_load_dwordx4 v21, s[60:63], s3 offen lds
    s_mov_b32 m0, 107520
    s_movk_i32 s3, 13312
    buffer_load_dwordx4 v21, s[60:63], s3 offen lds
    s_mov_b32 m0, 108544
    s_movk_i32 s3, 14336
    buffer_load_dwordx4 v21, s[60:63], s3 offen lds
    s_mov_b32 m0, 109568
    s_movk_i32 s3, 15360
    buffer_load_dwordx4 v21, s[60:63], s3 offen lds
    s_mul_i32 s3, s2, 768
    s_add_u32 s3, s3, 32768
    s_mov_b32 exec_hi, 0xffff
    buffer_store_dwordx4 v[36:39], v3, s[8:11], s3 offen sc1
    s_mov_b64 exec, -1
    s_waitcnt vmcnt(33)
    v_lshlrev_b32 v40, 16, v8
    v_and_b32 v41, 0xffff0000, v8
    v_lshlrev_b32 v42, 16, v9
    v_and_b32 v43, 0xffff0000, v9
    v_lshlrev_b32 v44, 16, v10
    v_and_b32 v45, 0xffff0000, v10
    v_lshlrev_b32 v46, 16, v11
    v_and_b32 v47, 0xffff0000, v11
    v_mul_f32 v48, 0xbfb8aa3b, v40
    v_mul_f32 v49, 0xbfb8aa3b, v41
    v_mul_f32 v50, 0xbfb8aa3b, v42
    v_mul_f32 v51, 0xbfb8aa3b, v43
    v_mul_f32 v52, 0xbfb8aa3b, v44
    v_mul_f32 v53, 0xbfb8aa3b, v45
    v_mul_f32 v54, 0xbfb8aa3b, v46
    v_mul_f32 v55, 0xbfb8aa3b, v47
    v_exp_f32 v48, v48
    v_exp_f32 v49, v49
    v_exp_f32 v50, v50
    v_exp_f32 v51, v51
    v_exp_f32 v52, v52
    v_exp_f32 v53, v53
    v_exp_f32 v54, v54
    v_exp_f32 v55, v55
    v_add_f32 v48, 1.0, v48
    v_add_f32 v49, 1.0, v49
    v_add_f32 v50, 1.0, v50
    v_add_f32 v51, 1.0, v51
    v_add_f32 v52, 1.0, v52
    v_add_f32 v53, 1.0, v53
    v_add_f32 v54, 1.0, v54
    v_add_f32 v55, 1.0, v55
    v_rcp_f32 v48, v48
    v_rcp_f32 v49, v49
    v_rcp_f32 v50, v50
    v_rcp_f32 v51, v51
    v_rcp_f32 v52, v52
    v_rcp_f32 v53, v53
    v_rcp_f32 v54, v54
    v_rcp_f32 v55, v55
    v_mul_f32 v40, v40, v48
    v_mul_f32 v41, v41, v49
    v_mul_f32 v42, v42, v50
    v_mul_f32 v43, v43, v51
    v_mul_f32 v44, v44, v52
    v_mul_f32 v45, v45, v53
    v_mul_f32 v46, v46, v54
    v_mul_f32 v47, v47, v55
    v_cvt_pk_bf16_f32 v8, v40, v41
    v_cvt_pk_bf16_f32 v9, v42, v43
    v_cvt_pk_bf16_f32 v10, v44, v45
    v_cvt_pk_bf16_f32 v11, v46, v47
    s_waitcnt vmcnt(17)
Lxw_5:
    v_lshrrev_b32 v4, 1, v1
    v_xor_b32 v4, v4, v2
    v_lshlrev_b32 v4, 4, v4
    v_lshl_add_u32 v4, v1, 7, v4
    v_add_u32 v4, s67, v4
    v_xor_b32 v5, 64, v4
    s_waitcnt lgkmcnt(0)
    s_add_u32 s42, s42, 1
    s_and_b32 s43, s42, 0xffff
    ds_read_b128 v[64:67], v4 offset:0
    ds_read_b128 v[68:71], v5 offset:0
    ds_read_b128 v[72:75], v4 offset:2048
    ds_read_b128 v[76:79], v5 offset:2048
    ds_read_b128 v[80:83], v4 offset:4096
    ds_read_b128 v[84:87], v5 offset:4096
    ds_read_b128 v[88:91], v4 offset:6144
    ds_read_b128 v[92:95], v5 offset:6144
    ds_read_b128 v[96:99], v4 offset:8192
    ds_read_b128 v[100:103], v5 offset:8192
    ds_read_b128 v[104:107], v4 offset:10240
    ds_read_b128 v[108:111], v5 offset:10240
    ds_read_b128 v[112:115], v4 offset:12288
    ds_read_b128 v[116:119], v5 offset:12288
    ds_read_b128 v[120:123], v4 offset:14336
    ds_read_b128 v[124:127], v5 offset:14336
    s_lshl_b32 s66, s47, 7
    s_add_u32 s4, s18, s66
    s_addc_u32 s5, s19, 0
    s_sub_u32 s6, 524288, s66
    s_mov_b32 s7, 0x20000
    v_lshrrev_b32 v4, 3, v0
    v_bfe_u32 v5, v0, 1, 2
    v_bfe_u32 v6, v4, 1, 1
    v_xor_b32 v5, v5, v6
    v_lshlrev_b32 v5, 5, v5
    v_lshl_add_u32 v5, v4, 10, v5
    v_add_u32 v19, v5, v18
    v_xor_b32 v20, 64, v19
    s_lshl_b32 s66, s48, 17
    s_waitcnt lgkmcnt(15)
    v_lshlrev_b32 v128, 16, v64
    v_and_b32 v129, 0xffff0000, v64
    v_lshlrev_b32 v130, 16, v65
    v_and_b32 v131, 0xffff0000, v65
    v_lshlrev_b32 v132, 16, v66
    v_and_b32 v133, 0xffff0000, v66
    v_lshlrev_b32 v134, 16, v67
    v_and_b32 v135, 0xffff0000, v67
    s_waitcnt lgkmcnt(14)
    v_lshlrev_b32 v136, 16, v68
    v_and_b32 v137, 0xffff0000, v68
    v_lshlrev_b32 v138, 16, v69
    v_and_b32 v139, 0xffff0000, v69
    v_lshlrev_b32 v140, 16, v70
    v_and_b32 v141, 0xffff0000, v70
    v_lshlrev_b32 v142, 16, v71
    v_and_b32 v143, 0xffff0000, v71
    s_waitcnt lgkmcnt(13)
    v_lshlrev_b32 v144, 16, v72
    v_and_b32 v145, 0xffff0000, v72
    v_lshlrev_b32 v146, 16, v73
    v_and_b32 v147, 0xffff0000, v73
    v_lshlrev_b32 v148, 16, v74
    v_and_b32 v149, 0xffff0000, v74
    v_lshlrev_b32 v150, 16, v75
    v_and_b32 v151, 0xffff0000, v75
    s_waitcnt lgkmcnt(12)
    v_lshlrev_b32 v152, 16, v76
    v_and_b32 v153, 0xffff0000, v76
    v_lshlrev_b32 v154, 16, v77
    v_and_b32 v155, 0xffff0000, v77
    v_lshlrev_b32 v156, 16, v78
    v_and_b32 v157, 0xffff0000, v78
    v_lshlrev_b32 v158, 16, v79
    v_and_b32 v159, 0xffff0000, v79
    s_waitcnt lgkmcnt(11)
    v_lshlrev_b32 v160, 16, v80
    v_and_b32 v161, 0xffff0000, v80
    v_lshlrev_b32 v162, 16, v81
    v_and_b32 v163, 0xffff0000, v81
    v_lshlrev_b32 v164, 16, v82
    v_and_b32 v165, 0xffff0000, v82
    v_lshlrev_b32 v166, 16, v83
    v_and_b32 v167, 0xffff0000, v83
    s_waitcnt lgkmcnt(10)
    v_lshlrev_b32 v168, 16, v84
    v_and_b32 v169, 0xffff0000, v84
    v_lshlrev_b32 v170, 16, v85
    v_and_b32 v171, 0xffff0000, v85
    v_lshlrev_b32 v172, 16, v86
    v_and_b32 v173, 0xffff0000, v86
    v_lshlrev_b32 v174, 16, v87
    v_and_b32 v175, 0xffff0000, v87
    s_waitcnt lgkmcnt(9)
    v_lshlrev_b32 v176, 16, v88
    v_and_b32 v177, 0xffff0000, v88
    v_lshlrev_b32 v178, 16, v89
    v_and_b32 v179, 0xffff0000, v89
    v_lshlrev_b32 v180, 16, v90
    v_and_b32 v181, 0xffff0000, v90
    v_lshlrev_b32 v182, 16, v91
    v_and_b32 v183, 0xffff0000, v91
    s_waitcnt lgkmcnt(8)
    v_lshlrev_b32 v184, 16, v92
    v_and_b32 v185, 0xffff0000, v92
    v_lshlrev_b32 v186, 16, v93
    v_and_b32 v187, 0xffff0000, v93
    v_lshlrev_b32 v188, 16, v94
    v_and_b32 v189, 0xffff0000, v94
    v_lshlrev_b32 v190, 16, v95
    v_and_b32 v191, 0xffff0000, v95
    s_waitcnt lgkmcnt(7)
    v_lshlrev_b32 v192, 16, v96
    v_and_b32 v193, 0xffff0000, v96
    v_lshlrev_b32 v194, 16, v97
    v_and_b32 v195, 0xffff0000, v97
    v_lshlrev_b32 v196, 16, v98
    v_and_b32 v197, 0xffff0000, v98
    v_lshlrev_b32 v198, 16, v99
    v_and_b32 v199, 0xffff0000, v99
    s_waitcnt lgkmcnt(6)
    v_lshlrev_b32 v200, 16, v100
    v_and_b32 v201, 0xffff0000, v100
    v_lshlrev_b32 v202, 16, v101
    v_and_b32 v203, 0xffff0000, v101
    v_lshlrev_b32 v204, 16, v102
    v_and_b32 v205, 0xffff0000, v102
    v_lshlrev_b32 v206, 16, v103
    v_and_b32 v207, 0xffff0000, v103
    s_waitcnt lgkmcnt(5)
    v_lshlrev_b32 v208, 16, v104
    v_and_b32 v209, 0xffff0000, v104
    v_lshlrev_b32 v210, 16, v105
    v_and_b32 v211, 0xffff0000, v105
    v_lshlrev_b32 v212, 16, v106
    v_and_b32 v213, 0xffff0000, v106
    v_lshlrev_b32 v214, 16, v107
    v_and_b32 v215, 0xffff0000, v107
    s_waitcnt lgkmcnt(4)
    v_lshlrev_b32 v216, 16, v108
    v_and_b32 v217, 0xffff0000, v108
    v_lshlrev_b32 v218, 16, v109
    v_and_b32 v219, 0xffff0000, v109
    v_lshlrev_b32 v220, 16, v110
    v_and_b32 v221, 0xffff0000, v110
    v_lshlrev_b32 v222, 16, v111
    v_and_b32 v223, 0xffff0000, v111
    s_waitcnt lgkmcnt(3)
    v_lshlrev_b32 v224, 16, v112
    v_and_b32 v225, 0xffff0000, v112
    v_lshlrev_b32 v226, 16, v113
    v_and_b32 v227, 0xffff0000, v113
    v_lshlrev_b32 v228, 16, v114
    v_and_b32 v229, 0xffff0000, v114
    v_lshlrev_b32 v230, 16, v115
    v_and_b32 v231, 0xffff0000, v115
    s_waitcnt lgkmcnt(2)
    v_lshlrev_b32 v232, 16, v116
    v_and_b32 v233, 0xffff0000, v116
    v_lshlrev_b32 v234, 16, v117
    v_and_b32 v235, 0xffff0000, v117
    v_lshlrev_b32 v236, 16, v118
    v_and_b32 v237, 0xffff0000, v118
    v_lshlrev_b32 v238, 16, v119
    v_and_b32 v239, 0xffff0000, v119
    s_waitcnt lgkmcnt(1)
    v_lshlrev_b32 v240, 16, v120
    v_and_b32 v241, 0xffff0000, v120
    v_lshlrev_b32 v242, 16, v121
    v_and_b32 v243, 0xffff0000, v121
    v_lshlrev_b32 v244, 16, v122
    v_and_b32 v245, 0xffff0000, v122
    v_lshlrev_b32 v246, 16, v123
    v_and_b32 v247, 0xffff0000, v123
    s_waitcnt lgkmcnt(0)
    v_lshlrev_b32 v248, 16, v124
    v_and_b32 v249, 0xffff0000, v124
    v_lshlrev_b32 v250, 16, v125
    v_and_b32 v251, 0xffff0000, v125
    v_lshlrev_b32 v252, 16, v126
    v_and_b32 v253, 0xffff0000, v126
    v_lshlrev_b32 v254, 16, v127
    v_and_b32 v255, 0xffff0000, v127
    v_pk_add_f32 v[32:33], v[128:129], v[130:131]
    v_pk_add_f32 v[34:35], v[132:133], v[134:135]
    v_pk_add_f32 v[36:37], v[136:137], v[138:139]
    v_pk_add_f32 v[38:39], v[140:141], v[142:143]
    v_pk_mul_f32 v[40:41], v[128:129], v[128:129]
    v_pk_mul_f32 v[42:43], v[130:131], v[130:131]
    v_pk_mul_f32 v[44:45], v[132:133], v[132:133]
    v_pk_mul_f32 v[46:47], v[134:135], v[134:135]
    v_pk_fma_f32 v[40:41], v[136:137], v[136:137], v[40:41]
    v_pk_fma_f32 v[42:43], v[138:139], v[138:139], v[42:43]
    v_pk_fma_f32 v[44:45], v[140:141], v[140:141], v[44:45]
    v_pk_fma_f32 v[46:47], v[142:143], v[142:143], v[46:47]
    s_mov_b32 m0, s67
    s_add_u32 s67, s67, 1024
    buffer_load_dwordx4 v19, s[4:7], s66 offen lds
    s_add_u32 s66, s66, 8192
    v_pk_add_f32 v[32:33], v[32:33], v[144:145]
    v_pk_fma_f32 v[40:41], v[144:145], v[144:145], v[40:41]
    v_pk_add_f32 v[34:35], v[34:35], v[146:147]
    v_pk_fma_f32 v[42:43], v[146:147], v[146:147], v[42:43]
    v_pk_add_f32 v[36:37], v[36:37], v[148:149]
    v_pk_fma_f32 v[44:45], v[148:149], v[148:149], v[44:45]
    v_pk_add_f32 v[38:39], v[38:39], v[150:151]
    v_pk_fma_f32 v[46:47], v[150:151], v[150:151], v[46:47]
    s_mov_b32 m0, s67
    s_add_u32 s67, s67, 1024
    buffer_load_dwordx4 v20, s[4:7], s66 offen lds
    s_add_u32 s66, s66, 8192
    v_pk_add_f32 v[32:33], v[32:33], v[152:153]
    v_pk_fma_f32 v[40:41], v[152:153], v[152:153], v[40:41]
    v_pk_add_f32 v[34:35], v[34:35], v[154:155]
    v_pk_fma_f32 v[42:43], v[154:155], v[154:155], v[42:43]
    v_pk_add_f32 v[36:37], v[36:37], v[156:157]
    v_pk_fma_f32 v[44:45], v[156:157], v[156:157], v[44:45]
    v_pk_add_f32 v[38:39], v[38:39], v[158:159]
    v_pk_fma_f32 v[46:47], v[158:159], v[158:159], v[46:47]
    s_mov_b32 m0, s67
    s_add_u32 s67, s67, 1024
    buffer_load_dwordx4 v19, s[4:7], s66 offen lds
    s_add_u32 s66, s66, 8192
    v_pk_add_f32 v[32:33], v[32:33], v[160:161]
    v_pk_fma_f32 v[40:41], v[160:161], v[160:161], v[40:41]
    v_pk_add_f32 v[34:35], v[34:35], v[162:163]
    v_pk_fma_f32 v[42:43], v[162:163], v[162:163], v[42:43]
    v_pk_add_f32 v[36:37], v[36:37], v[164:165]
    v_pk_fma_f32 v[44:45], v[164:165], v[164:165], v[44:45]
    v_pk_add_f32 v[38:39], v[38:39], v[166:167]
    v_pk_fma_f32 v[46:47], v[166:167], v[166:167], v[46:47]
    s_mov_b32 m0, s67
    s_add_u32 s67, s67, 1024
    buffer_load_dwordx4 v20, s[4:7], s66 offen lds
    s_add_u32 s66, s66, 8192
    v_pk_add_f32 v[32:33], v[32:33], v[168:169]
    v_pk_fma_f32 v[40:41], v[168:169], v[168:169], v[40:41]
    v_pk_add_f32 v[34:35], v[34:35], v[170:171]
    v_pk_fma_f32 v[42:43], v[170:171], v[170:171], v[42:43]
    v_pk_add_f32 v[36:37], v[36:37], v[172:173]
    v_pk_fma_f32 v[44:45], v[172:173], v[172:173], v[44:45]
    v_pk_add_f32 v[38:39], v[38:39], v[174:175]
    v_pk_fma_f32 v[46:47], v[174:175], v[174:175], v[46:47]
    s_mov_b32 m0, s67
    s_add_u32 s67, s67, 1024
    buffer_load_dwordx4 v19, s[4:7], s66 offen lds
    s_add_u32 s66, s66, 8192
    v_pk_add_f32 v[32:33], v[32:33], v[176:177]
    v_pk_fma_f32 v[40:41], v[176:177], v[176:177], v[40:41]
    v_pk_add_f32 v[34:35], v[34:35], v[178:179]
    v_pk_fma_f32 v[42:43], v[178:179], v[178:179], v[42:43]
    v_pk_add_f32 v[36:37], v[36:37], v[180:181]
    v_pk_fma_f32 v[44:45], v[180:181], v[180:181], v[44:45]
    v_pk_add_f32 v[38:39], v[38:39], v[182:183]
    v_pk_fma_f32 v[46:47], v[182:183], v[182:183], v[46:47]
    s_mov_b32 m0, s67
    s_add_u32 s67, s67, 1024
    buffer_load_dwordx4 v20, s[4:7], s66 offen lds
    s_add_u32 s66, s66, 8192
    v_pk_add_f32 v[32:33], v[32:33], v[184:185]
    v_pk_fma_f32 v[40:41], v[184:185], v[184:185], v[40:41]
    v_pk_add_f32 v[34:35], v[34:35], v[186:187]
    v_pk_fma_f32 v[42:43], v[186:187], v[186:187], v[42:43]
    v_pk_add_f32 v[36:37], v[36:37], v[188:189]
    v_pk_fma_f32 v[44:45], v[188:189], v[188:189], v[44:45]
    v_pk_add_f32 v[38:39], v[38:39], v[190:191]
    v_pk_fma_f32 v[46:47], v[190:191], v[190:191], v[46:47]
    s_mov_b32 m0, s67
    s_add_u32 s67, s67, 1024
    buffer_load_dwordx4 v19, s[4:7], s66 offen lds
    s_add_u32 s66, s66, 8192
    v_pk_add_f32 v[32:33], v[32:33], v[192:193]
    v_pk_fma_f32 v[40:41], v[192:193], v[192:193], v[40:41]
    v_pk_add_f32 v[34:35], v[34:35], v[194:195]
    v_pk_fma_f32 v[42:43], v[194:195], v[194:195], v[42:43]
    v_pk_add_f32 v[36:37], v[36:37], v[196:197]
    v_pk_fma_f32 v[44:45], v[196:197], v[196:197], v[44:45]
    v_pk_add_f32 v[38:39], v[38:39], v[198:199]
    v_pk_fma_f32 v[46:47], v[198:199], v[198:199], v[46:47]
    s_mov_b32 m0, s67
    s_add_u32 s67, s67, 1024
    buffer_load_dwordx4 v20, s[4:7], s66 offen lds
    s_add_u32 s66, s66, 8192
    v_pk_add_f32 v[32:33], v[32:33], v[200:201]
    v_pk_fma_f32 v[40:41], v[200:201], v[200:201], v[40:41]
    v_pk_add_f32 v[34:35], v[34:35], v[202:203]
    v_pk_fma_f32 v[42:43], v[202:203], v[202:203], v[42:43]
    v_pk_add_f32 v[36:37], v[36:37], v[204:205]
    v_pk_fma_f32 v[44:45], v[204:205], v[204:205], v[44:45]
    v_pk_add_f32 v[38:39], v[38:39], v[206:207]
    v_pk_fma_f32 v[46:47], v[206:207], v[206:207], v[46:47]
    s_mov_b32 m0, s67
    s_add_u32 s67, s67, 1024
    buffer_load_dwordx4 v19, s[4:7], s66 offen lds
    s_add_u32 s66, s66, 8192
    v_pk_add_f32 v[32:33], v[32:33], v[208:209]
    v_pk_fma_f32 v[40:41], v[208:209], v[208:209], v[40:41]
    v_pk_add_f32 v[34:35], v[34:35], v[210:211]
    v_pk_fma_f32 v[42:43], v[210:211], v[210:211], v[42:43]
    v_pk_add_f32 v[36:37], v[36:37], v[212:213]
    v_pk_fma_f32 v[44:45], v[212:213], v[212:213], v[44:45]
    v_pk_add_f32 v[38:39], v[38:39], v[214:215]
    v_pk_fma_f32 v[46:47], v[214:215], v[214:215], v[46:47]
    s_mov_b32 m0, s67
    s_add_u32 s67, s67, 1024
    buffer_load_dwordx4 v20, s[4:7], s66 offen lds
    s_add_u32 s66, s66, 8192
    v_pk_add_f32 v[32:33], v[32:33], v[216:217]
    v_pk_fma_f32 v[40:41], v[216:217], v[216:217], v[40:41]
    v_pk_add_f32 v[34:35], v[34:35], v[218:219]
    v_pk_fma_f32 v[42:43], v[218:219], v[218:219], v[42:43]
    v_pk_add_f32 v[36:37], v[36:37], v[220:221]
    v_pk_fma_f32 v[44:45], v[220:221], v[220:221], v[44:45]
    v_pk_add_f32 v[38:39], v[38:39], v[222:223]
    v_pk_fma_f32 v[46:47], v[222:223], v[222:223], v[46:47]
    s_mov_b32 m0, s67
    s_add_u32 s67, s67, 1024
    buffer_load_dwordx4 v19, s[4:7], s66 offen lds
    s_add_u32 s66, s66, 8192
    v_pk_add_f32 v[32:33], v[32:33], v[224:225]
    v_pk_fma_f32 v[40:41], v[224:225], v[224:225], v[40:41]
    v_pk_add_f32 v[34:35], v[34:35], v[226:227]
    v_pk_fma_f32 v[42:43], v[226:227], v[226:227], v[42:43]
    v_pk_add_f32 v[36:37], v[36:37], v[228:229]
    v_pk_fma_f32 v[44:45], v[228:229], v[228:229], v[44:45]
    v_pk_add_f32 v[38:39], v[38:39], v[230:231]
    v_pk_fma_f32 v[46:47], v[230:231], v[230:231], v[46:47]
    s_mov_b32 m0, s67
    s_add_u32 s67, s67, 1024
    buffer_load_dwordx4 v20, s[4:7], s66 offen lds
    s_add_u32 s66, s66, 8192
    v_pk_add_f32 v[32:33], v[32:33], v[232:233]
    v_pk_fma_f32 v[40:41], v[232:233], v[232:233], v[40:41]
    v_pk_add_f32 v[34:35], v[34:35], v[234:235]
    v_pk_fma_f32 v[42:43], v[234:235], v[234:235], v[42:43]
    v_pk_add_f32 v[36:37], v[36:37], v[236:237]
    v_pk_fma_f32 v[44:45], v[236:237], v[236:237], v[44:45]
    v_pk_add_f32 v[38:39], v[38:39], v[238:239]
    v_pk_fma_f32 v[46:47], v[238:239], v[238:239], v[46:47]
    s_mov_b32 m0, s67
    s_add_u32 s67, s67, 1024
    buffer_load_dwordx4 v19, s[4:7], s66 offen lds
    s_add_u32 s66, s66, 8192
    v_pk_add_f32 v[32:33], v[32:33], v[240:241]
    v_pk_fma_f32 v[40:41], v[240:241], v[240:241], v[40:41]
    v_pk_add_f32 v[34:35], v[34:35], v[242:243]
    v_pk_fma_f32 v[42:43], v[242:243], v[242:243], v[42:43]
    v_pk_add_f32 v[36:37], v[36:37], v[244:245]
    v_pk_fma_f32 v[44:45], v[244:245], v[244:245], v[44:45]
    v_pk_add_f32 v[38:39], v[38:39], v[246:247]
    v_pk_fma_f32 v[46:47], v[246:247], v[246:247], v[46:47]
    s_mov_b32 m0, s67
    s_add_u32 s67, s67, 1024
    buffer_load_dwordx4 v20, s[4:7], s66 offen lds
    s_add_u32 s66, s66, 8192
    v_pk_add_f32 v[32:33], v[32:33], v[248:249]
    v_pk_fma_f32 v[40:41], v[248:249], v[248:249], v[40:41]
    v_pk_add_f32 v[34:35], v[34:35], v[250:251]
    v_pk_fma_f32 v[42:43], v[250:251], v[250:251], v[42:43]
    v_pk_add_f32 v[36:37], v[36:37], v[252:253]
    v_pk_fma_f32 v[44:45], v[252:253], v[252:253], v[44:45]
    v_pk_add_f32 v[38:39], v[38:39], v[254:255]
    v_pk_fma_f32 v[46:47], v[254:255], v[254:255], v[46:47]
    s_mov_b32 m0, s67
    s_add_u32 s67, s67, 1024
    buffer_load_dwordx4 v19, s[4:7], s66 offen lds
    s_add_u32 s66, s66, 8192
    v_pk_add_f32 v[32:33], v[32:33], v[34:35]
    v_pk_add_f32 v[36:37], v[36:37], v[38:39]
    v_pk_add_f32 v[32:33], v[32:33], v[36:37]
    v_add_f32 v32, v32, v33
    v_pk_add_f32 v[40:41], v[40:41], v[42:43]
    v_pk_add_f32 v[44:45], v[44:45], v[46:47]
    v_pk_add_f32 v[40:41], v[40:41], v[44:45]
    v_add_f32 v40, v40, v41
    v_mov_b32 v33, v32
    v_mov_b32 v41, v40
    s_nop 0
    v_permlane32_swap_b32 v32, v33
    v_permlane32_swap_b32 v40, v41
    v_add_f32 v32, v32, v33
    v_add_f32 v40, v40, v41
    v_mov_b32 v33, v32
    v_mov_b32 v41, v40
    s_nop 0
    v_permlane16_swap_b32 v32, v33
    v_permlane16_swap_b32 v40, v41
    v_add_f32 v32, v32, v33
    v_add_f32 v40, v40, v41
    v_mul_f32 v34, 0xbb000000, v32
    v_mul_f32 v40, 0x3b000000, v40
    v_fma_f32 v40, -v34, v34, v40
    v_max_f32 v40, 0, v40
    v_add_f32 v40, 0x3727c5ac, v40
    v_rsq_f32 v36, v40
    s_nop 0
    v_mul_f32 v34, v34, v36
    s_mov_b32 s23, 241664
    v_pk_fma_f32 v[128:129], v[128:129], v[36:37], v[34:35] op_sel_hi:[1,0,0]
    s_mov_b32 m0, s67
    s_add_u32 s67, s67, 1024
    buffer_load_dwordx4 v20, s[4:7], s66 offen lds
    s_add_u32 s66, s66, 8192
    v_pk_fma_f32 v[130:131], v[130:131], v[36:37], v[34:35] op_sel_hi:[1,0,0]
    v_pk_fma_f32 v[132:133], v[132:133], v[36:37], v[34:35] op_sel_hi:[1,0,0]
    v_pk_fma_f32 v[134:135], v[134:135], v[36:37], v[34:35] op_sel_hi:[1,0,0]
    v_pk_fma_f32 v[136:137], v[136:137], v[36:37], v[34:35] op_sel_hi:[1,0,0]
    v_pk_fma_f32 v[138:139], v[138:139], v[36:37], v[34:35] op_sel_hi:[1,0,0]
    v_pk_fma_f32 v[140:141], v[140:141], v[36:37], v[34:35] op_sel_hi:[1,0,0]
    v_pk_fma_f32 v[142:143], v[142:143], v[36:37], v[34:35] op_sel_hi:[1,0,0]
    v_pk_fma_f32 v[144:145], v[144:145], v[36:37], v[34:35] op_sel_hi:[1,0,0]
    v_pk_fma_f32 v[146:147], v[146:147], v[36:37], v[34:35] op_sel_hi:[1,0,0]
    v_pk_fma_f32 v[148:149], v[148:149], v[36:37], v[34:35] op_sel_hi:[1,0,0]
    v_pk_fma_f32 v[150:151], v[150:151], v[36:37], v[34:35] op_sel_hi:[1,0,0]
    v_pk_fma_f32 v[152:153], v[152:153], v[36:37], v[34:35] op_sel_hi:[1,0,0]
    v_pk_fma_f32 v[154:155], v[154:155], v[36:37], v[34:35] op_sel_hi:[1,0,0]
    v_pk_fma_f32 v[156:157], v[156:157], v[36:37], v[34:35] op_sel_hi:[1,0,0]
    v_pk_fma_f32 v[158:159], v[158:159], v[36:37], v[34:35] op_sel_hi:[1,0,0]
    v_pk_fma_f32 v[160:161], v[160:161], v[36:37], v[34:35] op_sel_hi:[1,0,0]
    v_pk_fma_f32 v[162:163], v[162:163], v[36:37], v[34:35] op_sel_hi:[1,0,0]
    v_pk_fma_f32 v[164:165], v[164:165], v[36:37], v[34:35] op_sel_hi:[1,0,0]
    v_pk_fma_f32 v[166:167], v[166:167], v[36:37], v[34:35] op_sel_hi:[1,0,0]
    v_pk_fma_f32 v[168:169], v[168:169], v[36:37], v[34:35] op_sel_hi:[1,0,0]
    v_pk_fma_f32 v[170:171], v[170:171], v[36:37], v[34:35] op_sel_hi:[1,0,0]
    v_pk_fma_f32 v[172:173], v[172:173], v[36:37], v[34:35] op_sel_hi:[1,0,0]
    v_pk_fma_f32 v[174:175], v[174:175], v[36:37], v[34:35] op_sel_hi:[1,0,0]
    v_pk_fma_f32 v[176:177], v[176:177], v[36:37], v[34:35] op_sel_hi:[1,0,0]
    v_pk_fma_f32 v[178:179], v[178:179], v[36:37], v[34:35] op_sel_hi:[1,0,0]
    v_pk_fma_f32 v[180:181], v[180:181], v[36:37], v[34:35] op_sel_hi:[1,0,0]
    v_pk_fma_f32 v[182:183], v[182:183], v[36:37], v[34:35] op_sel_hi:[1,0,0]
    v_pk_fma_f32 v[184:185], v[184:185], v[36:37], v[34:35] op_sel_hi:[1,0,0]
    v_pk_fma_f32 v[186:187], v[186:187], v[36:37], v[34:35] op_sel_hi:[1,0,0]
    v_pk_fma_f32 v[188:189], v[188:189], v[36:37], v[34:35] op_sel_hi:[1,0,0]
    v_pk_fma_f32 v[190:191], v[190:191], v[36:37], v[34:35] op_sel_hi:[1,0,0]
    buffer_load_dwordx4 v[40:43], v3, s[8:11], s23 offen offset:0 sc1
    buffer_load_dwordx4 v[44:47], v3, s[8:11], s23 offen offset:1024 sc1
    buffer_load_dwordx4 v[48:51], v3, s[8:11], s23 offen offset:2048 sc1
    buffer_load_dwordx4 v[52:55], v3, s[8:11], s23 offen offset:3072 sc1
    v_pk_fma_f32 v[192:193], v[192:193], v[36:37], v[34:35] op_sel_hi:[1,0,0]
    v_pk_fma_f32 v[194:195], v[194:195], v[36:37], v[34:35] op_sel_hi:[1,0,0]
    v_pk_fma_f32 v[196:197], v[196:197], v[36:37], v[34:35] op_sel_hi:[1,0,0]
    v_pk_fma_f32 v[198:199], v[198:199], v[36:37], v[34:35] op_sel_hi:[1,0,0]
    v_pk_fma_f32 v[200:201], v[200:201], v[36:37], v[34:35] op_sel_hi:[1,0,0]
    v_pk_fma_f32 v[202:203], v[202:203], v[36:37], v[34:35] op_sel_hi:[1,0,0]
    v_pk_fma_f32 v[204:205], v[204:205], v[36:37], v[34:35] op_sel_hi:[1,0,0]
    v_pk_fma_f32 v[206:207], v[206:207], v[36:37], v[34:35] op_sel_hi:[1,0,0]
    v_pk_fma_f32 v[208:209], v[208:209], v[36:37], v[34:35] op_sel_hi:[1,0,0]
    v_pk_fma_f32 v[210:211], v[210:211], v[36:37], v[34:35] op_sel_hi:[1,0,0]
    v_pk_fma_f32 v[212:213], v[212:213], v[36:37], v[34:35] op_sel_hi:[1,0,0]
    v_pk_fma_f32 v[214:215], v[214:215], v[36:37], v[34:35] op_sel_hi:[1,0,0]
    v_pk_fma_f32 v[216:217], v[216:217], v[36:37], v[34:35] op_sel_hi:[1,0,0]
    v_pk_fma_f32 v[218:219], v[218:219], v[36:37], v[34:35] op_sel_hi:[1,0,0]
    v_pk_fma_f32 v[220:221], v[220:221], v[36:37], v[34:35] op_sel_hi:[1,0,0]
    v_pk_fma_f32 v[222:223], v[222:223], v[36:37], v[34:35] op_sel_hi:[1,0,0]
    v_pk_fma_f32 v[224:225], v[224:225], v[36:37], v[34:35] op_sel_hi:[1,0,0]
    v_pk_fma_f32 v[226:227], v[226:227], v[36:37], v[34:35] op_sel_hi:[1,0,0]
    v_pk_fma_f32 v[228:229], v[228:229], v[36:37], v[34:35] op_sel_hi:[1,0,0]
    v_pk_fma_f32 v[230:231], v[230:231], v[36:37], v[34:35] op_sel_hi:[1,0,0]
    v_pk_fma_f32 v[232:233], v[232:233], v[36:37], v[34:35] op_sel_hi:[1,0,0]
    v_pk_fma_f32 v[234:235], v[234:235], v[36:37], v[34:35] op_sel_hi:[1,0,0]
    v_pk_fma_f32 v[236:237], v[236:237], v[36:37], v[34:35] op_sel_hi:[1,0,0]
    v_pk_fma_f32 v[238:239], v[238:239], v[36:37], v[34:35] op_sel_hi:[1,0,0]
    v_pk_fma_f32 v[240:241], v[240:241], v[36:37], v[34:35] op_sel_hi:[1,0,0]
    v_pk_fma_f32 v[242:243], v[242:243], v[36:37], v[34:35] op_sel_hi:[1,0,0]
    v_pk_fma_f32 v[244:245], v[244:245], v[36:37], v[34:35] op_sel_hi:[1,0,0]
    v_pk_fma_f32 v[246:247], v[246:247], v[36:37], v[34:35] op_sel_hi:[1,0,0]
    v_pk_fma_f32 v[248:249], v[248:249], v[36:37], v[34:35] op_sel_hi:[1,0,0]
    v_pk_fma_f32 v[250:251], v[250:251], v[36:37], v[34:35] op_sel_hi:[1,0,0]
    v_pk_fma_f32 v[252:253], v[252:253], v[36:37], v[34:35] op_sel_hi:[1,0,0]
    v_pk_fma_f32 v[254:255], v[254:255], v[36:37], v[34:35] op_sel_hi:[1,0,0]
    s_cmp_eq_u32 s0, 0
    s_cbranch_scc0 Lnkvf_10
    v_add_u32 v7, 94208, v17
    s_waitcnt vmcnt(21)
    ds_read_b64_tr_b16 a[0:1], v7 offset:0
    ds_read_b64_tr_b16 a[2:3], v7 offset:256
    ds_read_b64_tr_b16 a[4:5], v7 offset:1024
    ds_read_b64_tr_b16 a[6:7], v7 offset:1280
    ds_read_b64_tr_b16 a[8:9], v7 offset:2048
    ds_read_b64_tr_b16 a[10:11], v7 offset:2304
    ds_read_b64_tr_b16 a[12:13], v7 offset:3072
    ds_read_b64_tr_b16 a[14:15], v7 offset:3328
    ds_read_b64_tr_b16 a[16:17], v7 offset:4096
    ds_read_b64_tr_b16 a[18:19], v7 offset:4352
    ds_read_b64_tr_b16 a[20:21], v7 offset:5120
    ds_read_b64_tr_b16 a[22:23], v7 offset:5376
    ds_read_b64_tr_b16 a[24:25], v7 offset:6144
    ds_read_b64_tr_b16 a[26:27], v7 offset:6400
    ds_read_b64_tr_b16 a[28:29], v7 offset:7168
    ds_read_b64_tr_b16 a[30:31], v7 offset:7424
    ds_read_b64_tr_b16 a[32:33], v7 offset:8192
    ds_read_b64_tr_b16 a[34:35], v7 offset:8448
    ds_read_b64_tr_b16 a[36:37], v7 offset:9216
    ds_read_b64_tr_b16 a[38:39], v7 offset:9472
    ds_read_b64_tr_b16 a[40:41], v7 offset:10240
    ds_read_b64_tr_b16 a[42:43], v7 offset:10496
    ds_read_b64_tr_b16 a[44:45], v7 offset:11264
    ds_read_b64_tr_b16 a[46:47], v7 offset:11520
    ds_read_b64_tr_b16 a[48:49], v7 offset:12288
    ds_read_b64_tr_b16 a[50:51], v7 offset:12544
    ds_read_b64_tr_b16 a[52:53], v7 offset:13312
    ds_read_b64_tr_b16 a[54:55], v7 offset:13568
    ds_read_b64_tr_b16 a[56:57], v7 offset:14336
    ds_read_b64_tr_b16 a[58:59], v7 offset:14592
    ds_read_b64_tr_b16 a[60:61], v7 offset:15360
    ds_read_b64_tr_b16 a[62:63], v7 offset:15616
Lnkvf_10:
    s_mul_i32 s77, s48, 12288
    s_lshl_b32 s68, s48, 12
    s_movk_i32 s74, 1024
    s_movk_i32 s75, 4
    s_movk_i32 s76, 8
    s_movk_i32 s1, 2048
    s_movk_i32 s20, 8192
    s_cmp_eq_u32 s48, 2
    s_cbranch_scc1 Lr2_11
    s_cmp_eq_u32 s48, 3
    s_cbranch_scc1 Lr3_12
    s_and_b32 s64, s46, 15
    s_mul_i32 s64, s64, 114688
    s_lshr_b32 s3, s46, 4
    s_mul_i32 s3, s3, 1792
    s_add_u32 s64, s64, s3
    s_mul_i32 s3, s47, 224
    s_add_u32 s64, s64, s3
    s_lshl_b32 s3, s48, 7
    s_add_u32 s64, s64, s3
    s_add_u32 s56, s28, s64
    s_addc_u32 s57, s29, 0
    s_sub_u32 s58, 1835008, s64
    s_mov_b32 s59, 0x20000
    s_movk_i32 s74, 3584
    s_movk_i32 s20, 28672
    s_mov_b32 s21, 57344
    s_mov_b32 s22, 86016
    s_lshl_b32 s36, s47, 5
    s_add_u32 s36, s36, s46
    s_mul_i32 s36, s36, 7168
    s_add_u32 s36, s36, s68
    s_add_u32 s36, s36, 16777216
    s_mov_b32 s24, s36
    s_cmp_eq_u32 s48, 0
    s_cselect_b32 s37, s36, 18874368
    s_branch Lre_13
Lr2_11:
    s_min_u32 s67, s46, 27
    s_mul_i32 s64, s67, 37
    s_lshr_b32 s64, s64, 8
    s_mul_i32 s3, s64, 7
    s_sub_u32 s65, s67, s3
    s_mul_i32 s64, s64, 224
    s_lshl_b32 s3, s65, 5
    s_add_u32 s66, s3, 16
    s_cmp_lt_u32 s65, 3
    s_cselect_b32 s3, s3, s66
    s_cmp_eq_u32 s65, 6
    s_cselect_b32 s3, 96, s3
    s_cselect_b32 s21, 112, 16
    s_cselect_b32 s75, 8, 4
    s_cselect_b32 s76, 16, 8
    s_cselect_b32 s1, 512, s1
    s_lshl_b32 s21, s21, 10
    s_add_u32 s22, s21, 8192
    s_add_u32 s64, s64, s3
    s_lshl_b32 s64, s64, 10
    s_lshl_b32 s3, s47, 7
    s_add_u32 s64, s64, s3
    s_add_u32 s56, s34, s64
    s_addc_u32 s57, s35, 0
    s_sub_u32 s58, 917504, s64
    s_mov_b32 s59, 0x20000
    s_mul_i32 s3, s67, 37
    s_lshr_b32 s3, s3, 8
    s_sub_u32 s36, s67, s3
    s_add_u32 s3, s3, 24
    s_cmp_eq_u32 s65, 6
    s_cselect_b32 s3, s3, s36
    s_mul_i32 s36, s47, 28
    s_add_u32 s36, s36, s3
    s_lshl_b32 s36, s36, 12
    s_add_u32 s36, s36, 14680064
    s_cmp_lt_u32 s46, 28
    s_cselect_b32 s36, s36, 18874368
    s_mov_b32 s37, s36
    s_mov_b32 s24, s36
    s_branch Lre_13
Lr3_12:
    s_lshr_b32 s67, s46, 1
    s_lshl_b32 s64, s67, 15
    s_lshl_b32 s3, s47, 7
    s_add_u32 s64, s64, s3
    s_add_u32 s56, s24, s64
    s_addc_u32 s57, s25, 0
    s_sub_u32 s58, 524288, s64
    s_mov_b32 s59, 0x20000
    s_movk_i32 s21, 16384
    s_movk_i32 s22, 24576
    s_movk_i32 s75, 16
    s_movk_i32 s76, 4
    s_movk_i32 s1, 1024
    s_lshl_b32 s36, s47, 4
    s_add_u32 s36, s36, s67
    s_lshl_b32 s36, s36, 12
    s_add_u32 s36, s36, 14155776
    s_bitcmp1_b32 s46, 0
    s_cselect_b32 s37, s36, 18874368
    s_cselect_b32 s36, 18874368, s36
    s_mov_b32 s24, s37
Lre_13:
    s_and_b32 s64, s2, 15
    s_mul_i32 s64, s64, 196608
    s_lshr_b32 s65, s2, 4
    s_lshl_b32 s3, s65, 8
    s_add_u32 s64, s64, s3
    s_lshl_b32 s3, s48, 6
    s_add_u32 s64, s64, s3
    s_add_u32 s64, s64, 2048
    s_add_u32 s60, s38, s64
    s_addc_u32 s61, s39, 0
    s_sub_u32 s62, 3145728, s64
    s_mov_b32 s63, 0x20000
    s_lshl_b32 s35, s48, 11
    s_add_u32 s35, s35, 16384
    s_lshl_b32 s64, s48, 11
    s_add_u32 s65, s64, 28672
    s_add_u32 s64, s64, 262144
    s_mul_i32 s66, s51, 4224
    s_add_u32 s66, s66, 262144
    s_lshl_b32 s67, s46, 10
L_ns1:
    s_waitcnt vmcnt(0)
    v_xor_b32 v40, s43, v40
    v_xor_b32 v41, s43, v41
    v_xor_b32 v42, s43, v42
    v_xor_b32 v43, s43, v43
    v_xor_b32 v44, s43, v44
    v_xor_b32 v45, s43, v45
    v_xor_b32 v46, s43, v46
    v_xor_b32 v47, s43, v47
    v_xor_b32 v48, s43, v48
    v_xor_b32 v49, s43, v49
    v_xor_b32 v50, s43, v50
    v_xor_b32 v51, s43, v51
    v_xor_b32 v52, s43, v52
    v_xor_b32 v53, s43, v53
    v_xor_b32 v54, s43, v54
    v_xor_b32 v55, s43, v55
    v_or3_b32 v4, v40, v41, v42
    v_or3_b32 v4, v4, v43, v44
    v_or3_b32 v4, v4, v45, v46
    v_or3_b32 v4, v4, v47, v48
    v_or3_b32 v4, v4, v49, v50
    v_or3_b32 v4, v4, v51, v52
    v_or3_b32 v4, v4, v53, v54
    v_or_b32 v4, v4, v55
    v_and_b32 v4, 0xffff, v4
    v_cmp_ne_u32 vcc, 0, v4
    s_cbranch_vccz L_parok
    s_mov_b64 exec, -1
    s_mov_b32 s3, 0
Lpoll_14:
    s_add_u32 s3, s3, 1
    s_cmp_gt_u32 s3, 131072
    s_cbranch_scc1 Lpollx_15
    s_sleep 5
    buffer_load_dwordx4 v[40:43], v3, s[8:11], s23 offen offset:0 sc1
    buffer_load_dwordx4 v[44:47], v3, s[8:11], s23 offen offset:1024 sc1
    buffer_load_dwordx4 v[48:51], v3, s[8:11], s23 offen offset:2048 sc1
    buffer_load_dwordx4 v[52:55], v3, s[8:11], s23 offen offset:3072 sc1
    s_waitcnt vmcnt(0)
    v_xor_b32 v40, s43, v40
    v_xor_b32 v41, s43, v41
    v_xor_b32 v42, s43, v42
    v_xor_b32 v43, s43, v43
    v_xor_b32 v44, s43, v44
    v_xor_b32 v45, s43, v45
    v_xor_b32 v46, s43, v46
    v_xor_b32 v47, s43, v47
    v_xor_b32 v48, s43, v48
    v_xor_b32 v49, s43, v49
    v_xor_b32 v50, s43, v50
    v_xor_b32 v51, s43, v51
    v_xor_b32 v52, s43, v52
    v_xor_b32 v53, s43, v53
    v_xor_b32 v54, s43, v54
    v_xor_b32 v55, s43, v55
    v_or3_b32 v4, v40, v41, v42
    v_or3_b32 v4, v4, v43, v44
    v_or3_b32 v4, v4, v45, v46
    v_or3_b32 v4, v4, v47, v48
    v_or3_b32 v4, v4, v49, v50
    v_or3_b32 v4, v4, v51, v52
    v_or3_b32 v4, v4, v53, v54
    v_or_b32 v4, v4, v55
    v_and_b32 v4, 0xffff, v4
    v_cmp_ne_u32 vcc, 0, v4
    s_cbranch_vccnz Lpoll_14
Lpollx_15:
    s_mov_b64 exec, -1
L_parok:
    s_lshl_b32 s3, s48, 12
    v_add_u32 v5, s3, v3
    ds_write_b128 v5, v[40:43] offset:0
    ds_write_b128 v5, v[44:47] offset:1024
    ds_write_b128 v5, v[48:51] offset:2048
    ds_write_b128 v5, v[52:55] offset:3072
    v_lshlrev_b32 v19, 5, v2
    v_add_u32 v19, s3, v19
    s_waitcnt lgkmcnt(0)
    s_bitcmp1_b32 s47, 0
    s_cbranch_scc1 LisV_16
    ds_read_b128 v[32:35], v19 offset:2048
    ds_read_b128 v[36:39], v19 offset:0
    ds_read_b128 v[40:43], v19 offset:2064
    ds_read_b128 v[44:47], v19 offset:16
    ds_read_b128 v[48:51], v19 offset:2176
    ds_read_b128 v[52:55], v19 offset:128
    ds_read_b128 v[56:59], v19 offset:2192
    ds_read_b128 v[60:63], v19 offset:144
    s_waitcnt lgkmcnt(6)
    v_pk_fma_f32 v[128:129], v[128:129], v[32:33], v[36:37]
    v_pk_fma_f32 v[130:131], v[130:131], v[34:35], v[38:39]
    ds_read_b128 v[32:35], v19 offset:2304
    ds_read_b128 v[36:39], v19 offset:256
    v_cvt_pk_bf16_f32 v64, v128, v129
    v_cvt_pk_bf16_f32 v65, v130, v131
    s_waitcnt lgkmcnt(6)
    v_pk_fma_f32 v[132:133], v[132:133], v[40:41], v[44:45]
    v_pk_fma_f32 v[134:135], v[134:135], v[42:43], v[46:47]
    ds_read_b128 v[40:43], v19 offset:2320
    ds_read_b128 v[44:47], v19 offset:272
    v_cvt_pk_bf16_f32 v66, v132, v133
    v_cvt_pk_bf16_f32 v67, v134, v135
    s_waitcnt lgkmcnt(6)
    v_pk_fma_f32 v[136:137], v[136:137], v[48:49], v[52:53]
    v_pk_fma_f32 v[138:139], v[138:139], v[50:51], v[54:55]
    v_mfma_f32_16x16x32_bf16 v[12:15], a[0:3], v[64:67], 0
    ds_read_b128 v[48:51], v19 offset:2432
    ds_read_b128 v[52:55], v19 offset:384
    v_cvt_pk_bf16_f32 v68, v136, v137
    v_cvt_pk_bf16_f32 v69, v138, v139
    s_waitcnt lgkmcnt(6)
    v_pk_fma_f32 v[140:141], v[140:141], v[56:57], v[60:61]
    v_pk_fma_f32 v[142:143], v[142:143], v[58:59], v[62:63]
    ds_read_b128 v[56:59], v19 offset:2448
    ds_read_b128 v[60:63], v19 offset:400
    v_cvt_pk_bf16_f32 v70, v140, v141
    v_cvt_pk_bf16_f32 v71, v142, v143
    s_waitcnt lgkmcnt(6)
    v_pk_fma_f32 v[144:145], v[144:145], v[32:33], v[36:37]
    v_pk_fma_f32 v[146:147], v[146:147], v[34:35], v[38:39]
    v_mfma_f32_16x16x32_bf16 v[12:15], a[4:7], v[68:71], v[12:15]
    ds_read_b128 v[32:35], v19 offset:2560
    ds_read_b128 v[36:39], v19 offset:512
    v_cvt_pk_bf16_f32 v72, v144, v145
    v_cvt_pk_bf16_f32 v73, v146, v147
    s_waitcnt lgkmcnt(6)
    v_pk_fma_f32 v[148:149], v[148:149], v[40:41], v[44:45]
    v_pk_fma_f32 v[150:151], v[150:151], v[42:43], v[46:47]
    ds_read_b128 v[40:43], v19 offset:2576
    ds_read_b128 v[44:47], v19 offset:528
    v_cvt_pk_bf16_f32 v74, v148, v149
    v_cvt_pk_bf16_f32 v75, v150, v151
    s_waitcnt lgkmcnt(6)
    v_pk_fma_f32 v[152:153], v[152:153], v[48:49], v[52:53]
    v_pk_fma_f32 v[154:155], v[154:155], v[50:51], v[54:55]
    v_mfma_f32_16x16x32_bf16 v[12:15], a[8:11], v[72:75], v[12:15]
    ds_read_b128 v[48:51], v19 offset:2688
    ds_read_b128 v[52:55], v19 offset:640
    v_cvt_pk_bf16_f32 v76, v152, v153
    v_cvt_pk_bf16_f32 v77, v154, v155
    s_waitcnt lgkmcnt(6)
    v_pk_fma_f32 v[156:157], v[156:157], v[56:57], v[60:61]
    v_pk_fma_f32 v[158:159], v[158:159], v[58:59], v[62:63]
    ds_read_b128 v[56:59], v19 offset:2704
    ds_read_b128 v[60:63], v19 offset:656
    v_cvt_pk_bf16_f32 v78, v156, v157
    v_cvt_pk_bf16_f32 v79, v158, v159
    s_waitcnt lgkmcnt(6)
    v_pk_fma_f32 v[160:161], v[160:161], v[32:33], v[36:37]
    v_pk_fma_f32 v[162:163], v[162:163], v[34:35], v[38:39]
    v_mfma_f32_16x16x32_bf16 v[12:15], a[12:15], v[76:79], v[12:15]
    ds_read_b128 v[32:35], v19 offset:2816
    ds_read_b128 v[36:39], v19 offset:768
    v_cvt_pk_bf16_f32 v80, v160, v161
    v_cvt_pk_bf16_f32 v81, v162, v163
    s_waitcnt lgkmcnt(6)
    v_pk_fma_f32 v[164:165], v[164:165], v[40:41], v[44:45]
    v_pk_fma_f32 v[166:167], v[166:167], v[42:43], v[46:47]
    ds_read_b128 v[40:43], v19 offset:2832
    ds_read_b128 v[44:47], v19 offset:784
    v_cvt_pk_bf16_f32 v82, v164, v165
    v_cvt_pk_bf16_f32 v83, v166, v167
    s_waitcnt lgkmcnt(6)
    v_pk_fma_f32 v[168:169], v[168:169], v[48:49], v[52:53]
    v_pk_fma_f32 v[170:171], v[170:171], v[50:51], v[54:55]
    v_mfma_f32_16x16x32_bf16 v[12:15], a[16:19], v[80:83], v[12:15]
    ds_read_b128 v[48:51], v19 offset:2944
    ds_read_b128 v[52:55], v19 offset:896
    v_cvt_pk_bf16_f32 v84, v168, v169
    v_cvt_pk_bf16_f32 v85, v170, v171
    s_waitcnt lgkmcnt(6)
    v_pk_fma_f32 v[172:173], v[172:173], v[56:57], v[60:61]
    v_pk_fma_f32 v[174:175], v[174:175], v[58:59], v[62:63]
    ds_read_b128 v[56:59], v19 offset:2960
    ds_read_b128 v[60:63], v19 offset:912
    v_cvt_pk_bf16_f32 v86, v172, v173
    v_cvt_pk_bf16_f32 v87, v174, v175
    s_waitcnt lgkmcnt(6)
    v_pk_fma_f32 v[176:177], v[176:177], v[32:33], v[36:37]
    v_pk_fma_f32 v[178:179], v[178:179], v[34:35], v[38:39]
    v_mfma_f32_16x16x32_bf16 v[12:15], a[20:23], v[84:87], v[12:15]
    ds_read_b128 v[32:35], v19 offset:3072
    ds_read_b128 v[36:39], v19 offset:1024
    v_cvt_pk_bf16_f32 v88, v176, v177
    v_cvt_pk_bf16_f32 v89, v178, v179
    s_waitcnt lgkmcnt(6)
    v_pk_fma_f32 v[180:181], v[180:181], v[40:41], v[44:45]
    v_pk_fma_f32 v[182:183], v[182:183], v[42:43], v[46:47]
    ds_read_b128 v[40:43], v19 offset:3088
    ds_read_b128 v[44:47], v19 offset:1040
    v_cvt_pk_bf16_f32 v90, v180, v181
    v_cvt_pk_bf16_f32 v91, v182, v183
    s_waitcnt lgkmcnt(6)
    v_pk_fma_f32 v[184:185], v[184:185], v[48:49], v[52:53]
    v_pk_fma_f32 v[186:187], v[186:187], v[50:51], v[54:55]
    v_mfma_f32_16x16x32_bf16 v[12:15], a[24:27], v[88:91], v[12:15]
    ds_read_b128 v[48:51], v19 offset:3200
    ds_read_b128 v[52:55], v19 offset:1152
    v_cvt_pk_bf16_f32 v92, v184, v185
    v_cvt_pk_bf16_f32 v93, v186, v187
    s_waitcnt lgkmcnt(6)
    v_pk_fma_f32 v[188:189], v[188:189], v[56:57], v[60:61]
    v_pk_fma_f32 v[190:191], v[190:191], v[58:59], v[62:63]
    ds_read_b128 v[56:59], v19 offset:3216
    ds_read_b128 v[60:63], v19 offset:1168
    v_cvt_pk_bf16_f32 v94, v188, v189
    v_cvt_pk_bf16_f32 v95, v190, v191
    s_waitcnt lgkmcnt(6)
    v_pk_fma_f32 v[192:193], v[192:193], v[32:33], v[36:37]
    v_pk_fma_f32 v[194:195], v[194:195], v[34:35], v[38:39]
    v_mfma_f32_16x16x32_bf16 v[12:15], a[28:31], v[92:95], v[12:15]
    ds_read_b128 v[32:35], v19 offset:3328
    ds_read_b128 v[36:39], v19 offset:1280
    v_cvt_pk_bf16_f32 v96, v192, v193
    v_cvt_pk_bf16_f32 v97, v194, v195
    s_waitcnt lgkmcnt(6)
    v_pk_fma_f32 v[196:197], v[196:197], v[40:41], v[44:45]
    v_pk_fma_f32 v[198:199], v[198:199], v[42:43], v[46:47]
    ds_read_b128 v[40:43], v19 offset:3344
    ds_read_b128 v[44:47], v19 offset:1296
    v_cvt_pk_bf16_f32 v98, v196, v197
    v_cvt_pk_bf16_f32 v99, v198, v199
    s_waitcnt lgkmcnt(6)
    v_pk_fma_f32 v[200:201], v[200:201], v[48:49], v[52:53]
    v_pk_fma_f32 v[202:203], v[202:203], v[50:51], v[54:55]
    v_mfma_f32_16x16x32_bf16 v[12:15], a[32:35], v[96:99], v[12:15]
    ds_read_b128 v[48:51], v19 offset:3456
    ds_read_b128 v[52:55], v19 offset:1408
    v_cvt_pk_bf16_f32 v100, v200, v201
    v_cvt_pk_bf16_f32 v101, v202, v203
    s_waitcnt lgkmcnt(6)
    v_pk_fma_f32 v[204:205], v[204:205], v[56:57], v[60:61]
    v_pk_fma_f32 v[206:207], v[206:207], v[58:59], v[62:63]
    ds_read_b128 v[56:59], v19 offset:3472
    ds_read_b128 v[60:63], v19 offset:1424
    v_cvt_pk_bf16_f32 v102, v204, v205
    v_cvt_pk_bf16_f32 v103, v206, v207
    s_waitcnt lgkmcnt(6)
    v_pk_fma_f32 v[208:209], v[208:209], v[32:33], v[36:37]
    v_pk_fma_f32 v[210:211], v[210:211], v[34:35], v[38:39]
    v_mfma_f32_16x16x32_bf16 v[12:15], a[36:39], v[100:103], v[12:15]
    ds_read_b128 v[32:35], v19 offset:3584
    ds_read_b128 v[36:39], v19 offset:1536
    v_cvt_pk_bf16_f32 v104, v208, v209
    v_cvt_pk_bf16_f32 v105, v210, v211
    s_waitcnt lgkmcnt(6)
    v_pk_fma_f32 v[212:213], v[212:213], v[40:41], v[44:45]
    v_pk_fma_f32 v[214:215], v[214:215], v[42:43], v[46:47]
    ds_read_b128 v[40:43], v19 offset:3600
    ds_read_b128 v[44:47], v19 offset:1552
    v_cvt_pk_bf16_f32 v106, v212, v213
    v_cvt_pk_bf16_f32 v107, v214, v215
    s_waitcnt lgkmcnt(6)
    v_pk_fma_f32 v[216:217], v[216:217], v[48:49], v[52:53]
    v_pk_fma_f32 v[218:219], v[218:219], v[50:51], v[54:55]
    v_mfma_f32_16x16x32_bf16 v[12:15], a[40:43], v[104:107], v[12:15]
    ds_read_b128 v[48:51], v19 offset:3712
    ds_read_b128 v[52:55], v19 offset:1664
    v_cvt_pk_bf16_f32 v108, v216, v217
    v_cvt_pk_bf16_f32 v109, v218, v219
    s_waitcnt lgkmcnt(6)
    v_pk_fma_f32 v[220:221], v[220:221], v[56:57], v[60:61]
    v_pk_fma_f32 v[222:223], v[222:223], v[58:59], v[62:63]
    ds_read_b128 v[56:59], v19 offset:3728
    ds_read_b128 v[60:63], v19 offset:1680
    v_cvt_pk_bf16_f32 v110, v220, v221
    v_cvt_pk_bf16_f32 v111, v222, v223
    s_waitcnt lgkmcnt(6)
    v_pk_fma_f32 v[224:225], v[224:225], v[32:33], v[36:37]
    v_pk_fma_f32 v[226:227], v[226:227], v[34:35], v[38:39]
    v_mfma_f32_16x16x32_bf16 v[12:15], a[44:47], v[108:111], v[12:15]
    ds_read_b128 v[32:35], v19 offset:3840
    ds_read_b128 v[36:39], v19 offset:1792
    v_cvt_pk_bf16_f32 v112, v224, v225
    v_cvt_pk_bf16_f32 v113, v226, v227
    s_waitcnt lgkmcnt(6)
    v_pk_fma_f32 v[228:229], v[228:229], v[40:41], v[44:45]
    v_pk_fma_f32 v[230:231], v[230:231], v[42:43], v[46:47]
    ds_read_b128 v[40:43], v19 offset:3856
    ds_read_b128 v[44:47], v19 offset:1808
    v_cvt_pk_bf16_f32 v114, v228, v229
    v_cvt_pk_bf16_f32 v115, v230, v231
    s_waitcnt lgkmcnt(6)
    v_pk_fma_f32 v[232:233], v[232:233], v[48:49], v[52:53]
    v_pk_fma_f32 v[234:235], v[234:235], v[50:51], v[54:55]
    v_mfma_f32_16x16x32_bf16 v[12:15], a[48:51], v[112:115], v[12:15]
    ds_read_b128 v[48:51], v19 offset:3968
    ds_read_b128 v[52:55], v19 offset:1920
    v_cvt_pk_bf16_f32 v116, v232, v233
    v_cvt_pk_bf16_f32 v117, v234, v235
    s_waitcnt lgkmcnt(6)
    v_pk_fma_f32 v[236:237], v[236:237], v[56:57], v[60:61]
    v_pk_fma_f32 v[238:239], v[238:239], v[58:59], v[62:63]
    ds_read_b128 v[56:59], v19 offset:3984
    ds_read_b128 v[60:63], v19 offset:1936
    v_cvt_pk_bf16_f32 v118, v236, v237
    v_cvt_pk_bf16_f32 v119, v238, v239
    s_waitcnt lgkmcnt(6)
    v_pk_fma_f32 v[240:241], v[240:241], v[32:33], v[36:37]
    v_pk_fma_f32 v[242:243], v[242:243], v[34:35], v[38:39]
    v_mfma_f32_16x16x32_bf16 v[12:15], a[52:55], v[116:119], v[12:15]
    v_cvt_pk_bf16_f32 v120, v240, v241
    v_cvt_pk_bf16_f32 v121, v242, v243
    s_waitcnt lgkmcnt(4)
    v_pk_fma_f32 v[244:245], v[244:245], v[40:41], v[44:45]
    v_pk_fma_f32 v[246:247], v[246:247], v[42:43], v[46:47]
    v_cvt_pk_bf16_f32 v122, v244, v245
    v_cvt_pk_bf16_f32 v123, v246, v247
    s_waitcnt lgkmcnt(2)
    v_pk_fma_f32 v[248:249], v[248:249], v[48:49], v[52:53]
    v_pk_fma_f32 v[250:251], v[250:251], v[50:51], v[54:55]
    v_mfma_f32_16x16x32_bf16 v[12:15], a[56:59], v[120:123], v[12:15]
    v_cvt_pk_bf16_f32 v124, v248, v249
    v_cvt_pk_bf16_f32 v125, v250, v251
    s_waitcnt lgkmcnt(0)
    v_pk_fma_f32 v[252:253], v[252:253], v[56:57], v[60:61]
    v_pk_fma_f32 v[254:255], v[254:255], v[58:59], v[62:63]
    v_cvt_pk_bf16_f32 v126, v252, v253
    v_cvt_pk_bf16_f32 v127, v254, v255
    s_nop 1
    v_mfma_f32_16x16x32_bf16 v[12:15], a[60:63], v[124:127], v[12:15]
    s_branch Lhdone_17
LisV_16:
    ds_read_b128 v[32:35], v19 offset:2048
    ds_read_b128 v[36:39], v19 offset:0
    ds_read_b128 v[40:43], v19 offset:2064
    ds_read_b128 v[44:47], v19 offset:16
    ds_read_b128 v[48:51], v19 offset:2176
    ds_read_b128 v[52:55], v19 offset:128
    ds_read_b128 v[56:59], v19 offset:2192
    ds_read_b128 v[60:63], v19 offset:144
    s_waitcnt lgkmcnt(6)
    v_pk_fma_f32 v[128:129], v[128:129], v[32:33], v[36:37]
    v_pk_fma_f32 v[130:131], v[130:131], v[34:35], v[38:39]
    ds_read_b128 v[32:35], v19 offset:2304
    ds_read_b128 v[36:39], v19 offset:256
    v_cvt_pk_bf16_f32 v64, v128, v129
    v_cvt_pk_bf16_f32 v65, v130, v131
    s_waitcnt lgkmcnt(6)
    v_pk_fma_f32 v[132:133], v[132:133], v[40:41], v[44:45]
    v_pk_fma_f32 v[134:135], v[134:135], v[42:43], v[46:47]
    ds_read_b128 v[40:43], v19 offset:2320
    ds_read_b128 v[44:47], v19 offset:272
    v_cvt_pk_bf16_f32 v66, v132, v133
    v_cvt_pk_bf16_f32 v67, v134, v135
    s_waitcnt lgkmcnt(6)
    v_pk_fma_f32 v[136:137], v[136:137], v[48:49], v[52:53]
    v_pk_fma_f32 v[138:139], v[138:139], v[50:51], v[54:55]
    v_mfma_f32_16x16x32_bf16 v[12:15], v[64:67], a[0:3], 0
    ds_read_b128 v[48:51], v19 offset:2432
    ds_read_b128 v[52:55], v19 offset:384
    v_cvt_pk_bf16_f32 v68, v136, v137
    v_cvt_pk_bf16_f32 v69, v138, v139
    s_waitcnt lgkmcnt(6)
    v_pk_fma_f32 v[140:141], v[140:141], v[56:57], v[60:61]
    v_pk_fma_f32 v[142:143], v[142:143], v[58:59], v[62:63]
    ds_read_b128 v[56:59], v19 offset:2448
    ds_read_b128 v[60:63], v19 offset:400
    v_cvt_pk_bf16_f32 v70, v140, v141
    v_cvt_pk_bf16_f32 v71, v142, v143
    s_waitcnt lgkmcnt(6)
    v_pk_fma_f32 v[144:145], v[144:145], v[32:33], v[36:37]
    v_pk_fma_f32 v[146:147], v[146:147], v[34:35], v[38:39]
    v_mfma_f32_16x16x32_bf16 v[12:15], v[68:71], a[4:7], v[12:15]
    ds_read_b128 v[32:35], v19 offset:2560
    ds_read_b128 v[36:39], v19 offset:512
    v_cvt_pk_bf16_f32 v72, v144, v145
    v_cvt_pk_bf16_f32 v73, v146, v147
    s_waitcnt lgkmcnt(6)
    v_pk_fma_f32 v[148:149], v[148:149], v[40:41], v[44:45]
    v_pk_fma_f32 v[150:151], v[150:151], v[42:43], v[46:47]
    ds_read_b128 v[40:43], v19 offset:2576
    ds_read_b128 v[44:47], v19 offset:528
    v_cvt_pk_bf16_f32 v74, v148, v149
    v_cvt_pk_bf16_f32 v75, v150, v151
    s_waitcnt lgkmcnt(6)
    v_pk_fma_f32 v[152:153], v[152:153], v[48:49], v[52:53]
    v_pk_fma_f32 v[154:155], v[154:155], v[50:51], v[54:55]
    v_mfma_f32_16x16x32_bf16 v[12:15], v[72:75], a[8:11], v[12:15]
    ds_read_b128 v[48:51], v19 offset:2688
    ds_read_b128 v[52:55], v19 offset:640
    v_cvt_pk_bf16_f32 v76, v152, v153
    v_cvt_pk_bf16_f32 v77, v154, v155
    s_waitcnt lgkmcnt(6)
    v_pk_fma_f32 v[156:157], v[156:157], v[56:57], v[60:61]
    v_pk_fma_f32 v[158:159], v[158:159], v[58:59], v[62:63]
    ds_read_b128 v[56:59], v19 offset:2704
    ds_read_b128 v[60:63], v19 offset:656
    v_cvt_pk_bf16_f32 v78, v156, v157
    v_cvt_pk_bf16_f32 v79, v158, v159
    s_waitcnt lgkmcnt(6)
    v_pk_fma_f32 v[160:161], v[160:161], v[32:33], v[36:37]
    v_pk_fma_f32 v[162:163], v[162:163], v[34:35], v[38:39]
    v_mfma_f32_16x16x32_bf16 v[12:15], v[76:79], a[12:15], v[12:15]
    ds_read_b128 v[32:35], v19 offset:2816
    ds_read_b128 v[36:39], v19 offset:768
    v_cvt_pk_bf16_f32 v80, v160, v161
    v_cvt_pk_bf16_f32 v81, v162, v163
    s_waitcnt lgkmcnt(6)
    v_pk_fma_f32 v[164:165], v[164:165], v[40:41], v[44:45]
    v_pk_fma_f32 v[166:167], v[166:167], v[42:43], v[46:47]
    ds_read_b128 v[40:43], v19 offset:2832
    ds_read_b128 v[44:47], v19 offset:784
    v_cvt_pk_bf16_f32 v82, v164, v165
    v_cvt_pk_bf16_f32 v83, v166, v167
    s_waitcnt lgkmcnt(6)
    v_pk_fma_f32 v[168:169], v[168:169], v[48:49], v[52:53]
    v_pk_fma_f32 v[170:171], v[170:171], v[50:51], v[54:55]
    v_mfma_f32_16x16x32_bf16 v[12:15], v[80:83], a[16:19], v[12:15]
    ds_read_b128 v[48:51], v19 offset:2944
    ds_read_b128 v[52:55], v19 offset:896
    v_cvt_pk_bf16_f32 v84, v168, v169
    v_cvt_pk_bf16_f32 v85, v170, v171
    s_waitcnt lgkmcnt(6)
    v_pk_fma_f32 v[172:173], v[172:173], v[56:57], v[60:61]
    v_pk_fma_f32 v[174:175], v[174:175], v[58:59], v[62:63]
    ds_read_b128 v[56:59], v19 offset:2960
    ds_read_b128 v[60:63], v19 offset:912
    v_cvt_pk_bf16_f32 v86, v172, v173
    v_cvt_pk_bf16_f32 v87, v174, v175
    s_waitcnt lgkmcnt(6)
    v_pk_fma_f32 v[176:177], v[176:177], v[32:33], v[36:37]
    v_pk_fma_f32 v[178:179], v[178:179], v[34:35], v[38:39]
    v_mfma_f32_16x16x32_bf16 v[12:15], v[84:87], a[20:23], v[12:15]
    ds_read_b128 v[32:35], v19 offset:3072
    ds_read_b128 v[36:39], v19 offset:1024
    v_cvt_pk_bf16_f32 v88, v176, v177
    v_cvt_pk_bf16_f32 v89, v178, v179
    s_waitcnt lgkmcnt(6)
    v_pk_fma_f32 v[180:181], v[180:181], v[40:41], v[44:45]
    v_pk_fma_f32 v[182:183], v[182:183], v[42:43], v[46:47]
    ds_read_b128 v[40:43], v19 offset:3088
    ds_read_b128 v[44:47], v19 offset:1040
    v_cvt_pk_bf16_f32 v90, v180, v181
    v_cvt_pk_bf16_f32 v91, v182, v183
    s_waitcnt lgkmcnt(6)
    v_pk_fma_f32 v[184:185], v[184:185], v[48:49], v[52:53]
    v_pk_fma_f32 v[186:187], v[186:187], v[50:51], v[54:55]
    v_mfma_f32_16x16x32_bf16 v[12:15], v[88:91], a[24:27], v[12:15]
    ds_read_b128 v[48:51], v19 offset:3200
    ds_read_b128 v[52:55], v19 offset:1152
    v_cvt_pk_bf16_f32 v92, v184, v185
    v_cvt_pk_bf16_f32 v93, v186, v187
    s_waitcnt lgkmcnt(6)
    v_pk_fma_f32 v[188:189], v[188:189], v[56:57], v[60:61]
    v_pk_fma_f32 v[190:191], v[190:191], v[58:59], v[62:63]
    ds_read_b128 v[56:59], v19 offset:3216
    ds_read_b128 v[60:63], v19 offset:1168
    v_cvt_pk_bf16_f32 v94, v188, v189
    v_cvt_pk_bf16_f32 v95, v190, v191
    s_waitcnt lgkmcnt(6)
    v_pk_fma_f32 v[192:193], v[192:193], v[32:33], v[36:37]
    v_pk_fma_f32 v[194:195], v[194:195], v[34:35], v[38:39]
    v_mfma_f32_16x16x32_bf16 v[12:15], v[92:95], a[28:31], v[12:15]
    ds_read_b128 v[32:35], v19 offset:3328
    ds_read_b128 v[36:39], v19 offset:1280
    v_cvt_pk_bf16_f32 v96, v192, v193
    v_cvt_pk_bf16_f32 v97, v194, v195
    s_waitcnt lgkmcnt(6)
    v_pk_fma_f32 v[196:197], v[196:197], v[40:41], v[44:45]
    v_pk_fma_f32 v[198:199], v[198:199], v[42:43], v[46:47]
    ds_read_b128 v[40:43], v19 offset:3344
    ds_read_b128 v[44:47], v19 offset:1296
    v_cvt_pk_bf16_f32 v98, v196, v197
    v_cvt_pk_bf16_f32 v99, v198, v199
    s_waitcnt lgkmcnt(6)
    v_pk_fma_f32 v[200:201], v[200:201], v[48:49], v[52:53]
    v_pk_fma_f32 v[202:203], v[202:203], v[50:51], v[54:55]
    v_mfma_f32_16x16x32_bf16 v[12:15], v[96:99], a[32:35], v[12:15]
    ds_read_b128 v[48:51], v19 offset:3456
    ds_read_b128 v[52:55], v19 offset:1408
    v_cvt_pk_bf16_f32 v100, v200, v201
    v_cvt_pk_bf16_f32 v101, v202, v203
    s_waitcnt lgkmcnt(6)
    v_pk_fma_f32 v[204:205], v[204:205], v[56:57], v[60:61]
    v_pk_fma_f32 v[206:207], v[206:207], v[58:59], v[62:63]
    ds_read_b128 v[56:59], v19 offset:3472
    ds_read_b128 v[60:63], v19 offset:1424
    v_cvt_pk_bf16_f32 v102, v204, v205
    v_cvt_pk_bf16_f32 v103, v206, v207
    s_waitcnt lgkmcnt(6)
    v_pk_fma_f32 v[208:209], v[208:209], v[32:33], v[36:37]
    v_pk_fma_f32 v[210:211], v[210:211], v[34:35], v[38:39]
    v_mfma_f32_16x16x32_bf16 v[12:15], v[100:103], a[36:39], v[12:15]
    ds_read_b128 v[32:35], v19 offset:3584
    ds_read_b128 v[36:39], v19 offset:1536
    v_cvt_pk_bf16_f32 v104, v208, v209
    v_cvt_pk_bf16_f32 v105, v210, v211
    s_waitcnt lgkmcnt(6)
    v_pk_fma_f32 v[212:213], v[212:213], v[40:41], v[44:45]
    v_pk_fma_f32 v[214:215], v[214:215], v[42:43], v[46:47]
    ds_read_b128 v[40:43], v19 offset:3600
    ds_read_b128 v[44:47], v19 offset:1552
    v_cvt_pk_bf16_f32 v106, v212, v213
    v_cvt_pk_bf16_f32 v107, v214, v215
    s_waitcnt lgkmcnt(6)
    v_pk_fma_f32 v[216:217], v[216:217], v[48:49], v[52:53]
    v_pk_fma_f32 v[218:219], v[218:219], v[50:51], v[54:55]
    v_mfma_f32_16x16x32_bf16 v[12:15], v[104:107], a[40:43], v[12:15]
    ds_read_b128 v[48:51], v19 offset:3712
    ds_read_b128 v[52:55], v19 offset:1664
    v_cvt_pk_bf16_f32 v108, v216, v217
    v_cvt_pk_bf16_f32 v109, v218, v219
    s_waitcnt lgkmcnt(6)
    v_pk_fma_f32 v[220:221], v[220:221], v[56:57], v[60:61]
    v_pk_fma_f32 v[222:223], v[222:223], v[58:59], v[62:63]
    ds_read_b128 v[56:59], v19 offset:3728
    ds_read_b128 v[60:63], v19 offset:1680
    v_cvt_pk_bf16_f32 v110, v220, v221
    v_cvt_pk_bf16_f32 v111, v222, v223
    s_waitcnt lgkmcnt(6)
    v_pk_fma_f32 v[224:225], v[224:225], v[32:33], v[36:37]
    v_pk_fma_f32 v[226:227], v[226:227], v[34:35], v[38:39]
    v_mfma_f32_16x16x32_bf16 v[12:15], v[108:111], a[44:47], v[12:15]
    ds_read_b128 v[32:35], v19 offset:3840
    ds_read_b128 v[36:39], v19 offset:1792
    v_cvt_pk_bf16_f32 v112, v224, v225
    v_cvt_pk_bf16_f32 v113, v226, v227
    s_waitcnt lgkmcnt(6)
    v_pk_fma_f32 v[228:229], v[228:229], v[40:41], v[44:45]
    v_pk_fma_f32 v[230:231], v[230:231], v[42:43], v[46:47]
    ds_read_b128 v[40:43], v19 offset:3856
    ds_read_b128 v[44:47], v19 offset:1808
    v_cvt_pk_bf16_f32 v114, v228, v229
    v_cvt_pk_bf16_f32 v115, v230, v231
    s_waitcnt lgkmcnt(6)
    v_pk_fma_f32 v[232:233], v[232:233], v[48:49], v[52:53]
    v_pk_fma_f32 v[234:235], v[234:235], v[50:51], v[54:55]
    v_mfma_f32_16x16x32_bf16 v[12:15], v[112:115], a[48:51], v[12:15]
    ds_read_b128 v[48:51], v19 offset:3968
    ds_read_b128 v[52:55], v19 offset:1920
    v_cvt_pk_bf16_f32 v116, v232, v233
    v_cvt_pk_bf16_f32 v117, v234, v235
    s_waitcnt lgkmcnt(6)
    v_pk_fma_f32 v[236:237], v[236:237], v[56:57], v[60:61]
    v_pk_fma_f32 v[238:239], v[238:239], v[58:59], v[62:63]
    ds_read_b128 v[56:59], v19 offset:3984
    ds_read_b128 v[60:63], v19 offset:1936
    v_cvt_pk_bf16_f32 v118, v236, v237
    v_cvt_pk_bf16_f32 v119, v238, v239
    s_waitcnt lgkmcnt(6)
    v_pk_fma_f32 v[240:241], v[240:241], v[32:33], v[36:37]
    v_pk_fma_f32 v[242:243], v[242:243], v[34:35], v[38:39]
    v_mfma_f32_16x16x32_bf16 v[12:15], v[116:119], a[52:55], v[12:15]
    v_cvt_pk_bf16_f32 v120, v240, v241
    v_cvt_pk_bf16_f32 v121, v242, v243
    s_waitcnt lgkmcnt(4)
    v_pk_fma_f32 v[244:245], v[244:245], v[40:41], v[44:45]
    v_pk_fma_f32 v[246:247], v[246:247], v[42:43], v[46:47]
    v_cvt_pk_bf16_f32 v122, v244, v245
    v_cvt_pk_bf16_f32 v123, v246, v247
    s_waitcnt lgkmcnt(2)
    v_pk_fma_f32 v[248:249], v[248:249], v[48:49], v[52:53]
    v_pk_fma_f32 v[250:251], v[250:251], v[50:51], v[54:55]
    v_mfma_f32_16x16x32_bf16 v[12:15], v[120:123], a[56:59], v[12:15]
    v_cvt_pk_bf16_f32 v124, v248, v249
    v_cvt_pk_bf16_f32 v125, v250, v251
    s_waitcnt lgkmcnt(0)
    v_pk_fma_f32 v[252:253], v[252:253], v[56:57], v[60:61]
    v_pk_fma_f32 v[254:255], v[254:255], v[58:59], v[62:63]
    v_cvt_pk_bf16_f32 v126, v252, v253
    v_cvt_pk_bf16_f32 v127, v254, v255
    s_nop 1
    v_mfma_f32_16x16x32_bf16 v[12:15], v[124:127], a[60:63], v[12:15]
Lhdone_17:
    s_cmp_eq_u32 s0, 0
    s_cbranch_scc0 Lnokv_18
    s_lshl_b32 s23, s46, 1
    s_lshr_b32 s3, s48, 1
    s_add_u32 s23, s23, s3
    s_mul_i32 s23, s23, 2112
    s_add_u32 s23, s23, 262144
    s_and_b32 s27, s48, 1
    v_lshrrev_b32 v20, 5, v0
    v_cvt_pk_bf16_f32 v36, v12, v13
    v_cvt_pk_bf16_f32 v37, v14, v15
    v_mov_b32 v38, v36
    v_mov_b32 v39, v37
    s_nop 0
    v_permlane16_swap_b32 v36, v38
    v_permlane16_swap_b32 v37, v39
    s_bitcmp1_b32 s47, 0
    s_cbranch_scc1 LisV2_19
    v_lshlrev_b32 v20, 9, v20
    v_lshl_add_u32 v20, v1, 4, v20
    s_lshl_b32 s27, s27, 8
    s_add_u32 s23, s23, s27
    s_add_u32 s23, s23, 1088
    s_mov_b32 exec_lo, 0x0000ffff
    s_mov_b32 exec_hi, 0x0000ffff
    s_branch Lkvst_20
LisV2_19:
    v_mul_u32_u24 v20, 272, v20
    v_and_b32 v4, 31, v0
    v_lshl_add_u32 v20, v4, 4, v20
    s_mul_i32 s27, s27, 544
    s_add_u32 s23, s23, s27
    s_mov_b32 exec_lo, 0xffff0000
    s_mov_b32 exec_hi, 0xffff0000
    v_mov_b32 v36, 0x3f803f80
    v_mov_b32 v37, 0x3f803f80
    v_mov_b32 v38, 0x3f803f80
    v_mov_b32 v39, 0x3f803f80
    s_mov_b32 exec_lo, 0x0001ffff
    s_mov_b32 exec_hi, 0x0001ffff
Lkvst_20:
    buffer_store_dwordx4 v[36:39], v20, s[8:11], s23 offen sc1
    s_mov_b64 exec, 1
    s_add_u32 s3, s49, 1
    v_mov_b32 v20, s3
    s_lshl_b32 s23, s47, 7
    s_add_u32 s23, s23, s67
    s_waitcnt vmcnt(0)
    buffer_store_dword v20, v0, s[8:11], s23 offen sc1
    s_mov_b64 exec, -1
Lnokv_18:
    v_lshrrev_b32 v4, 2, v1
    v_bfe_u32 v5, v1, 3, 1
    v_and_b32 v7, 1, v2
    v_lshl_or_b32 v5, v7, 1, v5
    v_lshl_add_u32 v4, v2, 3, v4
    v_and_b32 v6, 3, v1
    v_lshlrev_b32 v6, 3, v6
    v_lshl_add_u32 v6, v4, 7, v6
    v_lshl_add_u32 v6, v5, 5, v6
    v_add_u32 v24, 28672, v6
    v_xor_b32 v25, 32, v24
    v_xor_b32 v26, 64, v24
    v_xor_b32 v27, 96, v24
    s_barrier
    ds_read_b64_tr_b16 v[32:33], v24 offset:0
    ds_read_b64_tr_b16 v[34:35], v24 offset:512
    ds_read_b64_tr_b16 v[36:37], v25 offset:0
    ds_read_b64_tr_b16 v[38:39], v25 offset:512
    ds_read_b64_tr_b16 v[40:41], v26 offset:0
    ds_read_b64_tr_b16 v[42:43], v26 offset:512
    ds_read_b64_tr_b16 v[44:45], v27 offset:0
    ds_read_b64_tr_b16 v[46:47], v27 offset:512
    ds_read_b64_tr_b16 v[48:49], v24 offset:4096
    ds_read_b64_tr_b16 v[50:51], v24 offset:4608
    ds_read_b64_tr_b16 v[52:53], v25 offset:4096
    ds_read_b64_tr_b16 v[54:55], v25 offset:4608
    ds_read_b64_tr_b16 v[56:57], v26 offset:4096
    ds_read_b64_tr_b16 v[58:59], v26 offset:4608
    ds_read_b64_tr_b16 v[60:61], v27 offset:4096
    ds_read_b64_tr_b16 v[62:63], v27 offset:4608
    s_waitcnt lgkmcnt(8)
    v_mfma_f32_16x16x32_bf16 v[128:131], v[32:35], v[64:67], 0
    ds_read_b64_tr_b16 v[144:145], v24 offset:8192
    ds_read_b64_tr_b16 v[146:147], v24 offset:8704
    v_mfma_f32_16x16x32_bf16 v[132:135], v[36:39], v[64:67], 0
    ds_read_b64_tr_b16 v[148:149], v25 offset:8192
    ds_read_b64_tr_b16 v[150:151], v25 offset:8704
    v_mfma_f32_16x16x32_bf16 v[136:139], v[40:43], v[64:67], 0
    ds_read_b64_tr_b16 v[152:153], v26 offset:8192
    ds_read_b64_tr_b16 v[154:155], v26 offset:8704
    v_mfma_f32_16x16x32_bf16 v[140:143], v[44:47], v[64:67], 0
    ds_read_b64_tr_b16 v[156:157], v27 offset:8192
    ds_read_b64_tr_b16 v[158:159], v27 offset:8704
    s_waitcnt lgkmcnt(8)
    v_mfma_f32_16x16x32_bf16 v[128:131], v[48:51], v[68:71], v[128:131]
    ds_read_b64_tr_b16 v[32:33], v24 offset:12288
    ds_read_b64_tr_b16 v[34:35], v24 offset:12800
    v_mfma_f32_16x16x32_bf16 v[132:135], v[52:55], v[68:71], v[132:135]
    ds_read_b64_tr_b16 v[36:37], v25 offset:12288
    ds_read_b64_tr_b16 v[38:39], v25 offset:12800
    v_mfma_f32_16x16x32_bf16 v[136:139], v[56:59], v[68:71], v[136:139]
    ds_read_b64_tr_b16 v[40:41], v26 offset:12288
    ds_read_b64_tr_b16 v[42:43], v26 offset:12800
    v_mfma_f32_16x16x32_bf16 v[140:143], v[60:63], v[68:71], v[140:143]
    ds_read_b64_tr_b16 v[44:45], v27 offset:12288
    ds_read_b64_tr_b16 v[46:47], v27 offset:12800
    s_waitcnt lgkmcnt(8)
    v_mfma_f32_16x16x32_bf16 v[128:131], v[144:147], v[72:75], v[128:131]
    ds_read_b64_tr_b16 v[48:49], v24 offset:16384
    ds_read_b64_tr_b16 v[50:51], v24 offset:16896
    v_mfma_f32_16x16x32_bf16 v[132:135], v[148:151], v[72:75], v[132:135]
    ds_read_b64_tr_b16 v[52:53], v25 offset:16384
    ds_read_b64_tr_b16 v[54:55], v25 offset:16896
    v_mfma_f32_16x16x32_bf16 v[136:139], v[152:155], v[72:75], v[136:139]
    ds_read_b64_tr_b16 v[56:57], v26 offset:16384
    ds_read_b64_tr_b16 v[58:59], v26 offset:16896
    v_mfma_f32_16x16x32_bf16 v[140:143], v[156:159], v[72:75], v[140:143]
    ds_read_b64_tr_b16 v[60:61], v27 offset:16384
    ds_read_b64_tr_b16 v[62:63], v27 offset:16896
    s_waitcnt lgkmcnt(8)
    v_mfma_f32_16x16x32_bf16 v[128:131], v[32:35], v[76:79], v[128:131]
    ds_read_b64_tr_b16 v[144:145], v24 offset:20480
    ds_read_b64_tr_b16 v[146:147], v24 offset:20992
    v_mfma_f32_16x16x32_bf16 v[132:135], v[36:39], v[76:79], v[132:135]
    ds_read_b64_tr_b16 v[148:149], v25 offset:20480
    ds_read_b64_tr_b16 v[150:151], v25 offset:20992
    v_mfma_f32_16x16x32_bf16 v[136:139], v[40:43], v[76:79], v[136:139]
    ds_read_b64_tr_b16 v[152:153], v26 offset:20480
    ds_read_b64_tr_b16 v[154:155], v26 offset:20992
    v_mfma_f32_16x16x32_bf16 v[140:143], v[44:47], v[76:79], v[140:143]
    ds_read_b64_tr_b16 v[156:157], v27 offset:20480
    ds_read_b64_tr_b16 v[158:159], v27 offset:20992
    s_waitcnt lgkmcnt(8)
    v_mfma_f32_16x16x32_bf16 v[128:131], v[48:51], v[80:83], v[128:131]
    ds_read_b64_tr_b16 v[32:33], v24 offset:24576
    ds_read_b64_tr_b16 v[34:35], v24 offset:25088
    v_mfma_f32_16x16x32_bf16 v[132:135], v[52:55], v[80:83], v[132:135]
    ds_read_b64_tr_b16 v[36:37], v25 offset:24576
    ds_read_b64_tr_b16 v[38:39], v25 offset:25088
    v_mfma_f32_16x16x32_bf16 v[136:139], v[56:59], v[80:83], v[136:139]
    ds_read_b64_tr_b16 v[40:41], v26 offset:24576
    ds_read_b64_tr_b16 v[42:43], v26 offset:25088
    v_mfma_f32_16x16x32_bf16 v[140:143], v[60:63], v[80:83], v[140:143]
    ds_read_b64_tr_b16 v[44:45], v27 offset:24576
    ds_read_b64_tr_b16 v[46:47], v27 offset:25088
    s_waitcnt lgkmcnt(8)
    v_mfma_f32_16x16x32_bf16 v[128:131], v[144:147], v[84:87], v[128:131]
    ds_read_b64_tr_b16 v[48:49], v24 offset:28672
    ds_read_b64_tr_b16 v[50:51], v24 offset:29184
    v_mfma_f32_16x16x32_bf16 v[132:135], v[148:151], v[84:87], v[132:135]
    ds_read_b64_tr_b16 v[52:53], v25 offset:28672
    ds_read_b64_tr_b16 v[54:55], v25 offset:29184
    v_mfma_f32_16x16x32_bf16 v[136:139], v[152:155], v[84:87], v[136:139]
    ds_read_b64_tr_b16 v[56:57], v26 offset:28672
    ds_read_b64_tr_b16 v[58:59], v26 offset:29184
    v_mfma_f32_16x16x32_bf16 v[140:143], v[156:159], v[84:87], v[140:143]
    ds_read_b64_tr_b16 v[60:61], v27 offset:28672
    ds_read_b64_tr_b16 v[62:63], v27 offset:29184
    s_waitcnt lgkmcnt(8)
    v_mfma_f32_16x16x32_bf16 v[128:131], v[32:35], v[88:91], v[128:131]
    ds_read_b64_tr_b16 v[144:145], v24 offset:32768
    ds_read_b64_tr_b16 v[146:147], v24 offset:33280
    v_mfma_f32_16x16x32_bf16 v[132:135], v[36:39], v[88:91], v[132:135]
    ds_read_b64_tr_b16 v[148:149], v25 offset:32768
    ds_read_b64_tr_b16 v[150:151], v25 offset:33280
    v_mfma_f32_16x16x32_bf16 v[136:139], v[40:43], v[88:91], v[136:139]
    ds_read_b64_tr_b16 v[152:153], v26 offset:32768
    ds_read_b64_tr_b16 v[154:155], v26 offset:33280
    v_mfma_f32_16x16x32_bf16 v[140:143], v[44:47], v[88:91], v[140:143]
    ds_read_b64_tr_b16 v[156:157], v27 offset:32768
    ds_read_b64_tr_b16 v[158:159], v27 offset:33280
    s_waitcnt lgkmcnt(8)
    v_mfma_f32_16x16x32_bf16 v[128:131], v[48:51], v[92:95], v[128:131]
    ds_read_b64_tr_b16 v[32:33], v24 offset:36864
    ds_read_b64_tr_b16 v[34:35], v24 offset:37376
    v_mfma_f32_16x16x32_bf16 v[132:135], v[52:55], v[92:95], v[132:135]
    ds_read_b64_tr_b16 v[36:37], v25 offset:36864
    ds_read_b64_tr_b16 v[38:39], v25 offset:37376
    v_mfma_f32_16x16x32_bf16 v[136:139], v[56:59], v[92:95], v[136:139]
    ds_read_b64_tr_b16 v[40:41], v26 offset:36864
    ds_read_b64_tr_b16 v[42:43], v26 offset:37376
    v_mfma_f32_16x16x32_bf16 v[140:143], v[60:63], v[92:95], v[140:143]
    ds_read_b64_tr_b16 v[44:45], v27 offset:36864
    ds_read_b64_tr_b16 v[46:47], v27 offset:37376
    s_waitcnt lgkmcnt(8)
    v_mfma_f32_16x16x32_bf16 v[128:131], v[144:147], v[96:99], v[128:131]
    ds_read_b64_tr_b16 v[48:49], v24 offset:40960
    ds_read_b64_tr_b16 v[50:51], v24 offset:41472
    v_mfma_f32_16x16x32_bf16 v[132:135], v[148:151], v[96:99], v[132:135]
    ds_read_b64_tr_b16 v[52:53], v25 offset:40960
    ds_read_b64_tr_b16 v[54:55], v25 offset:41472
    v_mfma_f32_16x16x32_bf16 v[136:139], v[152:155], v[96:99], v[136:139]
    ds_read_b64_tr_b16 v[56:57], v26 offset:40960
    ds_read_b64_tr_b16 v[58:59], v26 offset:41472
    v_mfma_f32_16x16x32_bf16 v[140:143], v[156:159], v[96:99], v[140:143]
    ds_read_b64_tr_b16 v[60:61], v27 offset:40960
    ds_read_b64_tr_b16 v[62:63], v27 offset:41472
    s_waitcnt lgkmcnt(8)
    v_mfma_f32_16x16x32_bf16 v[128:131], v[32:35], v[100:103], v[128:131]
    ds_read_b64_tr_b16 v[144:145], v24 offset:45056
    ds_read_b64_tr_b16 v[146:147], v24 offset:45568
    v_mfma_f32_16x16x32_bf16 v[132:135], v[36:39], v[100:103], v[132:135]
    ds_read_b64_tr_b16 v[148:149], v25 offset:45056
    ds_read_b64_tr_b16 v[150:151], v25 offset:45568
    v_mfma_f32_16x16x32_bf16 v[136:139], v[40:43], v[100:103], v[136:139]
    ds_read_b64_tr_b16 v[152:153], v26 offset:45056
    ds_read_b64_tr_b16 v[154:155], v26 offset:45568
    v_mfma_f32_16x16x32_bf16 v[140:143], v[44:47], v[100:103], v[140:143]
    ds_read_b64_tr_b16 v[156:157], v27 offset:45056
    ds_read_b64_tr_b16 v[158:159], v27 offset:45568
    s_waitcnt lgkmcnt(8)
    v_mfma_f32_16x16x32_bf16 v[128:131], v[48:51], v[104:107], v[128:131]
    ds_read_b64_tr_b16 v[32:33], v24 offset:49152
    ds_read_b64_tr_b16 v[34:35], v24 offset:49664
    v_mfma_f32_16x16x32_bf16 v[132:135], v[52:55], v[104:107], v[132:135]
    ds_read_b64_tr_b16 v[36:37], v25 offset:49152
    ds_read_b64_tr_b16 v[38:39], v25 offset:49664
    v_mfma_f32_16x16x32_bf16 v[136:139], v[56:59], v[104:107], v[136:139]
    ds_read_b64_tr_b16 v[40:41], v26 offset:49152
    ds_read_b64_tr_b16 v[42:43], v26 offset:49664
    v_mfma_f32_16x16x32_bf16 v[140:143], v[60:63], v[104:107], v[140:143]
    ds_read_b64_tr_b16 v[44:45], v27 offset:49152
    ds_read_b64_tr_b16 v[46:47], v27 offset:49664
    s_waitcnt lgkmcnt(8)
    v_mfma_f32_16x16x32_bf16 v[128:131], v[144:147], v[108:111], v[128:131]
    ds_read_b64_tr_b16 v[48:49], v24 offset:53248
    ds_read_b64_tr_b16 v[50:51], v24 offset:53760
    v_mfma_f32_16x16x32_bf16 v[132:135], v[148:151], v[108:111], v[132:135]
    ds_read_b64_tr_b16 v[52:53], v25 offset:53248
    ds_read_b64_tr_b16 v[54:55], v25 offset:53760
    v_mfma_f32_16x16x32_bf16 v[136:139], v[152:155], v[108:111], v[136:139]
    ds_read_b64_tr_b16 v[56:57], v26 offset:53248
    ds_read_b64_tr_b16 v[58:59], v26 offset:53760
    v_mfma_f32_16x16x32_bf16 v[140:143], v[156:159], v[108:111], v[140:143]
    ds_read_b64_tr_b16 v[60:61], v27 offset:53248
    ds_read_b64_tr_b16 v[62:63], v27 offset:53760
    s_waitcnt lgkmcnt(8)
    v_mfma_f32_16x16x32_bf16 v[128:131], v[32:35], v[112:115], v[128:131]
    ds_read_b64_tr_b16 v[144:145], v24 offset:57344
    ds_read_b64_tr_b16 v[146:147], v24 offset:57856
    v_mfma_f32_16x16x32_bf16 v[132:135], v[36:39], v[112:115], v[132:135]
    ds_read_b64_tr_b16 v[148:149], v25 offset:57344
    ds_read_b64_tr_b16 v[150:151], v25 offset:57856
    v_mfma_f32_16x16x32_bf16 v[136:139], v[40:43], v[112:115], v[136:139]
    ds_read_b64_tr_b16 v[152:153], v26 offset:57344
    ds_read_b64_tr_b16 v[154:155], v26 offset:57856
    v_mfma_f32_16x16x32_bf16 v[140:143], v[44:47], v[112:115], v[140:143]
    ds_read_b64_tr_b16 v[156:157], v27 offset:57344
    ds_read_b64_tr_b16 v[158:159], v27 offset:57856
    s_waitcnt lgkmcnt(8)
    v_mfma_f32_16x16x32_bf16 v[128:131], v[48:51], v[116:119], v[128:131]
    ds_read_b64_tr_b16 v[32:33], v24 offset:61440
    ds_read_b64_tr_b16 v[34:35], v24 offset:61952
    v_mfma_f32_16x16x32_bf16 v[132:135], v[52:55], v[116:119], v[132:135]
    ds_read_b64_tr_b16 v[36:37], v25 offset:61440
    ds_read_b64_tr_b16 v[38:39], v25 offset:61952
    v_mfma_f32_16x16x32_bf16 v[136:139], v[56:59], v[116:119], v[136:139]
    ds_read_b64_tr_b16 v[40:41], v26 offset:61440
    ds_read_b64_tr_b16 v[42:43], v26 offset:61952
    v_mfma_f32_16x16x32_bf16 v[140:143], v[60:63], v[116:119], v[140:143]
    ds_read_b64_tr_b16 v[44:45], v27 offset:61440
    ds_read_b64_tr_b16 v[46:47], v27 offset:61952
    s_waitcnt lgkmcnt(8)
    v_mfma_f32_16x16x32_bf16 v[128:131], v[144:147], v[120:123], v[128:131]
    v_mfma_f32_16x16x32_bf16 v[132:135], v[148:151], v[120:123], v[132:135]
    v_mfma_f32_16x16x32_bf16 v[136:139], v[152:155], v[120:123], v[136:139]
    v_mfma_f32_16x16x32_bf16 v[140:143], v[156:159], v[120:123], v[140:143]
    s_waitcnt lgkmcnt(0)
    v_mfma_f32_16x16x32_bf16 v[128:131], v[32:35], v[124:127], v[128:131]
    v_mfma_f32_16x16x32_bf16 v[132:135], v[36:39], v[124:127], v[132:135]
    v_mfma_f32_16x16x32_bf16 v[136:139], v[40:43], v[124:127], v[136:139]
    v_mfma_f32_16x16x32_bf16 v[140:143], v[44:47], v[124:127], v[140:143]
    s_nop 4
    v_mul_f32 v128, 0x3eb8aa3b, v128
    v_mul_f32 v129, 0x3eb8aa3b, v129
    v_mul_f32 v130, 0x3eb8aa3b, v130
    v_mul_f32 v131, 0x3eb8aa3b, v131
    v_mul_f32 v132, 0x3eb8aa3b, v132
    v_mul_f32 v133, 0x3eb8aa3b, v133
    v_mul_f32 v134, 0x3eb8aa3b, v134
    v_mul_f32 v135, 0x3eb8aa3b, v135
    v_mul_f32 v136, 0x3eb8aa3b, v136
    v_mul_f32 v137, 0x3eb8aa3b, v137
    v_mul_f32 v138, 0x3eb8aa3b, v138
    v_mul_f32 v139, 0x3eb8aa3b, v139
    v_mul_f32 v140, 0x3eb8aa3b, v140
    v_mul_f32 v141, 0x3eb8aa3b, v141
    v_mul_f32 v142, 0x3eb8aa3b, v142
    v_mul_f32 v143, 0x3eb8aa3b, v143
    v_cvt_pk_bf16_f32 v16, v128, v129
    v_cvt_pk_bf16_f32 v17, v130, v131
    v_cvt_pk_bf16_f32 v18, v132, v133
    v_cvt_pk_bf16_f32 v19, v134, v135
    v_cvt_pk_bf16_f32 v20, v136, v137
    v_cvt_pk_bf16_f32 v21, v138, v139
    v_cvt_pk_bf16_f32 v22, v140, v141
    v_cvt_pk_bf16_f32 v23, v142, v143
    v_permlane16_swap_b32 v16, v18
    v_permlane16_swap_b32 v17, v19
    v_permlane16_swap_b32 v20, v22
    v_permlane16_swap_b32 v21, v23
    v_add_u32 v24, 29760, v3
    v_add_u32 v25, 65472, v24
    v_add_u32 v26, 65472, v25
    v_lshrrev_b32 v4, 5, v0
    v_mul_u32_u24 v4, 272, v4
    v_and_b32 v5, 31, v0
    v_lshl_add_u32 v4, v5, 4, v4
    v_add_u32 v27, 28672, v4
    v_mov_b32 v4, 0x40000
    v_cmp_lt_u32 vcc, 16, v5
    v_mov_b32 v31, 2147418112
    v_mov_b32 v30, 0xdddd
    v_cndmask_b32 v27, v27, v4, vcc
    v_add_u32 v28, 65472, v27
    v_add_u32 v29, 65472, v28
    v_lshrrev_b32 v7, 3, v0
    v_and_b32 v6, 7, v0
    v_xor_b32 v5, v6, v2
    v_lshlrev_b32 v5, 4, v5
    v_lshl_add_u32 v168, v7, 12, v5
    v_xor_b32 v169, 64, v168
    v_add_u32 v169, 31744, v169
    v_lshrrev_b32 v4, 1, v1
    v_xor_b32 v4, v4, v2
    v_lshlrev_b32 v4, 4, v4
    v_lshl_add_u32 v4, v1, 7, v4
    v_add_u32 v170, s77, v4
    v_xor_b32 v171, 64, v170
    v_lshlrev_b32 v4, 10, v1
    v_lshl_add_u32 v172, v2, 3, v4
    v_lshrrev_b32 v4, 2, v0
    v_lshlrev_b32 v4, 12, v4
    v_and_b32 v5, 3, v0
    v_lshl_add_u32 v4, v5, 7, v4
    v_cmp_gt_u32 vcc, 32, v0
    v_lshlrev_b32 v5, 7, v6
    v_lshl_add_u32 v5, v7, 12, v5
    v_cndmask_b32 v173, v5, v5, vcc
    v_lshlrev_b32 v6, 4, v6
    v_mad_u32_u24 v176, v7, s74, v6
    v_lshrrev_b32 v4, 2, v1
    v_and_b32 v5, 1, v2
    v_mad_u32_u24 v4, v5, s75, v4
    v_lshrrev_b32 v5, 1, v2
    v_mad_u32_u24 v4, v5, s76, v4
    v_and_b32 v5, 3, v1
    v_lshlrev_b32 v5, 3, v5
    v_lshl_add_u32 v4, v4, 7, v5
    v_add_u32 v177, s68, v4
    v_add_u32 v178, s1, v177
    v_lshlrev_b32 v4, 7, v0
    v_cmp_gt_u32 vcc, 32, v0
    v_cmp_gt_u32 s[74:75], 33, v0
    v_mov_b32 v199, 1
    v_lshlrev_b32 v218, 4, v2
    v_cndmask_b32 v196, v31, v4, vcc
    v_cndmask_b32 v197, v31, v4, s[74:75]
    v_cmp_gt_u32 vcc, 14, v0
    v_cmp_gt_u32 s[74:75], 4, v0
    s_nop 0
    v_cndmask_b32 v175, v31, v4, vcc
    v_cndmask_b32 v174, v31, v4, s[74:75]
    v_cmp_eq_u32 vcc, 0, v0
    v_and_b32 v7, 1, v0
    v_lshlrev_b32 v5, 4, v7
    v_cndmask_b32 v198, v31, v4, vcc
    v_lshrrev_b32 v4, 2, v0
    v_mul_u32_u24 v4, 6144, v4
    v_and_b32 v5, 3, v0
    v_lshl_add_u32 v212, v5, 4, v4
    v_lshrrev_b32 v4, 2, v1
    v_lshl_add_u32 v4, v2, 3, v4
    v_lshlrev_b32 v4, 6, v4
    v_lshl_add_u32 v4, v5, 3, v4
    v_add_u32 v213, s35, v4
    v_cvt_f32_u32 v219, v7
    v_sub_f32 v219, 1.0, v219
    v_lshlrev_b32 v4, 2, v0
    v_cmp_gt_u32 vcc, 32, v0
    s_cmp_eq_u32 s48, 0
    s_cselect_b32 s3, 64, 48
    v_cmp_gt_u32 s[74:75], s3, v0
    v_lshlrev_b32 v5, 11, v7
    v_cndmask_b32 v214, v31, v4, vcc
    v_cndmask_b32 v215, v31, v4, s[74:75]
    v_sub_u32 v4, 2048, v5
    v_add_u32 v4, v218, v4
    v_and_b32 v5, 2, v0
    v_cmp_eq_u32 vcc, 0, v5
    v_mul_u32_u24 v5, 131072, v7
    s_nop 0
    v_cndmask_b32 v216, v31, v4, vcc
    v_lshlrev_b32 v4, 7, v1
    v_lshl_add_u32 v4, v2, 14, v4
    v_cmp_gt_u32 vcc, 32, v0
    v_cmp_gt_u32 s[74:75], 2, v0
    v_mov_b64 v[80:81], 0
    v_mov_b64 v[82:83], 0
    v_cndmask_b32 v202, v31, v4, vcc
    v_cndmask_b32 v217, v31, v5, s[74:75]
    v_mov_b64 v[84:85], 0
    v_mov_b64 v[86:87], 0
    v_mov_b64 v[88:89], 0
    v_mov_b64 v[90:91], 0
    v_mov_b64 v[92:93], 0
    v_mov_b64 v[94:95], 0
    v_mov_b64 v[96:97], 0
    v_mov_b64 v[98:99], 0
    v_mov_b64 v[100:101], 0
    v_mov_b64 v[102:103], 0
    v_mov_b64 v[104:105], 0
    v_mov_b64 v[106:107], 0
    v_mov_b64 v[108:109], 0
    v_mov_b64 v[110:111], 0
    v_lshlrev_b32 v5, 7, v0
    s_lshl_b32 s23, s48, 13
    buffer_load_dword v4, v5, s[8:11], s23 offen sc1
    s_waitcnt vmcnt(0)
    v_cmp_eq_u32 vcc, 0, v4
    s_cbranch_vccz L_bok
    s_mov_b64 exec, -1
    s_mov_b32 s3, 0
Lpoll_22:
    s_add_u32 s3, s3, 1
    s_cmp_gt_u32 s3, 131072
    s_cbranch_scc1 Lpollx_23
    s_sleep 6
    buffer_load_dword v4, v5, s[8:11], s23 offen sc1
    s_waitcnt vmcnt(0)
    v_cmp_eq_u32 vcc, 0, v4
    s_cbranch_vccnz Lpoll_22
Lpollx_23:
    s_mov_b64 exec, -1
L_bok:
    s_waitcnt lgkmcnt(0)
    s_barrier
    s_or_b32 s3, s2, s48
    s_cbranch_scc1 Lnoep_24
    v_mov_b32 v4, s42
    s_mov_b32 s3, 253952
    buffer_store_dword v4, v198, s[8:11], s3 offen sc1
Lnoep_24:
    s_cmp_eq_u32 s48, 3
    s_cbranch_scc0 L_nkt
    buffer_load_dword v200, v197, s[8:11], s66 offen sc1
L_nkt:
    s_mov_b32 m0, s65
    s_nop 0
    buffer_load_dwordx4 v3, s[8:11], s64 offen sc1 lds
    buffer_load_dwordx4 v3, s[8:11], s64 offen offset:1024 sc1 lds
    s_add_u32 s64, s64, 8192
    s_add_u32 s65, s65, 8192
    s_mov_b32 m0, s65
    s_nop 0
    buffer_load_dwordx4 v3, s[8:11], s64 offen sc1 lds
    buffer_load_dwordx4 v3, s[8:11], s64 offen offset:1024 sc1 lds
    s_add_u32 s64, s64, 8192
    s_add_u32 s65, s65, 8192
    s_waitcnt vmcnt(2)
    s_barrier
    ds_read_b128 v[144:147], v24 offset:0
    ds_read_b128 v[148:151], v24 offset:2112
    s_waitcnt lgkmcnt(1)
    v_mfma_f32_32x32x16_bf16 v[32:47], v[144:147], v[16:19], 0
    v_mfma_f32_32x32x16_bf16 v[48:63], v[144:147], v[20:23], 0
    s_nop 10
    v_max_f32 v4, v32, v33
    v_max_f32 v5, v48, v49
    v_max3_f32 v4, v34, v35, v4
    v_max3_f32 v5, v50, v51, v5
    v_max3_f32 v4, v36, v37, v4
    v_max3_f32 v5, v52, v53, v5
    v_max3_f32 v4, v38, v39, v4
    v_max3_f32 v5, v54, v55, v5
    v_max3_f32 v4, v40, v41, v4
    v_max3_f32 v5, v56, v57, v5
    v_max3_f32 v4, v42, v43, v4
    v_max3_f32 v5, v58, v59, v5
    v_max3_f32 v4, v44, v45, v4
    v_max3_f32 v5, v60, v61, v5
    v_max3_f32 v4, v46, v47, v4
    v_max3_f32 v5, v62, v63, v5
    v_mov_b32 v6, v4
    v_mov_b32 v7, v5
    s_nop 0
    v_permlane32_swap_b32 v4, v6
    v_permlane32_swap_b32 v5, v7
    v_max_f32 v4, v4, v6
    v_max_f32 v5, v5, v7
    v_sub_f32 v112, 0, v4
    v_sub_f32 v113, 0, v4
    v_sub_f32 v128, 0, v5
    v_sub_f32 v129, 0, v5
    v_mov_b64 v[114:115], v[112:113]
    v_mov_b64 v[116:117], v[112:113]
    v_mov_b64 v[118:119], v[112:113]
    v_mov_b64 v[120:121], v[112:113]
    v_mov_b64 v[122:123], v[112:113]
    v_mov_b64 v[124:125], v[112:113]
    v_mov_b64 v[126:127], v[112:113]
    v_mov_b64 v[130:131], v[128:129]
    v_mov_b64 v[132:133], v[128:129]
    v_mov_b64 v[134:135], v[128:129]
    v_mov_b64 v[136:137], v[128:129]
    v_mov_b64 v[138:139], v[128:129]
    v_mov_b64 v[140:141], v[128:129]
    v_mov_b64 v[142:143], v[128:129]
    v_mfma_f32_32x32x16_bf16 v[32:47], v[144:147], v[16:19], v[112:127]
    s_nop 0
    v_mfma_f32_32x32x16_bf16 v[48:63], v[144:147], v[20:23], v[128:143]
    s_waitcnt lgkmcnt(0)
    s_nop 8
    v_exp_f32 v32, v32
    v_exp_f32 v33, v33
    v_exp_f32 v34, v34
    s_mov_b32 m0, s65
    ds_read_b128 v[152:155], v27 offset:0
    v_exp_f32 v35, v35
    v_exp_f32 v36, v36
    v_exp_f32 v37, v37
    v_exp_f32 v38, v38
    buffer_load_dwordx4 v3, s[8:11], s64 offen sc1 lds
    buffer_load_dwordx4 v3, s[8:11], s64 offen offset:1024 sc1 lds
    s_add_u32 s64, s64, 8192
    s_add_u32 s65, s65, 8192
    s_mov_b32 m0, s65
    ds_read_b128 v[156:159], v27 offset:544
    v_exp_f32 v39, v39
    v_exp_f32 v40, v40
    v_exp_f32 v41, v41
    v_exp_f32 v42, v42
    v_exp_f32 v43, v43
    v_exp_f32 v44, v44
    v_exp_f32 v45, v45
    v_exp_f32 v46, v46
    v_exp_f32 v47, v47
    v_mfma_f32_32x32x16_bf16 v[64:79], v[148:151], v[16:19], v[112:127]
    s_waitcnt lgkmcnt(0)
    v_exp_f32 v48, v48
    v_exp_f32 v49, v49
    v_exp_f32 v50, v50
    v_smfmac_f32_32x32x32_bf16 v[80:95], v[152:155], v[32:39], v30
    buffer_load_dwordx4 v3, s[8:11], s64 offen sc1 lds
    buffer_load_dwordx4 v3, s[8:11], s64 offen offset:1024 sc1 lds
    s_add_u32 s64, s64, 8192
    s_add_u32 s65, s65, 8192
    v_exp_f32 v51, v51
    v_exp_f32 v52, v52
    v_exp_f32 v53, v53
    v_exp_f32 v54, v54
    v_smfmac_f32_32x32x32_bf16 v[80:95], v[156:159], v[40:47], v30
    s_lshl_b32 s23, s46, 18
    s_lshl_b32 s19, s48, 10
    s_add_u32 s23, s23, s19
    ds_read_b128 v[144:147], v24 offset:4224
    v_exp_f32 v55, v55
    v_exp_f32 v56, v56
    v_exp_f32 v57, v57
    v_exp_f32 v58, v58
    v_exp_f32 v59, v59
    v_exp_f32 v60, v60
    v_exp_f32 v61, v61
    v_exp_f32 v62, v62
    v_exp_f32 v63, v63
    v_mfma_f32_32x32x16_bf16 v[32:47], v[148:151], v[20:23], v[128:143]
    s_waitcnt lgkmcnt(0)
    buffer_load_dword v253, v196, s[8:11], s67 offen sc1
    v_exp_f32 v64, v64
    v_exp_f32 v65, v65
    v_exp_f32 v66, v66
    v_smfmac_f32_32x32x32_bf16 v[96:111], v[152:155], v[48:55], v30
    s_mov_b32 m0, s65
    ds_read_b128 v[160:163], v27 offset:2112
    v_exp_f32 v67, v67
    v_exp_f32 v68, v68
    v_exp_f32 v69, v69
    v_exp_f32 v70, v70
    v_smfmac_f32_32x32x32_bf16 v[96:111], v[156:159], v[56:63], v30
    buffer_load_dwordx4 v3, s[8:11], s64 offen sc1 lds
    buffer_load_dwordx4 v3, s[8:11], s64 offen offset:1024 sc1 lds
    s_add_u32 s64, s64, 8192
    s_add_u32 s65, s65, 8192
    s_mov_b32 m0, s65
    ds_read_b128 v[164:167], v27 offset:2656
    v_exp_f32 v71, v71
    v_exp_f32 v72, v72
    v_exp_f32 v73, v73
    v_exp_f32 v74, v74
    v_exp_f32 v75, v75
    v_exp_f32 v76, v76
    v_exp_f32 v77, v77
    v_exp_f32 v78, v78
    v_exp_f32 v79, v79
    v_mfma_f32_32x32x16_bf16 v[48:63], v[144:147], v[16:19], v[112:127]
    s_waitcnt lgkmcnt(0)
    s_waitcnt vmcnt(7)
    s_barrier
    v_exp_f32 v32, v32
    v_exp_f32 v33, v33
    v_exp_f32 v34, v34
    v_smfmac_f32_32x32x32_bf16 v[80:95], v[160:163], v[64:71], v30
    buffer_load_dwordx4 v3, s[8:11], s64 offen sc1 lds
    buffer_load_dwordx4 v3, s[8:11], s64 offen offset:1024 sc1 lds
    s_add_u32 s64, s64, 8192
    s_add_u32 s65, s65, 8192
    v_exp_f32 v35, v35
    v_exp_f32 v36, v36
    v_exp_f32 v37, v37
    v_exp_f32 v38, v38
    v_smfmac_f32_32x32x32_bf16 v[80:95], v[164:167], v[72:79], v30
    s_add_u32 s4, s30, s23
    s_addc_u32 s5, s31, 0
    s_sub_u32 s6, 8388608, s23
    ds_read_b128 v[148:151], v24 offset:6336
    v_exp_f32 v39, v39
    v_exp_f32 v40, v40
    v_exp_f32 v41, v41
    v_exp_f32 v42, v42
    v_exp_f32 v43, v43
    v_exp_f32 v44, v44
    v_exp_f32 v45, v45
    v_exp_f32 v46, v46
    v_exp_f32 v47, v47
    v_mfma_f32_32x32x16_bf16 v[64:79], v[144:147], v[20:23], v[128:143]
    s_waitcnt lgkmcnt(0)
    v_exp_f32 v48, v48
    v_exp_f32 v49, v49
    v_exp_f32 v50, v50
    v_smfmac_f32_32x32x32_bf16 v[96:111], v[160:163], v[32:39], v30
    s_mov_b32 m0, s65
    ds_read_b128 v[152:155], v27 offset:4224
    v_exp_f32 v51, v51
    v_exp_f32 v52, v52
    v_exp_f32 v53, v53
    v_exp_f32 v54, v54
    v_smfmac_f32_32x32x32_bf16 v[96:111], v[164:167], v[40:47], v30
    buffer_load_dwordx4 v3, s[8:11], s64 offen sc1 lds
    buffer_load_dwordx4 v3, s[8:11], s64 offen offset:1024 sc1 lds
    s_add_u32 s64, s64, 8192
    s_add_u32 s65, s65, 8192
    s_mov_b32 m0, s65
    ds_read_b128 v[156:159], v27 offset:4768
    v_exp_f32 v55, v55
    v_exp_f32 v56, v56
    v_exp_f32 v57, v57
    v_exp_f32 v58, v58
    v_exp_f32 v59, v59
    v_exp_f32 v60, v60
    v_exp_f32 v61, v61
    v_exp_f32 v62, v62
    v_exp_f32 v63, v63
    v_mfma_f32_32x32x16_bf16 v[32:47], v[148:151], v[16:19], v[112:127]
    s_waitcnt lgkmcnt(0)
    v_exp_f32 v64, v64
    v_exp_f32 v65, v65
    v_exp_f32 v66, v66
    v_smfmac_f32_32x32x32_bf16 v[80:95], v[152:155], v[48:55], v30
    buffer_load_dwordx4 v3, s[8:11], s64 offen sc1 lds
    buffer_load_dwordx4 v3, s[8:11], s64 offen offset:1024 sc1 lds
    s_add_u32 s64, s64, 8192
    s_add_u32 s65, s65, 8192
    v_exp_f32 v67, v67
    v_exp_f32 v68, v68
    v_exp_f32 v69, v69
    v_exp_f32 v70, v70
    v_smfmac_f32_32x32x32_bf16 v[80:95], v[156:159], v[56:63], v30
    s_mov_b32 s7, 0x20000
    s_lshl_b32 s19, s47, 15
    s_lshl_b32 s30, s47, 7
    ds_read_b128 v[144:147], v24 offset:8448
    v_exp_f32 v71, v71
    v_exp_f32 v72, v72
    v_exp_f32 v73, v73
    v_exp_f32 v74, v74
    v_exp_f32 v75, v75
    v_exp_f32 v76, v76
    v_exp_f32 v77, v77
    v_exp_f32 v78, v78
    v_exp_f32 v79, v79
    v_mfma_f32_32x32x16_bf16 v[48:63], v[148:151], v[20:23], v[128:143]
    s_waitcnt lgkmcnt(0)
    buffer_load_dword v200, v198, s[8:11], s54 offen sc1
    v_exp_f32 v32, v32
    v_exp_f32 v33, v33
    v_exp_f32 v34, v34
    v_smfmac_f32_32x32x32_bf16 v[96:111], v[152:155], v[64:71], v30
    s_lshr_b32 s31, s55, 4
    s_add_u32 s31, s31, s30
    s_add_u32 s31, s31, 458752
    s_add_u32 m0, s68, 0
    ds_read_b128 v[160:163], v27 offset:6336
    v_exp_f32 v35, v35
    v_exp_f32 v36, v36
    v_exp_f32 v37, v37
    v_exp_f32 v38, v38
    v_smfmac_f32_32x32x32_bf16 v[96:111], v[156:159], v[72:79], v30
    buffer_load_dwordx4 v176, s[56:59], 0 offen lds
    s_add_u32 m0, s68, 1024
    ds_read_b128 v[164:167], v27 offset:6880
    v_exp_f32 v39, v39
    v_exp_f32 v40, v40
    v_exp_f32 v41, v41
    v_exp_f32 v42, v42
    v_exp_f32 v43, v43
    v_exp_f32 v44, v44
    v_exp_f32 v45, v45
    v_exp_f32 v46, v46
    v_exp_f32 v47, v47
    v_mfma_f32_32x32x16_bf16 v[64:79], v[144:147], v[16:19], v[112:127]
    s_waitcnt lgkmcnt(0)
    v_exp_f32 v48, v48
    v_exp_f32 v49, v49
    v_exp_f32 v50, v50
    v_smfmac_f32_32x32x32_bf16 v[80:95], v[160:163], v[32:39], v30
    buffer_load_dwordx4 v176, s[56:59], s20 offen lds
    v_exp_f32 v51, v51
    v_exp_f32 v52, v52
    v_exp_f32 v53, v53
    v_exp_f32 v54, v54
    v_smfmac_f32_32x32x32_bf16 v[80:95], v[164:167], v[40:47], v30
    s_add_u32 s23, s30, s55
    s_add_u32 s12, s16, s23
    s_addc_u32 s13, s17, 0
    ds_read_b128 v[148:151], v24 offset:10560
    v_exp_f32 v55, v55
    v_exp_f32 v56, v56
    v_exp_f32 v57, v57
    v_exp_f32 v58, v58
    v_exp_f32 v59, v59
    v_exp_f32 v60, v60
    v_exp_f32 v61, v61
    v_exp_f32 v62, v62
    v_exp_f32 v63, v63
    v_mfma_f32_32x32x16_bf16 v[32:47], v[144:147], v[20:23], v[128:143]
    s_waitcnt lgkmcnt(0)
    v_exp_f32 v64, v64
    v_exp_f32 v65, v65
    v_exp_f32 v66, v66
    v_smfmac_f32_32x32x32_bf16 v[96:111], v[160:163], v[48:55], v30
    s_sub_u32 s14, 2097152, s23
    s_mov_b32 s15, 0x20000
    s_lshr_b32 s34, s2, 4
    s_add_u32 m0, s68, 2048
    ds_read_b128 v[152:155], v27 offset:8448
    v_exp_f32 v67, v67
    v_exp_f32 v68, v68
    v_exp_f32 v69, v69
    v_exp_f32 v70, v70
    v_smfmac_f32_32x32x32_bf16 v[96:111], v[164:167], v[56:63], v30
    buffer_load_dwordx4 v176, s[56:59], s21 offen lds
    s_add_u32 m0, s68, 3072
    ds_read_b128 v[156:159], v27 offset:8992
    v_exp_f32 v71, v71
    v_exp_f32 v72, v72
    v_exp_f32 v73, v73
    v_exp_f32 v74, v74
    v_exp_f32 v75, v75
    v_exp_f32 v76, v76
    v_exp_f32 v77, v77
    v_exp_f32 v78, v78
    v_exp_f32 v79, v79
    v_mfma_f32_32x32x16_bf16 v[48:63], v[148:151], v[16:19], v[112:127]
    s_waitcnt lgkmcnt(0)
    v_exp_f32 v32, v32
    v_exp_f32 v33, v33
    v_exp_f32 v34, v34
    v_smfmac_f32_32x32x32_bf16 v[80:95], v[152:155], v[64:71], v30
    buffer_load_dwordx4 v176, s[56:59], s22 offen lds
    v_exp_f32 v35, v35
    v_exp_f32 v36, v36
    v_exp_f32 v37, v37
    v_exp_f32 v38, v38
    v_smfmac_f32_32x32x32_bf16 v[80:95], v[156:159], v[72:79], v30
    s_lshl_b32 s34, s34, 9
    s_lshl_b32 s23, s48, 7
    s_add_u32 s34, s34, s23
    ds_read_b128 v[144:147], v24 offset:12672
    v_exp_f32 v39, v39
    v_exp_f32 v40, v40
    v_exp_f32 v41, v41
    v_exp_f32 v42, v42
    v_exp_f32 v43, v43
    v_exp_f32 v44, v44
    v_exp_f32 v45, v45
    v_exp_f32 v46, v46
    v_exp_f32 v47, v47
    v_mfma_f32_32x32x16_bf16 v[64:79], v[148:151], v[20:23], v[128:143]
    s_waitcnt lgkmcnt(0)
    v_exp_f32 v48, v48
    v_exp_f32 v49, v49
    v_exp_f32 v50, v50
    v_smfmac_f32_32x32x32_bf16 v[96:111], v[152:155], v[32:39], v30
    s_add_u32 s34, s34, 53248
    s_lshl_b32 s39, s47, 9
    s_mov_b32 m0, s35
    ds_read_b128 v[160:163], v27 offset:10560
    v_exp_f32 v51, v51
    v_exp_f32 v52, v52
    v_exp_f32 v53, v53
    v_exp_f32 v54, v54
    v_smfmac_f32_32x32x32_bf16 v[96:111], v[156:159], v[40:47], v30
    buffer_load_dwordx4 v212, s[60:63], 0 offen lds
    s_mov_b32 s3, 98304
    s_add_u32 m0, s35, 1024
    ds_read_b128 v[164:167], v27 offset:11104
    v_exp_f32 v55, v55
    v_exp_f32 v56, v56
    v_exp_f32 v57, v57
    v_exp_f32 v58, v58
    v_exp_f32 v59, v59
    v_exp_f32 v60, v60
    v_exp_f32 v61, v61
    v_exp_f32 v62, v62
    v_exp_f32 v63, v63
    v_mfma_f32_32x32x16_bf16 v[32:47], v[144:147], v[16:19], v[112:127]
    s_waitcnt lgkmcnt(0)
    s_waitcnt vmcnt(6)
    s_barrier
    buffer_load_dword v200, v217, s[8:11], s31 offen sc1
    v_exp_f32 v64, v64
    v_exp_f32 v65, v65
    v_exp_f32 v66, v66
    v_smfmac_f32_32x32x32_bf16 v[80:95], v[160:163], v[48:55], v30
    buffer_load_dwordx4 v212, s[60:63], s3 offen lds
    v_exp_f32 v67, v67
    v_exp_f32 v68, v68
    v_exp_f32 v69, v69
    v_exp_f32 v70, v70
    v_smfmac_f32_32x32x32_bf16 v[80:95], v[164:167], v[56:63], v30
    ds_read_b128 v[148:151], v24 offset:14784
    v_exp_f32 v71, v71
    v_exp_f32 v72, v72
    v_exp_f32 v73, v73
    v_exp_f32 v74, v74
    v_exp_f32 v75, v75
    v_exp_f32 v76, v76
    v_exp_f32 v77, v77
    v_exp_f32 v78, v78
    v_exp_f32 v79, v79
    v_mfma_f32_32x32x16_bf16 v[48:63], v[144:147], v[20:23], v[128:143]
    s_waitcnt lgkmcnt(0)
    v_exp_f32 v32, v32
    v_exp_f32 v33, v33
    v_exp_f32 v34, v34
    v_smfmac_f32_32x32x32_bf16 v[96:111], v[160:163], v[64:71], v30
    s_mov_b32 s38, 49152
    s_add_u32 s27, s39, s38
    ds_read_b128 v[152:155], v27 offset:12672
    v_exp_f32 v35, v35
    v_exp_f32 v36, v36
    v_exp_f32 v37, v37
    v_exp_f32 v38, v38
    v_smfmac_f32_32x32x32_bf16 v[96:111], v[164:167], v[72:79], v30
    s_add_u32 s39, s27, s23
    s_lshr_b32 s23, s46, 4
    ds_read_b128 v[156:159], v27 offset:13216
    v_exp_f32 v39, v39
    v_exp_f32 v40, v40
    v_exp_f32 v41, v41
    v_exp_f32 v42, v42
    v_exp_f32 v43, v43
    v_exp_f32 v44, v44
    v_exp_f32 v45, v45
    v_exp_f32 v46, v46
    v_exp_f32 v47, v47
    v_mfma_f32_32x32x16_bf16 v[64:79], v[148:151], v[16:19], v[112:127]
    s_waitcnt lgkmcnt(0)
    v_exp_f32 v48, v48
    v_exp_f32 v49, v49
    v_exp_f32 v50, v50
    v_smfmac_f32_32x32x32_bf16 v[80:95], v[152:155], v[32:39], v30
    buffer_load_dword v200, v173, s[4:7], s19 offen
    v_exp_f32 v51, v51
    v_exp_f32 v52, v52
    v_exp_f32 v53, v53
    v_exp_f32 v54, v54
    v_smfmac_f32_32x32x32_bf16 v[80:95], v[156:159], v[40:47], v30
    s_mul_i32 s23, s23, 3584
    s_mul_i32 s28, s47, 448
    ds_read_b128 v[144:147], v24 offset:16896
    v_exp_f32 v55, v55
    v_exp_f32 v56, v56
    v_exp_f32 v57, v57
    v_exp_f32 v58, v58
    v_exp_f32 v59, v59
    v_exp_f32 v60, v60
    v_exp_f32 v61, v61
    v_exp_f32 v62, v62
    v_exp_f32 v63, v63
    v_mfma_f32_32x32x16_bf16 v[32:47], v[148:151], v[20:23], v[128:143]
    s_waitcnt lgkmcnt(0)
    v_exp_f32 v64, v64
    v_exp_f32 v65, v65
    v_exp_f32 v66, v66
    v_smfmac_f32_32x32x32_bf16 v[96:111], v[152:155], v[48:55], v30
    s_add_u32 s28, s28, s23
    s_lshl_b32 s23, s48, 8
    ds_read_b128 v[160:163], v27 offset:14784
    v_exp_f32 v67, v67
    v_exp_f32 v68, v68
    v_exp_f32 v69, v69
    v_exp_f32 v70, v70
    v_smfmac_f32_32x32x32_bf16 v[96:111], v[156:159], v[56:63], v30
    s_add_u32 s28, s28, s23
    s_add_u32 s28, s28, 192512
    ds_read_b128 v[164:167], v27 offset:15328
    v_exp_f32 v71, v71
    v_exp_f32 v72, v72
    v_exp_f32 v73, v73
    v_exp_f32 v74, v74
    v_exp_f32 v75, v75
    v_exp_f32 v76, v76
    v_exp_f32 v77, v77
    v_exp_f32 v78, v78
    v_exp_f32 v79, v79
    v_mfma_f32_32x32x16_bf16 v[48:63], v[144:147], v[16:19], v[112:127]
    s_waitcnt lgkmcnt(0)
    v_exp_f32 v32, v32
    v_exp_f32 v33, v33
    v_exp_f32 v34, v34
    v_smfmac_f32_32x32x32_bf16 v[80:95], v[160:163], v[64:71], v30
    v_exp_f32 v35, v35
    v_exp_f32 v36, v36
    v_exp_f32 v37, v37
    v_exp_f32 v38, v38
    v_smfmac_f32_32x32x32_bf16 v[80:95], v[164:167], v[72:79], v30
    s_lshr_b32 s23, s48, 1
    s_mul_i32 s23, s23, 18874368
    ds_read_b128 v[148:151], v24 offset:19008
    v_exp_f32 v39, v39
    v_exp_f32 v40, v40
    v_exp_f32 v41, v41
    v_exp_f32 v42, v42
    v_exp_f32 v43, v43
    v_exp_f32 v44, v44
    v_exp_f32 v45, v45
    v_exp_f32 v46, v46
    v_exp_f32 v47, v47
    v_mfma_f32_32x32x16_bf16 v[64:79], v[144:147], v[20:23], v[128:143]
    s_waitcnt lgkmcnt(0)
    v_exp_f32 v48, v48
    v_exp_f32 v49, v49
    v_exp_f32 v50, v50
    v_smfmac_f32_32x32x32_bf16 v[96:111], v[160:163], v[32:39], v30
    s_add_u32 s28, s28, s23
    s_add_u32 s29, s28, 7168
    ds_read_b128 v[152:155], v27 offset:16896
    v_exp_f32 v51, v51
    v_exp_f32 v52, v52
    v_exp_f32 v53, v53
    v_exp_f32 v54, v54
    v_smfmac_f32_32x32x32_bf16 v[96:111], v[164:167], v[40:47], v30
    s_and_b32 s25, s46, 15
    s_lshl_b32 s25, s25, 7
    ds_read_b128 v[156:159], v27 offset:17440
    v_exp_f32 v55, v55
    v_exp_f32 v56, v56
    v_exp_f32 v57, v57
    v_exp_f32 v58, v58
    v_exp_f32 v59, v59
    v_exp_f32 v60, v60
    v_exp_f32 v61, v61
    v_exp_f32 v62, v62
    v_exp_f32 v63, v63
    v_mfma_f32_32x32x16_bf16 v[32:47], v[148:151], v[16:19], v[112:127]
    s_waitcnt lgkmcnt(0)
    v_exp_f32 v64, v64
    v_exp_f32 v65, v65
    v_exp_f32 v66, v66
    v_smfmac_f32_32x32x32_bf16 v[80:95], v[152:155], v[48:55], v30
    v_exp_f32 v67, v67
    v_exp_f32 v68, v68
    v_exp_f32 v69, v69
    v_exp_f32 v70, v70
    v_smfmac_f32_32x32x32_bf16 v[80:95], v[156:159], v[56:63], v30
    s_add_u32 s25, s25, 55296
    s_and_b32 s23, s46, 3
    ds_read_b128 v[144:147], v24 offset:21120
    v_exp_f32 v71, v71
    v_exp_f32 v72, v72
    v_exp_f32 v73, v73
    v_exp_f32 v74, v74
    v_exp_f32 v75, v75
    v_exp_f32 v76, v76
    v_exp_f32 v77, v77
    v_exp_f32 v78, v78
    v_exp_f32 v79, v79
    v_mfma_f32_32x32x16_bf16 v[48:63], v[148:151], v[20:23], v[128:143]
    s_waitcnt lgkmcnt(0)
    v_exp_f32 v32, v32
    v_exp_f32 v33, v33
    v_exp_f32 v34, v34
    v_smfmac_f32_32x32x32_bf16 v[96:111], v[152:155], v[64:71], v30
    s_lshl_b32 s23, s23, 2
    s_add_u32 s23, s23, s48
    ds_read_b128 v[160:163], v27 offset:19008
    v_exp_f32 v35, v35
    v_exp_f32 v36, v36
    v_exp_f32 v37, v37
    v_exp_f32 v38, v38
    v_smfmac_f32_32x32x32_bf16 v[96:111], v[156:159], v[72:79], v30
    s_mul_i32 s26, s23, 7168
    s_mul_i32 s23, s47, 114688
    ds_read_b128 v[164:167], v27 offset:19552
    v_exp_f32 v39, v39
    v_exp_f32 v40, v40
    v_exp_f32 v41, v41
    v_exp_f32 v42, v42
    v_exp_f32 v43, v43
    v_exp_f32 v44, v44
    v_exp_f32 v45, v45
    v_exp_f32 v46, v46
    v_exp_f32 v47, v47
    v_mfma_f32_32x32x16_bf16 v[64:79], v[144:147], v[16:19], v[112:127]
    s_waitcnt lgkmcnt(0)
    v_exp_f32 v48, v48
    v_exp_f32 v49, v49
    v_exp_f32 v50, v50
    v_smfmac_f32_32x32x32_bf16 v[80:95], v[160:163], v[32:39], v30
    v_exp_f32 v51, v51
    v_exp_f32 v52, v52
    v_exp_f32 v53, v53
    v_exp_f32 v54, v54
    v_smfmac_f32_32x32x32_bf16 v[80:95], v[164:167], v[40:47], v30
    s_add_u32 s26, s26, s23
    s_add_u32 s26, s26, 14680064
    ds_read_b128 v[148:151], v24 offset:23232
    v_exp_f32 v55, v55
    v_exp_f32 v56, v56
    v_exp_f32 v57, v57
    v_exp_f32 v58, v58
    v_exp_f32 v59, v59
    v_exp_f32 v60, v60
    v_exp_f32 v61, v61
    v_exp_f32 v62, v62
    v_exp_f32 v63, v63
    v_mfma_f32_32x32x16_bf16 v[32:47], v[144:147], v[20:23], v[128:143]
    s_waitcnt lgkmcnt(0)
    v_exp_f32 v64, v64
    v_exp_f32 v65, v65
    v_exp_f32 v66, v66
    v_smfmac_f32_32x32x32_bf16 v[96:111], v[160:163], v[48:55], v30
    s_lshl_b32 s69, s47, 16
    s_add_u32 s69, s69, 14155776
    ds_read_b128 v[152:155], v27 offset:21120
    v_exp_f32 v67, v67
    v_exp_f32 v68, v68
    v_exp_f32 v69, v69
    v_exp_f32 v70, v70
    v_smfmac_f32_32x32x32_bf16 v[96:111], v[164:167], v[56:63], v30
    s_lshl_b32 s16, s55, 1
    s_lshl_b32 s23, s47, 11
    ds_read_b128 v[156:159], v27 offset:21664
    v_exp_f32 v71, v71
    v_exp_f32 v72, v72
    v_exp_f32 v73, v73
    v_exp_f32 v74, v74
    v_exp_f32 v75, v75
    v_exp_f32 v76, v76
    v_exp_f32 v77, v77
    v_exp_f32 v78, v78
    v_exp_f32 v79, v79
    v_mfma_f32_32x32x16_bf16 v[48:63], v[148:151], v[16:19], v[112:127]
    s_waitcnt lgkmcnt(0)
    v_exp_f32 v32, v32
    v_exp_f32 v33, v33
    v_exp_f32 v34, v34
    v_smfmac_f32_32x32x32_bf16 v[80:95], v[152:155], v[64:71], v30
    v_exp_f32 v35, v35
    v_exp_f32 v36, v36
    v_exp_f32 v37, v37
    v_exp_f32 v38, v38
    v_smfmac_f32_32x32x32_bf16 v[80:95], v[156:159], v[72:79], v30
    s_add_u32 s16, s16, s23
    s_add_u32 s16, s16, 1048576
    ds_read_b128 v[144:147], v24 offset:25344
    v_exp_f32 v39, v39
    v_exp_f32 v40, v40
    v_exp_f32 v41, v41
    v_exp_f32 v42, v42
    v_exp_f32 v43, v43
    v_exp_f32 v44, v44
    v_exp_f32 v45, v45
    v_exp_f32 v46, v46
    v_exp_f32 v47, v47
    v_mfma_f32_32x32x16_bf16 v[64:79], v[148:151], v[20:23], v[128:143]
    s_waitcnt lgkmcnt(0)
    v_exp_f32 v48, v48
    v_exp_f32 v49, v49
    v_exp_f32 v50, v50
    v_smfmac_f32_32x32x32_bf16 v[96:111], v[152:155], v[32:39], v30
    s_add_u32 s17, s16, 16384
    s_lshl_b32 s23, s47, 8
    ds_read_b128 v[160:163], v27 offset:23232
    v_exp_f32 v51, v51
    v_exp_f32 v52, v52
    v_exp_f32 v53, v53
    v_exp_f32 v54, v54
    v_smfmac_f32_32x32x32_bf16 v[96:111], v[156:159], v[40:47], v30
    s_add_u32 s18, s23, 53248
    s_add_u32 s30, s23, 57344
    ds_read_b128 v[164:167], v27 offset:23776
    v_exp_f32 v55, v55
    v_exp_f32 v56, v56
    v_exp_f32 v57, v57
    v_exp_f32 v58, v58
    v_exp_f32 v59, v59
    v_exp_f32 v60, v60
    v_exp_f32 v61, v61
    v_exp_f32 v62, v62
    v_exp_f32 v63, v63
    v_mfma_f32_32x32x16_bf16 v[32:47], v[144:147], v[16:19], v[112:127]
    s_waitcnt lgkmcnt(0)
    v_exp_f32 v64, v64
    v_exp_f32 v65, v65
    v_exp_f32 v66, v66
    v_smfmac_f32_32x32x32_bf16 v[80:95], v[160:163], v[48:55], v30
    v_exp_f32 v67, v67
    v_exp_f32 v68, v68
    v_exp_f32 v69, v69
    v_exp_f32 v70, v70
    v_smfmac_f32_32x32x32_bf16 v[80:95], v[164:167], v[56:63], v30
    s_add_u32 s23, s48, 0
    s_and_b32 s23, s23, 3
    ds_read_b128 v[148:151], v24 offset:27456
    v_exp_f32 v71, v71
    v_exp_f32 v72, v72
    v_exp_f32 v73, v73
    v_exp_f32 v74, v74
    v_exp_f32 v75, v75
    v_exp_f32 v76, v76
    v_exp_f32 v77, v77
    v_exp_f32 v78, v78
    v_exp_f32 v79, v79
    v_mfma_f32_32x32x16_bf16 v[48:63], v[144:147], v[20:23], v[128:143]
    s_waitcnt lgkmcnt(0)
    v_exp_f32 v32, v32
    v_exp_f32 v33, v33
    v_exp_f32 v34, v34
    v_smfmac_f32_32x32x32_bf16 v[96:111], v[160:163], v[64:71], v30
    s_lshl_b32 s70, s23, 16
    s_add_u32 s23, s48, 1
    s_lshl_b32 s21, s47, 1
    s_add_u32 s21, s21, s48
    ds_read_b128 v[152:155], v27 offset:25344
    v_exp_f32 v35, v35
    v_exp_f32 v36, v36
    v_exp_f32 v37, v37
    v_exp_f32 v38, v38
    v_smfmac_f32_32x32x32_bf16 v[96:111], v[164:167], v[72:79], v30
    s_and_b32 s23, s23, 3
    s_lshl_b32 s71, s23, 16
    s_lshl_b32 s22, s47, 5
    s_lshl_b32 s1, s21, 12
    ds_read_b128 v[156:159], v27 offset:25888
    v_exp_f32 v39, v39
    v_exp_f32 v40, v40
    v_exp_f32 v41, v41
    v_exp_f32 v42, v42
    v_exp_f32 v43, v43
    v_exp_f32 v44, v44
    v_exp_f32 v45, v45
    v_exp_f32 v46, v46
    v_exp_f32 v47, v47
    v_mfma_f32_32x32x16_bf16 v[64:79], v[148:151], v[16:19], v[112:127]
    s_waitcnt lgkmcnt(0)
    v_exp_f32 v48, v48
    v_exp_f32 v49, v49
    v_exp_f32 v50, v50
    v_smfmac_f32_32x32x32_bf16 v[80:95], v[152:155], v[32:39], v30
    v_exp_f32 v51, v51
    v_exp_f32 v52, v52
    v_exp_f32 v53, v53
    v_exp_f32 v54, v54
    v_smfmac_f32_32x32x32_bf16 v[80:95], v[156:159], v[40:47], v30
    s_add_u32 s23, s48, 2
    s_and_b32 s23, s23, 3
    ds_read_b128 v[144:147], v24 offset:29568
    v_exp_f32 v55, v55
    v_exp_f32 v56, v56
    v_exp_f32 v57, v57
    v_exp_f32 v58, v58
    v_exp_f32 v59, v59
    v_exp_f32 v60, v60
    v_exp_f32 v61, v61
    v_exp_f32 v62, v62
    v_exp_f32 v63, v63
    v_mfma_f32_32x32x16_bf16 v[32:47], v[148:151], v[20:23], v[128:143]
    s_waitcnt lgkmcnt(0)
    v_exp_f32 v64, v64
    v_exp_f32 v65, v65
    v_exp_f32 v66, v66
    v_smfmac_f32_32x32x32_bf16 v[96:111], v[152:155], v[48:55], v30
    s_lshl_b32 s72, s23, 16
    s_add_u32 s23, s48, 3
    ds_read_b128 v[160:163], v27 offset:27456
    v_exp_f32 v67, v67
    v_exp_f32 v68, v68
    v_exp_f32 v69, v69
    v_exp_f32 v70, v70
    v_smfmac_f32_32x32x32_bf16 v[96:111], v[156:159], v[56:63], v30
    s_and_b32 s23, s23, 3
    s_lshl_b32 s73, s23, 16
    ds_read_b128 v[164:167], v27 offset:28000
    v_exp_f32 v71, v71
    v_exp_f32 v72, v72
    v_exp_f32 v73, v73
    v_exp_f32 v74, v74
    v_exp_f32 v75, v75
    v_exp_f32 v76, v76
    v_exp_f32 v77, v77
    v_exp_f32 v78, v78
    v_exp_f32 v79, v79
    v_mfma_f32_32x32x16_bf16 v[48:63], v[144:147], v[16:19], v[112:127]
    s_waitcnt lgkmcnt(0)
    v_exp_f32 v32, v32
    v_exp_f32 v33, v33
    v_exp_f32 v34, v34
    v_smfmac_f32_32x32x32_bf16 v[80:95], v[160:163], v[64:71], v30
    v_exp_f32 v35, v35
    v_exp_f32 v36, v36
    v_exp_f32 v37, v37
    v_exp_f32 v38, v38
    v_smfmac_f32_32x32x32_bf16 v[80:95], v[164:167], v[72:79], v30
    ds_read_b128 v[148:151], v24 offset:31680
    v_exp_f32 v39, v39
    v_exp_f32 v40, v40
    v_exp_f32 v41, v41
    v_exp_f32 v42, v42
    v_exp_f32 v43, v43
    v_exp_f32 v44, v44
    v_exp_f32 v45, v45
    v_exp_f32 v46, v46
    v_exp_f32 v47, v47
    v_mfma_f32_32x32x16_bf16 v[64:79], v[144:147], v[20:23], v[128:143]
    s_waitcnt lgkmcnt(0)
    v_exp_f32 v48, v48
    v_exp_f32 v49, v49
    v_exp_f32 v50, v50
    v_smfmac_f32_32x32x32_bf16 v[96:111], v[160:163], v[32:39], v30
    ds_read_b128 v[152:155], v27 offset:29568
    v_exp_f32 v51, v51
    v_exp_f32 v52, v52
    v_exp_f32 v53, v53
    v_exp_f32 v54, v54
    v_smfmac_f32_32x32x32_bf16 v[96:111], v[164:167], v[40:47], v30
    ds_read_b128 v[156:159], v27 offset:30112
    v_exp_f32 v55, v55
    v_exp_f32 v56, v56
    v_exp_f32 v57, v57
    v_exp_f32 v58, v58
    v_exp_f32 v59, v59
    v_exp_f32 v60, v60
    v_exp_f32 v61, v61
    v_exp_f32 v62, v62
    v_exp_f32 v63, v63
    v_mfma_f32_32x32x16_bf16 v[32:47], v[148:151], v[16:19], v[112:127]
    s_waitcnt lgkmcnt(0)
    v_exp_f32 v64, v64
    v_exp_f32 v65, v65
    v_exp_f32 v66, v66
    v_smfmac_f32_32x32x32_bf16 v[80:95], v[152:155], v[48:55], v30
    v_exp_f32 v67, v67
    v_exp_f32 v68, v68
    v_exp_f32 v69, v69
    v_exp_f32 v70, v70
    v_smfmac_f32_32x32x32_bf16 v[80:95], v[156:159], v[56:63], v30
    ds_read_b128 v[144:147], v24 offset:33792
    v_exp_f32 v71, v71
    v_exp_f32 v72, v72
    v_exp_f32 v73, v73
    v_exp_f32 v74, v74
    v_exp_f32 v75, v75
    v_exp_f32 v76, v76
    v_exp_f32 v77, v77
    v_exp_f32 v78, v78
    v_exp_f32 v79, v79
    v_mfma_f32_32x32x16_bf16 v[48:63], v[148:151], v[20:23], v[128:143]
    s_waitcnt lgkmcnt(0)
    v_exp_f32 v32, v32
    v_exp_f32 v33, v33
    v_exp_f32 v34, v34
    v_smfmac_f32_32x32x32_bf16 v[96:111], v[152:155], v[64:71], v30
    ds_read_b128 v[160:163], v27 offset:31680
    v_exp_f32 v35, v35
    v_exp_f32 v36, v36
    v_exp_f32 v37, v37
    v_exp_f32 v38, v38
    v_smfmac_f32_32x32x32_bf16 v[96:111], v[156:159], v[72:79], v30
    ds_read_b128 v[164:167], v27 offset:32224
    v_exp_f32 v39, v39
    v_exp_f32 v40, v40
    v_exp_f32 v41, v41
    v_exp_f32 v42, v42
    v_exp_f32 v43, v43
    v_exp_f32 v44, v44
    v_exp_f32 v45, v45
    v_exp_f32 v46, v46
    v_exp_f32 v47, v47
    v_mfma_f32_32x32x16_bf16 v[64:79], v[144:147], v[16:19], v[112:127]
    s_waitcnt lgkmcnt(0)
    v_exp_f32 v48, v48
    v_exp_f32 v49, v49
    v_exp_f32 v50, v50
    v_smfmac_f32_32x32x32_bf16 v[80:95], v[160:163], v[32:39], v30
    v_exp_f32 v51, v51
    v_exp_f32 v52, v52
    v_exp_f32 v53, v53
    v_exp_f32 v54, v54
    v_smfmac_f32_32x32x32_bf16 v[80:95], v[164:167], v[40:47], v30
    ds_read_b128 v[148:151], v24 offset:35904
    v_exp_f32 v55, v55
    v_exp_f32 v56, v56
    v_exp_f32 v57, v57
    v_exp_f32 v58, v58
    v_exp_f32 v59, v59
    v_exp_f32 v60, v60
    v_exp_f32 v61, v61
    v_exp_f32 v62, v62
    v_exp_f32 v63, v63
    v_mfma_f32_32x32x16_bf16 v[32:47], v[144:147], v[20:23], v[128:143]
    s_waitcnt lgkmcnt(0)
    v_exp_f32 v64, v64
    v_exp_f32 v65, v65
    v_exp_f32 v66, v66
    v_smfmac_f32_32x32x32_bf16 v[96:111], v[160:163], v[48:55], v30
    ds_read_b128 v[152:155], v27 offset:33792
    v_exp_f32 v67, v67
    v_exp_f32 v68, v68
    v_exp_f32 v69, v69
    v_exp_f32 v70, v70
    v_smfmac_f32_32x32x32_bf16 v[96:111], v[164:167], v[56:63], v30
    ds_read_b128 v[156:159], v27 offset:34336
    v_exp_f32 v71, v71
    v_exp_f32 v72, v72
    v_exp_f32 v73, v73
    v_exp_f32 v74, v74
    v_exp_f32 v75, v75
    v_exp_f32 v76, v76
    v_exp_f32 v77, v77
    v_exp_f32 v78, v78
    v_exp_f32 v79, v79
    v_mfma_f32_32x32x16_bf16 v[48:63], v[148:151], v[16:19], v[112:127]
    s_waitcnt lgkmcnt(0)
    v_exp_f32 v32, v32
    v_exp_f32 v33, v33
    v_exp_f32 v34, v34
    v_smfmac_f32_32x32x32_bf16 v[80:95], v[152:155], v[64:71], v30
    v_exp_f32 v35, v35
    v_exp_f32 v36, v36
    v_exp_f32 v37, v37
    v_exp_f32 v38, v38
    v_smfmac_f32_32x32x32_bf16 v[80:95], v[156:159], v[72:79], v30
    ds_read_b128 v[144:147], v24 offset:38016
    v_exp_f32 v39, v39
    v_exp_f32 v40, v40
    v_exp_f32 v41, v41
    v_exp_f32 v42, v42
    v_exp_f32 v43, v43
    v_exp_f32 v44, v44
    v_exp_f32 v45, v45
    v_exp_f32 v46, v46
    v_exp_f32 v47, v47
    v_mfma_f32_32x32x16_bf16 v[64:79], v[148:151], v[20:23], v[128:143]
    s_waitcnt lgkmcnt(0)
    v_exp_f32 v48, v48
    v_exp_f32 v49, v49
    v_exp_f32 v50, v50
    v_smfmac_f32_32x32x32_bf16 v[96:111], v[152:155], v[32:39], v30
    ds_read_b128 v[160:163], v27 offset:35904
    v_exp_f32 v51, v51
    v_exp_f32 v52, v52
    v_exp_f32 v53, v53
    v_exp_f32 v54, v54
    v_smfmac_f32_32x32x32_bf16 v[96:111], v[156:159], v[40:47], v30
    ds_read_b128 v[164:167], v27 offset:36448
    v_exp_f32 v55, v55
    v_exp_f32 v56, v56
    v_exp_f32 v57, v57
    v_exp_f32 v58, v58
    v_exp_f32 v59, v59
    v_exp_f32 v60, v60
    v_exp_f32 v61, v61
    v_exp_f32 v62, v62
    v_exp_f32 v63, v63
    v_mfma_f32_32x32x16_bf16 v[32:47], v[144:147], v[16:19], v[112:127]
    s_waitcnt lgkmcnt(0)
    v_exp_f32 v64, v64
    v_exp_f32 v65, v65
    v_exp_f32 v66, v66
    v_smfmac_f32_32x32x32_bf16 v[80:95], v[160:163], v[48:55], v30
    v_exp_f32 v67, v67
    v_exp_f32 v68, v68
    v_exp_f32 v69, v69
    v_exp_f32 v70, v70
    v_smfmac_f32_32x32x32_bf16 v[80:95], v[164:167], v[56:63], v30
    ds_read_b128 v[148:151], v24 offset:40128
    v_exp_f32 v71, v71
    v_exp_f32 v72, v72
    v_exp_f32 v73, v73
    v_exp_f32 v74, v74
    v_exp_f32 v75, v75
    v_exp_f32 v76, v76
    v_exp_f32 v77, v77
    v_exp_f32 v78, v78
    v_exp_f32 v79, v79
    v_mfma_f32_32x32x16_bf16 v[48:63], v[144:147], v[20:23], v[128:143]
    s_waitcnt lgkmcnt(0)
    v_exp_f32 v32, v32
    v_exp_f32 v33, v33
    v_exp_f32 v34, v34
    v_smfmac_f32_32x32x32_bf16 v[96:111], v[160:163], v[64:71], v30
    ds_read_b128 v[152:155], v27 offset:38016
    v_exp_f32 v35, v35
    v_exp_f32 v36, v36
    v_exp_f32 v37, v37
    v_exp_f32 v38, v38
    v_smfmac_f32_32x32x32_bf16 v[96:111], v[164:167], v[72:79], v30
    ds_read_b128 v[156:159], v27 offset:38560
    v_exp_f32 v39, v39
    v_exp_f32 v40, v40
    v_exp_f32 v41, v41
    v_exp_f32 v42, v42
    v_exp_f32 v43, v43
    v_exp_f32 v44, v44
    v_exp_f32 v45, v45
    v_exp_f32 v46, v46
    v_exp_f32 v47, v47
    v_mfma_f32_32x32x16_bf16 v[64:79], v[148:151], v[16:19], v[112:127]
    s_waitcnt lgkmcnt(0)
    v_exp_f32 v48, v48
    v_exp_f32 v49, v49
    v_exp_f32 v50, v50
    v_smfmac_f32_32x32x32_bf16 v[80:95], v[152:155], v[32:39], v30
    v_exp_f32 v51, v51
    v_exp_f32 v52, v52
    v_exp_f32 v53, v53
    v_exp_f32 v54, v54
    v_smfmac_f32_32x32x32_bf16 v[80:95], v[156:159], v[40:47], v30
    s_waitcnt vmcnt(1)
    ds_read_b128 v[144:147], v24 offset:42240
    ds_read_b64_tr_b16 v[220:221], v213
    ds_read_b64_tr_b16 v[222:223], v213 offset:256
    v_exp_f32 v55, v55
    v_exp_f32 v56, v56
    v_exp_f32 v57, v57
    v_exp_f32 v58, v58
    v_exp_f32 v59, v59
    v_exp_f32 v60, v60
    v_exp_f32 v61, v61
    v_exp_f32 v62, v62
    v_exp_f32 v63, v63
    v_mfma_f32_32x32x16_bf16 v[32:47], v[148:151], v[20:23], v[128:143]
    s_waitcnt lgkmcnt(0)
    ds_read_b64_tr_b16 v[180:181], v177 offset:0
    ds_read_b64_tr_b16 v[182:183], v178 offset:0
    v_exp_f32 v64, v64
    v_exp_f32 v65, v65
    v_exp_f32 v66, v66
    v_smfmac_f32_32x32x32_bf16 v[96:111], v[152:155], v[48:55], v30
    ds_read_b128 v[160:163], v27 offset:40128
    ds_read_b64_tr_b16 v[224:225], v213 offset:32
    ds_read_b64_tr_b16 v[226:227], v213 offset:288
    v_exp_f32 v67, v67
    v_exp_f32 v68, v68
    v_exp_f32 v69, v69
    v_exp_f32 v70, v70
    v_smfmac_f32_32x32x32_bf16 v[96:111], v[156:159], v[56:63], v30
    ds_read_b128 v[164:167], v27 offset:40672
    v_exp_f32 v71, v71
    v_exp_f32 v72, v72
    v_exp_f32 v73, v73
    v_exp_f32 v74, v74
    v_exp_f32 v75, v75
    v_exp_f32 v76, v76
    v_exp_f32 v77, v77
    v_exp_f32 v78, v78
    v_exp_f32 v79, v79
    v_mfma_f32_32x32x16_bf16 v[48:63], v[144:147], v[16:19], v[112:127]
    s_waitcnt lgkmcnt(0)
    ds_read_b64_tr_b16 v[184:185], v177 offset:32
    ds_read_b64_tr_b16 v[186:187], v178 offset:32
    v_exp_f32 v32, v32
    v_exp_f32 v33, v33
    v_exp_f32 v34, v34
    v_smfmac_f32_32x32x32_bf16 v[80:95], v[160:163], v[64:71], v30
    v_mfma_f32_16x16x32_bf16 v[228:231], v[8:11], v[220:223], 0
    v_mfma_f32_16x16x32_bf16 v[232:235], v[8:11], v[224:227], 0
    v_exp_f32 v35, v35
    v_exp_f32 v36, v36
    v_exp_f32 v37, v37
    v_exp_f32 v38, v38
    v_smfmac_f32_32x32x32_bf16 v[80:95], v[164:167], v[72:79], v30
    ds_read_b128 v[148:151], v24 offset:44352
    v_exp_f32 v39, v39
    v_exp_f32 v40, v40
    v_exp_f32 v41, v41
    v_exp_f32 v42, v42
    v_exp_f32 v43, v43
    v_exp_f32 v44, v44
    v_exp_f32 v45, v45
    v_exp_f32 v46, v46
    v_exp_f32 v47, v47
    v_mfma_f32_32x32x16_bf16 v[64:79], v[144:147], v[20:23], v[128:143]
    s_waitcnt lgkmcnt(0)
    ds_read_b64_tr_b16 v[188:189], v177 offset:64
    ds_read_b64_tr_b16 v[190:191], v178 offset:64
    v_exp_f32 v48, v48
    v_exp_f32 v49, v49
    v_exp_f32 v50, v50
    v_smfmac_f32_32x32x32_bf16 v[96:111], v[160:163], v[32:39], v30
    ds_read_b128 v[152:155], v27 offset:42240
    s_mov_b32 exec_lo, 0xffff0000
    v_mov_b32 v228, v232
    s_mov_b32 exec_lo, -1
    v_exp_f32 v51, v51
    v_exp_f32 v52, v52
    v_exp_f32 v53, v53
    v_exp_f32 v54, v54
    v_smfmac_f32_32x32x32_bf16 v[96:111], v[164:167], v[40:47], v30
    buffer_atomic_add_f32 v228, v214, s[8:11], s34 offen
    ds_read_b128 v[156:159], v27 offset:42784
    v_exp_f32 v55, v55
    v_exp_f32 v56, v56
    v_exp_f32 v57, v57
    v_exp_f32 v58, v58
    v_exp_f32 v59, v59
    v_exp_f32 v60, v60
    v_exp_f32 v61, v61
    v_exp_f32 v62, v62
    v_exp_f32 v63, v63
    v_mfma_f32_32x32x16_bf16 v[32:47], v[148:151], v[16:19], v[112:127]
    s_waitcnt lgkmcnt(0)
    ds_read_b64_tr_b16 v[192:193], v177 offset:96
    ds_read_b64_tr_b16 v[194:195], v178 offset:96
    v_exp_f32 v64, v64
    v_exp_f32 v65, v65
    v_exp_f32 v66, v66
    v_smfmac_f32_32x32x32_bf16 v[80:95], v[152:155], v[48:55], v30
    buffer_store_dwordx4 v[180:183], v3, s[8:11], s36 offen offset:0 sc1
    buffer_store_dwordx4 v[184:187], v3, s[8:11], s36 offen offset:1024 sc1
    v_exp_f32 v67, v67
    v_exp_f32 v68, v68
    v_exp_f32 v69, v69
    v_exp_f32 v70, v70
    v_smfmac_f32_32x32x32_bf16 v[80:95], v[156:159], v[56:63], v30
    ds_read_b128 v[144:147], v24 offset:46464
    v_exp_f32 v71, v71
    v_exp_f32 v72, v72
    v_exp_f32 v73, v73
    v_exp_f32 v74, v74
    v_exp_f32 v75, v75
    v_exp_f32 v76, v76
    v_exp_f32 v77, v77
    v_exp_f32 v78, v78
    v_exp_f32 v79, v79
    v_mfma_f32_32x32x16_bf16 v[48:63], v[148:151], v[20:23], v[128:143]
    s_waitcnt lgkmcnt(0)
    v_exp_f32 v32, v32
    v_exp_f32 v33, v33
    v_exp_f32 v34, v34
    v_smfmac_f32_32x32x32_bf16 v[96:111], v[152:155], v[64:71], v30
    ds_read_b128 v[160:163], v27 offset:44352
    v_exp_f32 v35, v35
    v_exp_f32 v36, v36
    v_exp_f32 v37, v37
    v_exp_f32 v38, v38
    v_smfmac_f32_32x32x32_bf16 v[96:111], v[156:159], v[72:79], v30
    ds_read_b128 v[164:167], v27 offset:44896
    v_exp_f32 v39, v39
    v_exp_f32 v40, v40
    v_exp_f32 v41, v41
    v_exp_f32 v42, v42
    v_exp_f32 v43, v43
    v_exp_f32 v44, v44
    v_exp_f32 v45, v45
    v_exp_f32 v46, v46
    v_exp_f32 v47, v47
    v_mfma_f32_32x32x16_bf16 v[64:79], v[144:147], v[16:19], v[112:127]
    s_waitcnt lgkmcnt(0)
    v_exp_f32 v48, v48
    v_exp_f32 v49, v49
    v_exp_f32 v50, v50
    v_smfmac_f32_32x32x32_bf16 v[80:95], v[160:163], v[32:39], v30
    buffer_store_dwordx4 v[188:191], v3, s[8:11], s24 offen offset:2048 sc1
    buffer_store_dwordx4 v[192:195], v3, s[8:11], s37 offen offset:3072 sc1
    v_exp_f32 v51, v51
    v_exp_f32 v52, v52
    v_exp_f32 v53, v53
    v_exp_f32 v54, v54
    v_smfmac_f32_32x32x32_bf16 v[80:95], v[164:167], v[40:47], v30
    ds_read_b128 v[148:151], v24 offset:48576
    v_exp_f32 v55, v55
    v_exp_f32 v56, v56
    v_exp_f32 v57, v57
    v_exp_f32 v58, v58
    v_exp_f32 v59, v59
    v_exp_f32 v60, v60
    v_exp_f32 v61, v61
    v_exp_f32 v62, v62
    v_exp_f32 v63, v63
    v_mfma_f32_32x32x16_bf16 v[32:47], v[144:147], v[20:23], v[128:143]
    s_waitcnt lgkmcnt(0)
    v_exp_f32 v64, v64
    v_exp_f32 v65, v65
    v_exp_f32 v66, v66
    v_smfmac_f32_32x32x32_bf16 v[96:111], v[160:163], v[48:55], v30
    ds_read_b128 v[152:155], v27 offset:46464
    v_exp_f32 v67, v67
    v_exp_f32 v68, v68
    v_exp_f32 v69, v69
    v_exp_f32 v70, v70
    v_smfmac_f32_32x32x32_bf16 v[96:111], v[164:167], v[56:63], v30
    ds_read_b128 v[156:159], v27 offset:47008
    v_exp_f32 v71, v71
    v_exp_f32 v72, v72
    v_exp_f32 v73, v73
    v_exp_f32 v74, v74
    v_exp_f32 v75, v75
    v_exp_f32 v76, v76
    v_exp_f32 v77, v77
    v_exp_f32 v78, v78
    v_exp_f32 v79, v79
    v_mfma_f32_32x32x16_bf16 v[48:63], v[148:151], v[16:19], v[112:127]
    s_waitcnt lgkmcnt(0)
    v_exp_f32 v32, v32
    v_exp_f32 v33, v33
    v_exp_f32 v34, v34
    v_smfmac_f32_32x32x32_bf16 v[80:95], v[152:155], v[64:71], v30
    v_exp_f32 v35, v35
    v_exp_f32 v36, v36
    v_exp_f32 v37, v37
    v_exp_f32 v38, v38
    v_smfmac_f32_32x32x32_bf16 v[80:95], v[156:159], v[72:79], v30
    ds_read_b128 v[144:147], v24 offset:50688
    v_exp_f32 v39, v39
    v_exp_f32 v40, v40
    v_exp_f32 v41, v41
    v_exp_f32 v42, v42
    v_exp_f32 v43, v43
    v_exp_f32 v44, v44
    v_exp_f32 v45, v45
    v_exp_f32 v46, v46
    v_exp_f32 v47, v47
    v_mfma_f32_32x32x16_bf16 v[64:79], v[148:151], v[20:23], v[128:143]
    s_waitcnt lgkmcnt(0)
    v_exp_f32 v48, v48
    v_exp_f32 v49, v49
    v_exp_f32 v50, v50
    v_smfmac_f32_32x32x32_bf16 v[96:111], v[152:155], v[32:39], v30
    ds_read_b128 v[160:163], v27 offset:48576
    v_exp_f32 v51, v51
    v_exp_f32 v52, v52
    v_exp_f32 v53, v53
    v_exp_f32 v54, v54
    v_smfmac_f32_32x32x32_bf16 v[96:111], v[156:159], v[40:47], v30
    ds_read_b128 v[164:167], v27 offset:49120
    v_exp_f32 v55, v55
    v_exp_f32 v56, v56
    v_exp_f32 v57, v57
    v_exp_f32 v58, v58
    v_exp_f32 v59, v59
    v_exp_f32 v60, v60
    v_exp_f32 v61, v61
    v_exp_f32 v62, v62
    v_exp_f32 v63, v63
    v_mfma_f32_32x32x16_bf16 v[32:47], v[144:147], v[16:19], v[112:127]
    s_waitcnt lgkmcnt(0)
    v_exp_f32 v64, v64
    v_exp_f32 v65, v65
    v_exp_f32 v66, v66
    v_smfmac_f32_32x32x32_bf16 v[80:95], v[160:163], v[48:55], v30
    v_exp_f32 v67, v67
    v_exp_f32 v68, v68
    v_exp_f32 v69, v69
    v_exp_f32 v70, v70
    v_smfmac_f32_32x32x32_bf16 v[80:95], v[164:167], v[56:63], v30
    ds_read_b128 v[148:151], v24 offset:52800
    v_exp_f32 v71, v71
    v_exp_f32 v72, v72
    v_exp_f32 v73, v73
    v_exp_f32 v74, v74
    v_exp_f32 v75, v75
    v_exp_f32 v76, v76
    v_exp_f32 v77, v77
    v_exp_f32 v78, v78
    v_exp_f32 v79, v79
    v_mfma_f32_32x32x16_bf16 v[48:63], v[144:147], v[20:23], v[128:143]
    s_waitcnt lgkmcnt(0)
    v_exp_f32 v32, v32
    v_exp_f32 v33, v33
    v_exp_f32 v34, v34
    v_smfmac_f32_32x32x32_bf16 v[96:111], v[160:163], v[64:71], v30
    s_mov_b32 m0, s65
    ds_read_b128 v[152:155], v27 offset:50688
    v_exp_f32 v35, v35
    v_exp_f32 v36, v36
    v_exp_f32 v37, v37
    v_exp_f32 v38, v38
    v_smfmac_f32_32x32x32_bf16 v[96:111], v[164:167], v[72:79], v30
    buffer_load_dwordx4 v3, s[8:11], s64 offen sc1 lds
    buffer_load_dwordx4 v3, s[8:11], s64 offen offset:1024 sc1 lds
    s_add_u32 s64, s64, 8192
    s_add_u32 s65, s65, 8192
    s_mov_b32 m0, s65
    ds_read_b128 v[156:159], v27 offset:51232
    v_exp_f32 v39, v39
    v_exp_f32 v40, v40
    v_exp_f32 v41, v41
    v_exp_f32 v42, v42
    v_exp_f32 v43, v43
    v_exp_f32 v44, v44
    v_exp_f32 v45, v45
    v_exp_f32 v46, v46
    v_exp_f32 v47, v47
    v_mfma_f32_32x32x16_bf16 v[64:79], v[148:151], v[16:19], v[112:127]
    s_waitcnt lgkmcnt(0)
    v_exp_f32 v48, v48
    v_exp_f32 v49, v49
    v_exp_f32 v50, v50
    v_smfmac_f32_32x32x32_bf16 v[80:95], v[152:155], v[32:39], v30
    buffer_load_dwordx4 v3, s[8:11], s64 offen sc1 lds
    buffer_load_dwordx4 v3, s[8:11], s64 offen offset:1024 sc1 lds
    s_add_u32 s64, s64, 8192
    s_add_u32 s65, s65, 8192
    v_exp_f32 v51, v51
    v_exp_f32 v52, v52
    v_exp_f32 v53, v53
    v_exp_f32 v54, v54
    v_smfmac_f32_32x32x32_bf16 v[80:95], v[156:159], v[40:47], v30
    ds_read_b128 v[144:147], v24 offset:54912
    v_exp_f32 v55, v55
    v_exp_f32 v56, v56
    v_exp_f32 v57, v57
    v_exp_f32 v58, v58
    v_exp_f32 v59, v59
    v_exp_f32 v60, v60
    v_exp_f32 v61, v61
    v_exp_f32 v62, v62
    v_exp_f32 v63, v63
    v_mfma_f32_32x32x16_bf16 v[32:47], v[148:151], v[20:23], v[128:143]
    s_waitcnt lgkmcnt(0)
    v_exp_f32 v64, v64
    v_exp_f32 v65, v65
    v_exp_f32 v66, v66
    v_smfmac_f32_32x32x32_bf16 v[96:111], v[152:155], v[48:55], v30
    s_mov_b32 m0, s65
    ds_read_b128 v[160:163], v27 offset:52800
    v_exp_f32 v67, v67
    v_exp_f32 v68, v68
    v_exp_f32 v69, v69
    v_exp_f32 v70, v70
    v_smfmac_f32_32x32x32_bf16 v[96:111], v[156:159], v[56:63], v30
    buffer_load_dwordx4 v3, s[8:11], s64 offen sc1 lds
    buffer_load_dwordx4 v3, s[8:11], s64 offen offset:1024 sc1 lds
    s_add_u32 s64, s64, 8192
    s_add_u32 s65, s65, 8192
    s_mov_b32 m0, s65
    ds_read_b128 v[164:167], v27 offset:53344
    v_exp_f32 v71, v71
    v_exp_f32 v72, v72
    v_exp_f32 v73, v73
    v_exp_f32 v74, v74
    v_exp_f32 v75, v75
    v_exp_f32 v76, v76
    v_exp_f32 v77, v77
    v_exp_f32 v78, v78
    v_exp_f32 v79, v79
    v_mfma_f32_32x32x16_bf16 v[48:63], v[144:147], v[16:19], v[112:127]
    s_waitcnt lgkmcnt(0)
    s_barrier
    v_exp_f32 v32, v32
    v_exp_f32 v33, v33
    v_exp_f32 v34, v34
    v_smfmac_f32_32x32x32_bf16 v[80:95], v[160:163], v[64:71], v30
    buffer_load_dwordx4 v3, s[8:11], s64 offen sc1 lds
    buffer_load_dwordx4 v3, s[8:11], s64 offen offset:1024 sc1 lds
    s_add_u32 s64, s64, 8192
    s_add_u32 s65, s65, 8192
    v_exp_f32 v35, v35
    v_exp_f32 v36, v36
    v_exp_f32 v37, v37
    v_exp_f32 v38, v38
    v_smfmac_f32_32x32x32_bf16 v[80:95], v[164:167], v[72:79], v30
    ds_read_b128 v[148:151], v24 offset:57024
    v_exp_f32 v39, v39
    v_exp_f32 v40, v40
    v_exp_f32 v41, v41
    v_exp_f32 v42, v42
    v_exp_f32 v43, v43
    v_exp_f32 v44, v44
    v_exp_f32 v45, v45
    v_exp_f32 v46, v46
    v_exp_f32 v47, v47
    v_mfma_f32_32x32x16_bf16 v[64:79], v[144:147], v[20:23], v[128:143]
    s_waitcnt lgkmcnt(0)
    v_exp_f32 v48, v48
    v_exp_f32 v49, v49
    v_exp_f32 v50, v50
    v_smfmac_f32_32x32x32_bf16 v[96:111], v[160:163], v[32:39], v30
    s_mov_b32 m0, s65
    ds_read_b128 v[152:155], v27 offset:54912
    v_exp_f32 v51, v51
    v_exp_f32 v52, v52
    v_exp_f32 v53, v53
    v_exp_f32 v54, v54
    v_smfmac_f32_32x32x32_bf16 v[96:111], v[164:167], v[40:47], v30
    buffer_load_dwordx4 v3, s[8:11], s64 offen sc1 lds
    buffer_load_dwordx4 v3, s[8:11], s64 offen offset:1024 sc1 lds
    s_add_u32 s64, s64, 8192
    s_add_u32 s65, s65, 8192
    s_mov_b32 m0, s65
    ds_read_b128 v[156:159], v27 offset:55456
    v_exp_f32 v55, v55
    v_exp_f32 v56, v56
    v_exp_f32 v57, v57
    v_exp_f32 v58, v58
    v_exp_f32 v59, v59
    v_exp_f32 v60, v60
    v_exp_f32 v61, v61
    v_exp_f32 v62, v62
    v_exp_f32 v63, v63
    v_mfma_f32_32x32x16_bf16 v[32:47], v[148:151], v[16:19], v[112:127]
    s_waitcnt lgkmcnt(0)
    v_exp_f32 v64, v64
    v_exp_f32 v65, v65
    v_exp_f32 v66, v66
    v_smfmac_f32_32x32x32_bf16 v[80:95], v[152:155], v[48:55], v30
    buffer_load_dwordx4 v3, s[8:11], s64 offen sc1 lds
    buffer_load_dwordx4 v3, s[8:11], s64 offen offset:1024 sc1 lds
    s_add_u32 s64, s64, 8192
    s_add_u32 s65, s65, 8192
    v_exp_f32 v67, v67
    v_exp_f32 v68, v68
    v_exp_f32 v69, v69
    v_exp_f32 v70, v70
    v_smfmac_f32_32x32x32_bf16 v[80:95], v[156:159], v[56:63], v30
    ds_read_b128 v[144:147], v24 offset:59136
    v_exp_f32 v71, v71
    v_exp_f32 v72, v72
    v_exp_f32 v73, v73
    v_exp_f32 v74, v74
    v_exp_f32 v75, v75
    v_exp_f32 v76, v76
    v_exp_f32 v77, v77
    v_exp_f32 v78, v78
    v_exp_f32 v79, v79
    v_mfma_f32_32x32x16_bf16 v[48:63], v[148:151], v[20:23], v[128:143]
    s_waitcnt lgkmcnt(0)
    v_exp_f32 v32, v32
    v_exp_f32 v33, v33
    v_exp_f32 v34, v34
    v_smfmac_f32_32x32x32_bf16 v[96:111], v[152:155], v[64:71], v30
    s_mov_b32 m0, s65
    ds_read_b128 v[160:163], v27 offset:57024
    v_exp_f32 v35, v35
    v_exp_f32 v36, v36
    v_exp_f32 v37, v37
    v_exp_f32 v38, v38
    v_smfmac_f32_32x32x32_bf16 v[96:111], v[156:159], v[72:79], v30
    buffer_load_dwordx4 v3, s[8:11], s64 offen sc1 lds
    buffer_load_dwordx4 v3, s[8:11], s64 offen offset:1024 sc1 lds
    s_add_u32 s64, s64, 8192
    s_add_u32 s65, s65, 8192
    s_mov_b32 m0, s65
    ds_read_b128 v[164:167], v27 offset:57568
    v_exp_f32 v39, v39
    v_exp_f32 v40, v40
    v_exp_f32 v41, v41
    v_exp_f32 v42, v42
    v_exp_f32 v43, v43
    v_exp_f32 v44, v44
    v_exp_f32 v45, v45
    v_exp_f32 v46, v46
    v_exp_f32 v47, v47
    v_mfma_f32_32x32x16_bf16 v[64:79], v[144:147], v[16:19], v[112:127]
    s_waitcnt lgkmcnt(0)
    v_exp_f32 v48, v48
    v_exp_f32 v49, v49
    v_exp_f32 v50, v50
    v_smfmac_f32_32x32x32_bf16 v[80:95], v[160:163], v[32:39], v30
    buffer_load_dwordx4 v3, s[8:11], s64 offen sc1 lds
    buffer_load_dwordx4 v3, s[8:11], s64 offen offset:1024 sc1 lds
    s_add_u32 s64, s64, 8192
    s_add_u32 s65, s65, 8192
    s_lshl_b32 s3, s48, 10
    s_sub_u32 s64, s64, s3
    v_exp_f32 v51, v51
    v_exp_f32 v52, v52
    v_exp_f32 v53, v53
    v_exp_f32 v54, v54
    v_smfmac_f32_32x32x32_bf16 v[80:95], v[164:167], v[40:47], v30
    s_sub_u32 m0, s65, s3
    ds_read_b128 v[148:151], v24 offset:61248
    v_exp_f32 v55, v55
    v_exp_f32 v56, v56
    v_exp_f32 v57, v57
    v_exp_f32 v58, v58
    v_exp_f32 v59, v59
    v_exp_f32 v60, v60
    v_exp_f32 v61, v61
    v_exp_f32 v62, v62
    v_exp_f32 v63, v63
    v_mfma_f32_32x32x16_bf16 v[32:47], v[144:147], v[20:23], v[128:143]
    s_waitcnt lgkmcnt(0)
    buffer_load_dwordx4 v3, s[8:11], s64 offen sc1 lds
    v_exp_f32 v64, v64
    v_exp_f32 v65, v65
    v_exp_f32 v66, v66
    v_smfmac_f32_32x32x32_bf16 v[96:111], v[160:163], v[48:55], v30
    s_add_u32 s75, s70, 0
    s_add_u32 m0, s77, 0
    ds_read_b128 v[152:155], v27 offset:59136
    v_exp_f32 v67, v67
    v_exp_f32 v68, v68
    v_exp_f32 v69, v69
    v_exp_f32 v70, v70
    v_smfmac_f32_32x32x32_bf16 v[96:111], v[164:167], v[56:63], v30
    buffer_load_dwordx4 v168, s[4:7], s75 offen lds
    buffer_load_dwordx4 v169, s[4:7], s75 offen offset:1024 lds
    s_add_u32 s75, s71, 0
    s_add_u32 m0, s77, 2048
    ds_read_b128 v[156:159], v27 offset:59680
    v_exp_f32 v71, v71
    v_exp_f32 v72, v72
    v_exp_f32 v73, v73
    v_exp_f32 v74, v74
    v_exp_f32 v75, v75
    v_exp_f32 v76, v76
    v_exp_f32 v77, v77
    v_exp_f32 v78, v78
    v_exp_f32 v79, v79
    v_mfma_f32_32x32x16_bf16 v[48:63], v[148:151], v[16:19], v[112:127]
    s_waitcnt lgkmcnt(0)
    v_exp_f32 v32, v32
    v_exp_f32 v33, v33
    v_exp_f32 v34, v34
    v_smfmac_f32_32x32x32_bf16 v[80:95], v[152:155], v[64:71], v30
    buffer_load_dwordx4 v168, s[4:7], s75 offen lds
    buffer_load_dwordx4 v169, s[4:7], s75 offen offset:1024 lds
    v_exp_f32 v35, v35
    v_exp_f32 v36, v36
    v_exp_f32 v37, v37
    v_exp_f32 v38, v38
    v_smfmac_f32_32x32x32_bf16 v[80:95], v[156:159], v[72:79], v30
    s_waitcnt vmcnt(21)
    ds_read_b128 v[144:147], v24 offset:63360
    v_exp_f32 v39, v39
    v_exp_f32 v40, v40
    v_exp_f32 v41, v41
    v_exp_f32 v42, v42
    v_exp_f32 v43, v43
    v_exp_f32 v44, v44
    v_exp_f32 v45, v45
    v_exp_f32 v46, v46
    v_exp_f32 v47, v47
    v_mfma_f32_32x32x16_bf16 v[64:79], v[148:151], v[20:23], v[128:143]
    s_waitcnt lgkmcnt(0)
    buffer_atomic_add v199, v198, s[8:11], s39 offen sc1
    v_exp_f32 v48, v48
    v_exp_f32 v49, v49
    v_exp_f32 v50, v50
    v_smfmac_f32_32x32x32_bf16 v[96:111], v[152:155], v[32:39], v30
    s_add_u32 s75, s72, 0
    s_add_u32 m0, s77, 4096
    ds_read_b128 v[160:163], v27 offset:61248
    v_exp_f32 v51, v51
    v_exp_f32 v52, v52
    v_exp_f32 v53, v53
    v_exp_f32 v54, v54
    v_smfmac_f32_32x32x32_bf16 v[96:111], v[156:159], v[40:47], v30
    buffer_load_dwordx4 v168, s[4:7], s75 offen lds
    buffer_load_dwordx4 v169, s[4:7], s75 offen offset:1024 lds
    s_add_u32 s75, s73, 0
    s_add_u32 m0, s77, 6144
    ds_read_b128 v[164:167], v27 offset:61792
    v_exp_f32 v55, v55
    v_exp_f32 v56, v56
    v_exp_f32 v57, v57
    v_exp_f32 v58, v58
    v_exp_f32 v59, v59
    v_exp_f32 v60, v60
    v_exp_f32 v61, v61
    v_exp_f32 v62, v62
    v_exp_f32 v63, v63
    v_mfma_f32_32x32x16_bf16 v[32:47], v[144:147], v[16:19], v[112:127]
    s_waitcnt lgkmcnt(0)
    s_waitcnt vmcnt(7)
    s_barrier
    v_exp_f32 v64, v64
    v_exp_f32 v65, v65
    v_exp_f32 v66, v66
    v_smfmac_f32_32x32x32_bf16 v[80:95], v[160:163], v[48:55], v30
    buffer_load_dwordx4 v168, s[4:7], s75 offen lds
    buffer_load_dwordx4 v169, s[4:7], s75 offen offset:1024 lds
    v_exp_f32 v67, v67
    v_exp_f32 v68, v68
    v_exp_f32 v69, v69
    v_exp_f32 v70, v70
    v_smfmac_f32_32x32x32_bf16 v[80:95], v[164:167], v[56:63], v30
    s_waitcnt vmcnt(5)
    ds_read_b128 v[148:151], v25 offset:0
    v_exp_f32 v71, v71
    v_exp_f32 v72, v72
    v_exp_f32 v73, v73
    v_exp_f32 v74, v74
    v_exp_f32 v75, v75
    v_exp_f32 v76, v76
    v_exp_f32 v77, v77
    v_exp_f32 v78, v78
    v_exp_f32 v79, v79
    v_mfma_f32_32x32x16_bf16 v[48:63], v[144:147], v[20:23], v[128:143]
    s_waitcnt lgkmcnt(0)
    ds_read_b128 a[0:3], v170 offset:0
    v_exp_f32 v32, v32
    v_exp_f32 v33, v33
    v_exp_f32 v34, v34
    v_smfmac_f32_32x32x32_bf16 v[96:111], v[160:163], v[64:71], v30
    s_add_u32 s75, s70, 128
    s_add_u32 m0, s77, 8192
    ds_read_b128 v[152:155], v27 offset:63360
    ds_read_b128 a[16:19], v171 offset:0
    v_exp_f32 v35, v35
    v_exp_f32 v36, v36
    v_exp_f32 v37, v37
    v_exp_f32 v38, v38
    v_smfmac_f32_32x32x32_bf16 v[96:111], v[164:167], v[72:79], v30
    buffer_load_dwordx4 v168, s[4:7], s75 offen lds
    buffer_load_dwordx4 v169, s[4:7], s75 offen offset:1024 lds
    s_add_u32 s75, s71, 128
    s_add_u32 m0, s77, 10240
    ds_read_b128 v[156:159], v27 offset:63904
    v_exp_f32 v39, v39
    v_exp_f32 v40, v40
    v_exp_f32 v41, v41
    v_exp_f32 v42, v42
    v_exp_f32 v43, v43
    v_exp_f32 v44, v44
    v_exp_f32 v45, v45
    v_exp_f32 v46, v46
    v_exp_f32 v47, v47
    v_mfma_f32_32x32x16_bf16 v[64:79], v[148:151], v[16:19], v[112:127]
    s_waitcnt lgkmcnt(0)
    ds_read_b128 a[4:7], v170 offset:2048
    v_exp_f32 v48, v48
    v_exp_f32 v49, v49
    v_exp_f32 v50, v50
    v_smfmac_f32_32x32x32_bf16 v[80:95], v[152:155], v[32:39], v30
    buffer_load_dwordx4 v168, s[4:7], s75 offen lds
    buffer_load_dwordx4 v169, s[4:7], s75 offen offset:1024 lds
    v_exp_f32 v51, v51
    v_exp_f32 v52, v52
    v_exp_f32 v53, v53
    v_exp_f32 v54, v54
    v_smfmac_f32_32x32x32_bf16 v[80:95], v[156:159], v[40:47], v30
    s_waitcnt vmcnt(4)
    ds_read_b128 v[144:147], v25 offset:2112
    ds_read_b128 a[20:23], v171 offset:2048
    v_exp_f32 v55, v55
    v_exp_f32 v56, v56
    v_exp_f32 v57, v57
    v_exp_f32 v58, v58
    v_exp_f32 v59, v59
    v_exp_f32 v60, v60
    v_exp_f32 v61, v61
    v_exp_f32 v62, v62
    v_exp_f32 v63, v63
    v_mfma_f32_32x32x16_bf16 v[32:47], v[148:151], v[20:23], v[128:143]
    s_waitcnt lgkmcnt(0)
    ds_read_b128 a[8:11], v170 offset:4096
    v_exp_f32 v64, v64
    v_exp_f32 v65, v65
    v_exp_f32 v66, v66
    v_smfmac_f32_32x32x32_bf16 v[96:111], v[152:155], v[48:55], v30
    s_add_u32 s75, s72, 128
    s_add_u32 m0, s77, 0
    ds_read_b128 v[160:163], v28 offset:0
    ds_read_b128 a[24:27], v171 offset:4096
    v_exp_f32 v67, v67
    v_exp_f32 v68, v68
    v_exp_f32 v69, v69
    v_exp_f32 v70, v70
    v_smfmac_f32_32x32x32_bf16 v[96:111], v[156:159], v[56:63], v30
    buffer_load_dwordx4 v168, s[4:7], s75 offen lds
    buffer_load_dwordx4 v169, s[4:7], s75 offen offset:1024 lds
    s_add_u32 s75, s73, 128
    s_add_u32 m0, s77, 2048
    ds_read_b128 v[164:167], v28 offset:544
    v_exp_f32 v71, v71
    v_exp_f32 v72, v72
    v_exp_f32 v73, v73
    v_exp_f32 v74, v74
    v_exp_f32 v75, v75
    v_exp_f32 v76, v76
    v_exp_f32 v77, v77
    v_exp_f32 v78, v78
    v_exp_f32 v79, v79
    v_mfma_f32_32x32x16_bf16 v[48:63], v[144:147], v[16:19], v[112:127]
    s_waitcnt lgkmcnt(0)
    ds_read_b128 a[12:15], v170 offset:6144
    v_exp_f32 v32, v32
    v_exp_f32 v33, v33
    v_exp_f32 v34, v34
    v_smfmac_f32_32x32x32_bf16 v[80:95], v[160:163], v[64:71], v30
    buffer_load_dwordx4 v168, s[4:7], s75 offen lds
    buffer_load_dwordx4 v169, s[4:7], s75 offen offset:1024 lds
    v_exp_f32 v35, v35
    v_exp_f32 v36, v36
    v_exp_f32 v37, v37
    v_exp_f32 v38, v38
    v_smfmac_f32_32x32x32_bf16 v[80:95], v[164:167], v[72:79], v30
    s_waitcnt vmcnt(4)
    ds_read_b128 v[148:151], v25 offset:4224
    ds_read_b128 a[28:31], v171 offset:6144
    v_exp_f32 v39, v39
    v_exp_f32 v40, v40
    v_exp_f32 v41, v41
    v_exp_f32 v42, v42
    v_exp_f32 v43, v43
    v_exp_f32 v44, v44
    v_exp_f32 v45, v45
    v_exp_f32 v46, v46
    v_exp_f32 v47, v47
    v_mfma_f32_32x32x16_bf16 v[64:79], v[144:147], v[20:23], v[128:143]
    s_waitcnt lgkmcnt(0)
    ds_read_b128 a[32:35], v170 offset:8192
    v_exp_f32 v48, v48
    v_exp_f32 v49, v49
    v_exp_f32 v50, v50
    v_smfmac_f32_32x32x32_bf16 v[96:111], v[160:163], v[32:39], v30
    s_add_u32 s75, s70, 256
    s_add_u32 m0, s77, 4096
    ds_read_b128 v[152:155], v28 offset:2112
    ds_read_b128 a[48:51], v171 offset:8192
    v_exp_f32 v51, v51
    v_exp_f32 v52, v52
    v_exp_f32 v53, v53
    v_exp_f32 v54, v54
    v_smfmac_f32_32x32x32_bf16 v[96:111], v[164:167], v[40:47], v30
    buffer_load_dwordx4 v168, s[4:7], s75 offen lds
    buffer_load_dwordx4 v169, s[4:7], s75 offen offset:1024 lds
    s_add_u32 s75, s71, 256
    s_add_u32 m0, s77, 6144
    ds_read_b128 v[156:159], v28 offset:2656
    v_exp_f32 v55, v55
    v_exp_f32 v56, v56
    v_exp_f32 v57, v57
    v_exp_f32 v58, v58
    v_exp_f32 v59, v59
    v_exp_f32 v60, v60
    v_exp_f32 v61, v61
    v_exp_f32 v62, v62
    v_exp_f32 v63, v63
    v_mfma_f32_32x32x16_bf16 v[32:47], v[148:151], v[16:19], v[112:127]
    s_waitcnt lgkmcnt(0)
    ds_read_b128 a[36:39], v170 offset:10240
    v_exp_f32 v64, v64
    v_exp_f32 v65, v65
    v_exp_f32 v66, v66
    v_smfmac_f32_32x32x32_bf16 v[80:95], v[152:155], v[48:55], v30
    buffer_load_dwordx4 v168, s[4:7], s75 offen lds
    buffer_load_dwordx4 v169, s[4:7], s75 offen offset:1024 lds
    v_exp_f32 v67, v67
    v_exp_f32 v68, v68
    v_exp_f32 v69, v69
    v_exp_f32 v70, v70
    v_smfmac_f32_32x32x32_bf16 v[80:95], v[156:159], v[56:63], v30
    s_waitcnt vmcnt(4)
    ds_read_b128 v[144:147], v25 offset:6336
    ds_read_b128 a[52:55], v171 offset:10240
    v_exp_f32 v71, v71
    v_exp_f32 v72, v72
    v_exp_f32 v73, v73
    v_exp_f32 v74, v74
    v_exp_f32 v75, v75
    v_exp_f32 v76, v76
    v_exp_f32 v77, v77
    v_exp_f32 v78, v78
    v_exp_f32 v79, v79
    v_mfma_f32_32x32x16_bf16 v[48:63], v[148:151], v[20:23], v[128:143]
    s_waitcnt lgkmcnt(0)
    ds_read_b128 a[40:43], v170 offset:0
    v_exp_f32 v32, v32
    v_exp_f32 v33, v33
    v_exp_f32 v34, v34
    v_smfmac_f32_32x32x32_bf16 v[96:111], v[152:155], v[64:71], v30
    s_add_u32 s75, s72, 256
    s_add_u32 m0, s77, 8192
    ds_read_b128 v[160:163], v28 offset:4224
    ds_read_b128 a[56:59], v171 offset:0
    v_exp_f32 v35, v35
    v_exp_f32 v36, v36
    v_exp_f32 v37, v37
    v_exp_f32 v38, v38
    v_smfmac_f32_32x32x32_bf16 v[96:111], v[156:159], v[72:79], v30
    buffer_load_dwordx4 v168, s[4:7], s75 offen lds
    buffer_load_dwordx4 v169, s[4:7], s75 offen offset:1024 lds
    s_add_u32 s75, s73, 256
    s_add_u32 m0, s77, 10240
    ds_read_b128 v[164:167], v28 offset:4768
    v_exp_f32 v39, v39
    v_exp_f32 v40, v40
    v_exp_f32 v41, v41
    v_exp_f32 v42, v42
    v_exp_f32 v43, v43
    v_exp_f32 v44, v44
    v_exp_f32 v45, v45
    v_exp_f32 v46, v46
    v_exp_f32 v47, v47
    v_mfma_f32_32x32x16_bf16 v[64:79], v[144:147], v[16:19], v[112:127]
    s_waitcnt lgkmcnt(0)
    s_barrier
    ds_read_b128 a[44:47], v170 offset:2048
    v_exp_f32 v48, v48
    v_exp_f32 v49, v49
    v_exp_f32 v50, v50
    v_smfmac_f32_32x32x32_bf16 v[80:95], v[160:163], v[32:39], v30
    buffer_load_dwordx4 v168, s[4:7], s75 offen lds
    buffer_load_dwordx4 v169, s[4:7], s75 offen offset:1024 lds
    v_exp_f32 v51, v51
    v_exp_f32 v52, v52
    v_exp_f32 v53, v53
    v_exp_f32 v54, v54
    v_smfmac_f32_32x32x32_bf16 v[80:95], v[164:167], v[40:47], v30
    s_waitcnt vmcnt(4)
    ds_read_b128 v[148:151], v25 offset:8448
    ds_read_b128 a[60:63], v171 offset:2048
    v_exp_f32 v55, v55
    v_exp_f32 v56, v56
    v_exp_f32 v57, v57
    v_exp_f32 v58, v58
    v_exp_f32 v59, v59
    v_exp_f32 v60, v60
    v_exp_f32 v61, v61
    v_exp_f32 v62, v62
    v_exp_f32 v63, v63
    v_mfma_f32_32x32x16_bf16 v[32:47], v[144:147], v[20:23], v[128:143]
    s_waitcnt lgkmcnt(0)
    ds_read_b128 a[64:67], v170 offset:4096
    v_exp_f32 v64, v64
    v_exp_f32 v65, v65
    v_exp_f32 v66, v66
    v_smfmac_f32_32x32x32_bf16 v[96:111], v[160:163], v[48:55], v30
    s_add_u32 s75, s70, 384
    s_add_u32 m0, s77, 0
    ds_read_b128 v[152:155], v28 offset:6336
    ds_read_b128 a[80:83], v171 offset:4096
    v_exp_f32 v67, v67
    v_exp_f32 v68, v68
    v_exp_f32 v69, v69
    v_exp_f32 v70, v70
    v_smfmac_f32_32x32x32_bf16 v[96:111], v[164:167], v[56:63], v30
    buffer_load_dwordx4 v168, s[4:7], s75 offen lds
    buffer_load_dwordx4 v169, s[4:7], s75 offen offset:1024 lds
    s_add_u32 s75, s71, 384
    s_add_u32 m0, s77, 2048
    ds_read_b128 v[156:159], v28 offset:6880
    v_exp_f32 v71, v71
    v_exp_f32 v72, v72
    v_exp_f32 v73, v73
    v_exp_f32 v74, v74
    v_exp_f32 v75, v75
    v_exp_f32 v76, v76
    v_exp_f32 v77, v77
    v_exp_f32 v78, v78
    v_exp_f32 v79, v79
    v_mfma_f32_32x32x16_bf16 v[48:63], v[148:151], v[16:19], v[112:127]
    s_waitcnt lgkmcnt(0)
    ds_read_b128 a[68:71], v170 offset:6144
    v_exp_f32 v32, v32
    v_exp_f32 v33, v33
    v_exp_f32 v34, v34
    v_smfmac_f32_32x32x32_bf16 v[80:95], v[152:155], v[64:71], v30
    buffer_load_dwordx4 v168, s[4:7], s75 offen lds
    buffer_load_dwordx4 v169, s[4:7], s75 offen offset:1024 lds
    v_exp_f32 v35, v35
    v_exp_f32 v36, v36
    v_exp_f32 v37, v37
    v_exp_f32 v38, v38
    v_smfmac_f32_32x32x32_bf16 v[80:95], v[156:159], v[72:79], v30
    s_waitcnt vmcnt(4)
    ds_read_b128 v[144:147], v25 offset:10560
    ds_read_b128 a[84:87], v171 offset:6144
    v_exp_f32 v39, v39
    v_exp_f32 v40, v40
    v_exp_f32 v41, v41
    v_exp_f32 v42, v42
    v_exp_f32 v43, v43
    v_exp_f32 v44, v44
    v_exp_f32 v45, v45
    v_exp_f32 v46, v46
    v_exp_f32 v47, v47
    v_mfma_f32_32x32x16_bf16 v[64:79], v[148:151], v[20:23], v[128:143]
    s_waitcnt lgkmcnt(0)
    ds_read_b128 a[72:75], v170 offset:8192
    v_exp_f32 v48, v48
    v_exp_f32 v49, v49
    v_exp_f32 v50, v50
    v_smfmac_f32_32x32x32_bf16 v[96:111], v[152:155], v[32:39], v30
    s_add_u32 s75, s72, 384
    s_add_u32 m0, s77, 4096
    ds_read_b128 v[160:163], v28 offset:8448
    ds_read_b128 a[88:91], v171 offset:8192
    v_exp_f32 v51, v51
    v_exp_f32 v52, v52
    v_exp_f32 v53, v53
    v_exp_f32 v54, v54
    v_smfmac_f32_32x32x32_bf16 v[96:111], v[156:159], v[40:47], v30
    buffer_load_dwordx4 v168, s[4:7], s75 offen lds
    buffer_load_dwordx4 v169, s[4:7], s75 offen offset:1024 lds
    s_add_u32 s75, s73, 384
    s_add_u32 m0, s77, 6144
    ds_read_b128 v[164:167], v28 offset:8992
    v_exp_f32 v55, v55
    v_exp_f32 v56, v56
    v_exp_f32 v57, v57
    v_exp_f32 v58, v58
    v_exp_f32 v59, v59
    v_exp_f32 v60, v60
    v_exp_f32 v61, v61
    v_exp_f32 v62, v62
    v_exp_f32 v63, v63
    v_mfma_f32_32x32x16_bf16 v[32:47], v[144:147], v[16:19], v[112:127]
    s_waitcnt lgkmcnt(0)
    ds_read_b128 a[76:79], v170 offset:10240
    v_exp_f32 v64, v64
    v_exp_f32 v65, v65
    v_exp_f32 v66, v66
    v_smfmac_f32_32x32x32_bf16 v[80:95], v[160:163], v[48:55], v30
    buffer_load_dwordx4 v168, s[4:7], s75 offen lds
    buffer_load_dwordx4 v169, s[4:7], s75 offen offset:1024 lds
    v_exp_f32 v67, v67
    v_exp_f32 v68, v68
    v_exp_f32 v69, v69
    v_exp_f32 v70, v70
    v_smfmac_f32_32x32x32_bf16 v[80:95], v[164:167], v[56:63], v30
    s_waitcnt vmcnt(4)
    ds_read_b128 v[148:151], v25 offset:12672
    ds_read_b128 a[92:95], v171 offset:10240
    v_exp_f32 v71, v71
    v_exp_f32 v72, v72
    v_exp_f32 v73, v73
    v_exp_f32 v74, v74
    v_exp_f32 v75, v75
    v_exp_f32 v76, v76
    v_exp_f32 v77, v77
    v_exp_f32 v78, v78
    v_exp_f32 v79, v79
    v_mfma_f32_32x32x16_bf16 v[48:63], v[144:147], v[20:23], v[128:143]
    s_waitcnt lgkmcnt(0)
    ds_read_b128 a[96:99], v170 offset:0
    v_exp_f32 v32, v32
    v_exp_f32 v33, v33
    v_exp_f32 v34, v34
    v_smfmac_f32_32x32x32_bf16 v[96:111], v[160:163], v[64:71], v30
    s_add_u32 s75, s70, 512
    s_add_u32 m0, s77, 8192
    ds_read_b128 v[152:155], v28 offset:10560
    ds_read_b128 a[112:115], v171 offset:0
    v_exp_f32 v35, v35
    v_exp_f32 v36, v36
    v_exp_f32 v37, v37
    v_exp_f32 v38, v38
    v_smfmac_f32_32x32x32_bf16 v[96:111], v[164:167], v[72:79], v30
    buffer_load_dwordx4 v168, s[4:7], s75 offen lds
    buffer_load_dwordx4 v169, s[4:7], s75 offen offset:1024 lds
    s_add_u32 s75, s71, 512
    s_add_u32 m0, s77, 10240
    ds_read_b128 v[156:159], v28 offset:11104
    v_exp_f32 v39, v39
    v_exp_f32 v40, v40
    v_exp_f32 v41, v41
    v_exp_f32 v42, v42
    v_exp_f32 v43, v43
    v_exp_f32 v44, v44
    v_exp_f32 v45, v45
    v_exp_f32 v46, v46
    v_exp_f32 v47, v47
    v_mfma_f32_32x32x16_bf16 v[64:79], v[148:151], v[16:19], v[112:127]
    s_waitcnt lgkmcnt(0)
    ds_read_b128 a[100:103], v170 offset:2048
    v_exp_f32 v48, v48
    v_exp_f32 v49, v49
    v_exp_f32 v50, v50
    v_smfmac_f32_32x32x32_bf16 v[80:95], v[152:155], v[32:39], v30
    buffer_load_dwordx4 v168, s[4:7], s75 offen lds
    buffer_load_dwordx4 v169, s[4:7], s75 offen offset:1024 lds
    v_exp_f32 v51, v51
    v_exp_f32 v52, v52
    v_exp_f32 v53, v53
    v_exp_f32 v54, v54
    v_smfmac_f32_32x32x32_bf16 v[80:95], v[156:159], v[40:47], v30
    s_waitcnt vmcnt(4)
    ds_read_b128 v[144:147], v25 offset:14784
    ds_read_b128 a[116:119], v171 offset:2048
    v_exp_f32 v55, v55
    v_exp_f32 v56, v56
    v_exp_f32 v57, v57
    v_exp_f32 v58, v58
    v_exp_f32 v59, v59
    v_exp_f32 v60, v60
    v_exp_f32 v61, v61
    v_exp_f32 v62, v62
    v_exp_f32 v63, v63
    v_mfma_f32_32x32x16_bf16 v[32:47], v[148:151], v[20:23], v[128:143]
    s_waitcnt lgkmcnt(0)
    ds_read_b128 a[104:107], v170 offset:4096
    v_exp_f32 v64, v64
    v_exp_f32 v65, v65
    v_exp_f32 v66, v66
    v_smfmac_f32_32x32x32_bf16 v[96:111], v[152:155], v[48:55], v30
    s_add_u32 s75, s72, 512
    s_add_u32 m0, s77, 0
    ds_read_b128 v[160:163], v28 offset:12672
    ds_read_b128 a[120:123], v171 offset:4096
    v_exp_f32 v67, v67
    v_exp_f32 v68, v68
    v_exp_f32 v69, v69
    v_exp_f32 v70, v70
    v_smfmac_f32_32x32x32_bf16 v[96:111], v[156:159], v[56:63], v30
    buffer_load_dwordx4 v168, s[4:7], s75 offen lds
    buffer_load_dwordx4 v169, s[4:7], s75 offen offset:1024 lds
    s_add_u32 s75, s73, 512
    s_add_u32 m0, s77, 2048
    ds_read_b128 v[164:167], v28 offset:13216
    v_exp_f32 v71, v71
    v_exp_f32 v72, v72
    v_exp_f32 v73, v73
    v_exp_f32 v74, v74
    v_exp_f32 v75, v75
    v_exp_f32 v76, v76
    v_exp_f32 v77, v77
    v_exp_f32 v78, v78
    v_exp_f32 v79, v79
    v_mfma_f32_32x32x16_bf16 v[48:63], v[144:147], v[16:19], v[112:127]
    s_waitcnt lgkmcnt(0)
    ds_read_b128 a[108:111], v170 offset:6144
    v_exp_f32 v32, v32
    v_exp_f32 v33, v33
    v_exp_f32 v34, v34
    v_smfmac_f32_32x32x32_bf16 v[80:95], v[160:163], v[64:71], v30
    buffer_load_dwordx4 v168, s[4:7], s75 offen lds
    buffer_load_dwordx4 v169, s[4:7], s75 offen offset:1024 lds
    v_exp_f32 v35, v35
    v_exp_f32 v36, v36
    v_exp_f32 v37, v37
    v_exp_f32 v38, v38
    v_smfmac_f32_32x32x32_bf16 v[80:95], v[164:167], v[72:79], v30
    s_waitcnt vmcnt(4)
    ds_read_b128 v[148:151], v25 offset:16896
    ds_read_b128 a[124:127], v171 offset:6144
    v_exp_f32 v39, v39
    v_exp_f32 v40, v40
    v_exp_f32 v41, v41
    v_exp_f32 v42, v42
    v_exp_f32 v43, v43
    v_exp_f32 v44, v44
    v_exp_f32 v45, v45
    v_exp_f32 v46, v46
    v_exp_f32 v47, v47
    v_mfma_f32_32x32x16_bf16 v[64:79], v[144:147], v[20:23], v[128:143]
    s_waitcnt lgkmcnt(0)
    ds_read_b128 a[128:131], v170 offset:8192
    v_exp_f32 v48, v48
    v_exp_f32 v49, v49
    v_exp_f32 v50, v50
    v_smfmac_f32_32x32x32_bf16 v[96:111], v[160:163], v[32:39], v30
    s_add_u32 s75, s70, 640
    s_add_u32 m0, s77, 4096
    ds_read_b128 v[152:155], v28 offset:14784
    ds_read_b128 a[144:147], v171 offset:8192
    v_exp_f32 v51, v51
    v_exp_f32 v52, v52
    v_exp_f32 v53, v53
    v_exp_f32 v54, v54
    v_smfmac_f32_32x32x32_bf16 v[96:111], v[164:167], v[40:47], v30
    buffer_load_dwordx4 v168, s[4:7], s75 offen lds
    buffer_load_dwordx4 v169, s[4:7], s75 offen offset:1024 lds
    s_add_u32 s75, s71, 640
    s_add_u32 m0, s77, 6144
    ds_read_b128 v[156:159], v28 offset:15328
    v_exp_f32 v55, v55
    v_exp_f32 v56, v56
    v_exp_f32 v57, v57
    v_exp_f32 v58, v58
    v_exp_f32 v59, v59
    v_exp_f32 v60, v60
    v_exp_f32 v61, v61
    v_exp_f32 v62, v62
    v_exp_f32 v63, v63
    v_mfma_f32_32x32x16_bf16 v[32:47], v[148:151], v[16:19], v[112:127]
    s_waitcnt lgkmcnt(0)
    ds_read_b128 a[132:135], v170 offset:10240
    v_exp_f32 v64, v64
    v_exp_f32 v65, v65
    v_exp_f32 v66, v66
    v_smfmac_f32_32x32x32_bf16 v[80:95], v[152:155], v[48:55], v30
    buffer_load_dwordx4 v168, s[4:7], s75 offen lds
    buffer_load_dwordx4 v169, s[4:7], s75 offen offset:1024 lds
    v_exp_f32 v67, v67
    v_exp_f32 v68, v68
    v_exp_f32 v69, v69
    v_exp_f32 v70, v70
    v_smfmac_f32_32x32x32_bf16 v[80:95], v[156:159], v[56:63], v30
    s_waitcnt vmcnt(4)
    ds_read_b128 v[144:147], v25 offset:19008
    ds_read_b128 a[148:151], v171 offset:10240
    v_exp_f32 v71, v71
    v_exp_f32 v72, v72
    v_exp_f32 v73, v73
    v_exp_f32 v74, v74
    v_exp_f32 v75, v75
    v_exp_f32 v76, v76
    v_exp_f32 v77, v77
    v_exp_f32 v78, v78
    v_exp_f32 v79, v79
    v_mfma_f32_32x32x16_bf16 v[48:63], v[148:151], v[20:23], v[128:143]
    s_waitcnt lgkmcnt(0)
    ds_read_b128 a[136:139], v170 offset:0
    v_exp_f32 v32, v32
    v_exp_f32 v33, v33
    v_exp_f32 v34, v34
    v_smfmac_f32_32x32x32_bf16 v[96:111], v[152:155], v[64:71], v30
    s_add_u32 s75, s72, 640
    s_add_u32 m0, s77, 8192
    ds_read_b128 v[160:163], v28 offset:16896
    ds_read_b128 a[152:155], v171 offset:0
    v_exp_f32 v35, v35
    v_exp_f32 v36, v36
    v_exp_f32 v37, v37
    v_exp_f32 v38, v38
    v_smfmac_f32_32x32x32_bf16 v[96:111], v[156:159], v[72:79], v30
    buffer_load_dwordx4 v168, s[4:7], s75 offen lds
    buffer_load_dwordx4 v169, s[4:7], s75 offen offset:1024 lds
    s_add_u32 s75, s73, 640
    s_add_u32 m0, s77, 10240
    ds_read_b128 v[164:167], v28 offset:17440
    v_exp_f32 v39, v39
    v_exp_f32 v40, v40
    v_exp_f32 v41, v41
    v_exp_f32 v42, v42
    v_exp_f32 v43, v43
    v_exp_f32 v44, v44
    v_exp_f32 v45, v45
    v_exp_f32 v46, v46
    v_exp_f32 v47, v47
    v_mfma_f32_32x32x16_bf16 v[64:79], v[144:147], v[16:19], v[112:127]
    s_waitcnt lgkmcnt(0)
    ds_read_b128 a[140:143], v170 offset:2048
    v_exp_f32 v48, v48
    v_exp_f32 v49, v49
    v_exp_f32 v50, v50
    v_smfmac_f32_32x32x32_bf16 v[80:95], v[160:163], v[32:39], v30
    buffer_load_dwordx4 v168, s[4:7], s75 offen lds
    buffer_load_dwordx4 v169, s[4:7], s75 offen offset:1024 lds
    v_exp_f32 v51, v51
    v_exp_f32 v52, v52
    v_exp_f32 v53, v53
    v_exp_f32 v54, v54
    v_smfmac_f32_32x32x32_bf16 v[80:95], v[164:167], v[40:47], v30
    s_waitcnt vmcnt(4)
    ds_read_b128 v[148:151], v25 offset:21120
    ds_read_b128 a[156:159], v171 offset:2048
    v_exp_f32 v55, v55
    v_exp_f32 v56, v56
    v_exp_f32 v57, v57
    v_exp_f32 v58, v58
    v_exp_f32 v59, v59
    v_exp_f32 v60, v60
    v_exp_f32 v61, v61
    v_exp_f32 v62, v62
    v_exp_f32 v63, v63
    v_mfma_f32_32x32x16_bf16 v[32:47], v[144:147], v[20:23], v[128:143]
    s_waitcnt lgkmcnt(0)
    ds_read_b128 a[160:163], v170 offset:4096
    v_exp_f32 v64, v64
    v_exp_f32 v65, v65
    v_exp_f32 v66, v66
    v_smfmac_f32_32x32x32_bf16 v[96:111], v[160:163], v[48:55], v30
    s_add_u32 s75, s70, 768
    s_add_u32 m0, s77, 0
    ds_read_b128 v[152:155], v28 offset:19008
    ds_read_b128 a[176:179], v171 offset:4096
    v_exp_f32 v67, v67
    v_exp_f32 v68, v68
    v_exp_f32 v69, v69
    v_exp_f32 v70, v70
    v_smfmac_f32_32x32x32_bf16 v[96:111], v[164:167], v[56:63], v30
    buffer_load_dwordx4 v168, s[4:7], s75 offen lds
    buffer_load_dwordx4 v169, s[4:7], s75 offen offset:1024 lds
    s_add_u32 s75, s71, 768
    s_add_u32 m0, s77, 2048
    ds_read_b128 v[156:159], v28 offset:19552
    v_exp_f32 v71, v71
    v_exp_f32 v72, v72
    v_exp_f32 v73, v73
    v_exp_f32 v74, v74
    v_exp_f32 v75, v75
    v_exp_f32 v76, v76
    v_exp_f32 v77, v77
    v_exp_f32 v78, v78
    v_exp_f32 v79, v79
    v_mfma_f32_32x32x16_bf16 v[48:63], v[148:151], v[16:19], v[112:127]
    s_waitcnt lgkmcnt(0)
    ds_read_b128 a[164:167], v170 offset:6144
    v_exp_f32 v32, v32
    v_exp_f32 v33, v33
    v_exp_f32 v34, v34
    v_smfmac_f32_32x32x32_bf16 v[80:95], v[152:155], v[64:71], v30
    buffer_load_dwordx4 v168, s[4:7], s75 offen lds
    buffer_load_dwordx4 v169, s[4:7], s75 offen offset:1024 lds
    v_exp_f32 v35, v35
    v_exp_f32 v36, v36
    v_exp_f32 v37, v37
    v_exp_f32 v38, v38
    v_smfmac_f32_32x32x32_bf16 v[80:95], v[156:159], v[72:79], v30
    s_waitcnt vmcnt(4)
    ds_read_b128 v[144:147], v25 offset:23232
    ds_read_b128 a[180:183], v171 offset:6144
    v_exp_f32 v39, v39
    v_exp_f32 v40, v40
    v_exp_f32 v41, v41
    v_exp_f32 v42, v42
    v_exp_f32 v43, v43
    v_exp_f32 v44, v44
    v_exp_f32 v45, v45
    v_exp_f32 v46, v46
    v_exp_f32 v47, v47
    v_mfma_f32_32x32x16_bf16 v[64:79], v[148:151], v[20:23], v[128:143]
    s_waitcnt lgkmcnt(0)
    ds_read_b128 a[168:171], v170 offset:8192
    v_exp_f32 v48, v48
    v_exp_f32 v49, v49
    v_exp_f32 v50, v50
    v_smfmac_f32_32x32x32_bf16 v[96:111], v[152:155], v[32:39], v30
    s_add_u32 s75, s72, 768
    s_add_u32 m0, s77, 4096
    ds_read_b128 v[160:163], v28 offset:21120
    ds_read_b128 a[184:187], v171 offset:8192
    v_exp_f32 v51, v51
    v_exp_f32 v52, v52
    v_exp_f32 v53, v53
    v_exp_f32 v54, v54
    v_smfmac_f32_32x32x32_bf16 v[96:111], v[156:159], v[40:47], v30
    buffer_load_dwordx4 v168, s[4:7], s75 offen lds
    buffer_load_dwordx4 v169, s[4:7], s75 offen offset:1024 lds
    s_add_u32 s75, s73, 768
    s_add_u32 m0, s77, 6144
    ds_read_b128 v[164:167], v28 offset:21664
    v_exp_f32 v55, v55
    v_exp_f32 v56, v56
    v_exp_f32 v57, v57
    v_exp_f32 v58, v58
    v_exp_f32 v59, v59
    v_exp_f32 v60, v60
    v_exp_f32 v61, v61
    v_exp_f32 v62, v62
    v_exp_f32 v63, v63
    v_mfma_f32_32x32x16_bf16 v[32:47], v[144:147], v[16:19], v[112:127]
    s_waitcnt lgkmcnt(0)
    buffer_load_dword v201, v174, s[8:11], s27 offen sc1
    ds_read_b128 a[172:175], v170 offset:10240
    v_exp_f32 v64, v64
    v_exp_f32 v65, v65
    v_exp_f32 v66, v66
    v_smfmac_f32_32x32x32_bf16 v[80:95], v[160:163], v[48:55], v30
    buffer_load_dwordx4 v168, s[4:7], s75 offen lds
    buffer_load_dwordx4 v169, s[4:7], s75 offen offset:1024 lds
    v_exp_f32 v67, v67
    v_exp_f32 v68, v68
    v_exp_f32 v69, v69
    v_exp_f32 v70, v70
    v_smfmac_f32_32x32x32_bf16 v[80:95], v[164:167], v[56:63], v30
    s_waitcnt vmcnt(5)
    ds_read_b128 v[148:151], v25 offset:25344
    ds_read_b128 a[188:191], v171 offset:10240
    v_exp_f32 v71, v71
    v_exp_f32 v72, v72
    v_exp_f32 v73, v73
    v_exp_f32 v74, v74
    v_exp_f32 v75, v75
    v_exp_f32 v76, v76
    v_exp_f32 v77, v77
    v_exp_f32 v78, v78
    v_exp_f32 v79, v79
    v_mfma_f32_32x32x16_bf16 v[48:63], v[144:147], v[20:23], v[128:143]
    s_waitcnt lgkmcnt(0)
    ds_read_b128 a[192:195], v170 offset:0
    v_exp_f32 v32, v32
    v_exp_f32 v33, v33
    v_exp_f32 v34, v34
    v_smfmac_f32_32x32x32_bf16 v[96:111], v[160:163], v[64:71], v30
    s_add_u32 s75, s70, 896
    s_add_u32 m0, s77, 8192
    ds_read_b128 v[152:155], v28 offset:23232
    ds_read_b128 a[208:211], v171 offset:0
    v_exp_f32 v35, v35
    v_exp_f32 v36, v36
    v_exp_f32 v37, v37
    v_exp_f32 v38, v38
    v_smfmac_f32_32x32x32_bf16 v[96:111], v[164:167], v[72:79], v30
    buffer_load_dwordx4 v168, s[4:7], s75 offen lds
    buffer_load_dwordx4 v169, s[4:7], s75 offen offset:1024 lds
    s_add_u32 s75, s71, 896
    s_add_u32 m0, s77, 10240
    ds_read_b128 v[156:159], v28 offset:23776
    v_exp_f32 v39, v39
    v_exp_f32 v40, v40
    v_exp_f32 v41, v41
    v_exp_f32 v42, v42
    v_exp_f32 v43, v43
    v_exp_f32 v44, v44
    v_exp_f32 v45, v45
    v_exp_f32 v46, v46
    v_exp_f32 v47, v47
    v_mfma_f32_32x32x16_bf16 v[64:79], v[148:151], v[16:19], v[112:127]
    s_waitcnt lgkmcnt(0)
    ds_read_b128 a[196:199], v170 offset:2048
    v_exp_f32 v48, v48
    v_exp_f32 v49, v49
    v_exp_f32 v50, v50
    v_smfmac_f32_32x32x32_bf16 v[80:95], v[152:155], v[32:39], v30
    buffer_load_dwordx4 v168, s[4:7], s75 offen lds
    buffer_load_dwordx4 v169, s[4:7], s75 offen offset:1024 lds
    v_exp_f32 v51, v51
    v_exp_f32 v52, v52
    v_exp_f32 v53, v53
    v_exp_f32 v54, v54
    v_smfmac_f32_32x32x32_bf16 v[80:95], v[156:159], v[40:47], v30
    s_waitcnt vmcnt(4)
    ds_read_b128 v[144:147], v25 offset:27456
    ds_read_b128 a[212:215], v171 offset:2048
    v_exp_f32 v55, v55
    v_exp_f32 v56, v56
    v_exp_f32 v57, v57
    v_exp_f32 v58, v58
    v_exp_f32 v59, v59
    v_exp_f32 v60, v60
    v_exp_f32 v61, v61
    v_exp_f32 v62, v62
    v_exp_f32 v63, v63
    v_mfma_f32_32x32x16_bf16 v[32:47], v[148:151], v[20:23], v[128:143]
    s_waitcnt lgkmcnt(0)
    s_waitcnt vmcnt(6)
    v_cmp_gt_u32 vcc, 32, v201
    s_nop 1
    s_and_b32 s3, vcc_lo, 15
    s_cbranch_scc1 L_pwait
L_pok:
    ds_read_b128 a[200:203], v170 offset:4096
    v_exp_f32 v64, v64
    v_exp_f32 v65, v65
    v_exp_f32 v66, v66
    v_smfmac_f32_32x32x32_bf16 v[96:111], v[152:155], v[48:55], v30
    s_add_u32 s75, s72, 896
    s_add_u32 m0, s77, 0
    ds_read_b128 v[160:163], v28 offset:25344
    ds_read_b128 a[216:219], v171 offset:4096
    v_exp_f32 v67, v67
    v_exp_f32 v68, v68
    v_exp_f32 v69, v69
    v_exp_f32 v70, v70
    v_smfmac_f32_32x32x32_bf16 v[96:111], v[156:159], v[56:63], v30
    buffer_load_dwordx4 v168, s[4:7], s75 offen lds
    buffer_load_dwordx4 v169, s[4:7], s75 offen offset:1024 lds
    s_add_u32 s75, s73, 896
    s_add_u32 m0, s77, 2048
    ds_read_b128 v[164:167], v28 offset:25888
    v_exp_f32 v71, v71
    v_exp_f32 v72, v72
    v_exp_f32 v73, v73
    v_exp_f32 v74, v74
    v_exp_f32 v75, v75
    v_exp_f32 v76, v76
    v_exp_f32 v77, v77
    v_exp_f32 v78, v78
    v_exp_f32 v79, v79
    v_mfma_f32_32x32x16_bf16 v[48:63], v[144:147], v[16:19], v[112:127]
    s_waitcnt lgkmcnt(0)
    ds_read_b128 a[204:207], v170 offset:6144
    v_exp_f32 v32, v32
    v_exp_f32 v33, v33
    v_exp_f32 v34, v34
    v_smfmac_f32_32x32x32_bf16 v[80:95], v[160:163], v[64:71], v30
    buffer_load_dwordx4 v168, s[4:7], s75 offen lds
    buffer_load_dwordx4 v169, s[4:7], s75 offen offset:1024 lds
    v_exp_f32 v35, v35
    v_exp_f32 v36, v36
    v_exp_f32 v37, v37
    v_exp_f32 v38, v38
    v_smfmac_f32_32x32x32_bf16 v[80:95], v[164:167], v[72:79], v30
    s_waitcnt vmcnt(4)
    ds_read_b128 v[148:151], v25 offset:29568
    ds_read_b128 a[220:223], v171 offset:6144
    v_exp_f32 v39, v39
    v_exp_f32 v40, v40
    v_exp_f32 v41, v41
    v_exp_f32 v42, v42
    v_exp_f32 v43, v43
    v_exp_f32 v44, v44
    v_exp_f32 v45, v45
    v_exp_f32 v46, v46
    v_exp_f32 v47, v47
    v_mfma_f32_32x32x16_bf16 v[64:79], v[144:147], v[20:23], v[128:143]
    s_waitcnt lgkmcnt(0)
    ds_read_b128 a[224:227], v170 offset:8192
    v_exp_f32 v48, v48
    v_exp_f32 v49, v49
    v_exp_f32 v50, v50
    v_smfmac_f32_32x32x32_bf16 v[96:111], v[160:163], v[32:39], v30
    s_add_u32 s74, s21, 0
    s_and_b32 s74, s74, 15
    s_add_u32 s74, s74, s22
    s_mul_i32 s74, s74, 7168
    s_add_u32 s74, s74, 16891904
    s_mul_i32 s75, s48, 7168
    s_add_u32 s75, s75, 65536
    ds_read_b128 v[152:155], v28 offset:27456
    ds_read_b128 a[240:243], v171 offset:8192
    v_exp_f32 v51, v51
    v_exp_f32 v52, v52
    v_exp_f32 v53, v53
    v_exp_f32 v54, v54
    v_smfmac_f32_32x32x32_bf16 v[96:111], v[164:167], v[40:47], v30
    s_mov_b32 m0, s75
    ds_read_b128 v[156:159], v28 offset:28000
    v_exp_f32 v55, v55
    v_exp_f32 v56, v56
    v_exp_f32 v57, v57
    v_exp_f32 v58, v58
    v_exp_f32 v59, v59
    v_exp_f32 v60, v60
    v_exp_f32 v61, v61
    v_exp_f32 v62, v62
    v_exp_f32 v63, v63
    v_mfma_f32_32x32x16_bf16 v[32:47], v[148:151], v[16:19], v[112:127]
    s_waitcnt lgkmcnt(0)
    ds_read_b128 a[228:231], v170 offset:10240
    v_exp_f32 v64, v64
    v_exp_f32 v65, v65
    v_exp_f32 v66, v66
    v_smfmac_f32_32x32x32_bf16 v[80:95], v[152:155], v[48:55], v30
    buffer_load_dwordx4 v3, s[8:11], s74 offen offset:0 sc1 lds
    buffer_load_dwordx4 v3, s[8:11], s74 offen offset:1024 sc1 lds
    v_exp_f32 v67, v67
    v_exp_f32 v68, v68
    v_exp_f32 v69, v69
    v_exp_f32 v70, v70
    v_smfmac_f32_32x32x32_bf16 v[80:95], v[156:159], v[56:63], v30
    s_waitcnt vmcnt(2)
    ds_read_b128 v[144:147], v25 offset:31680
    ds_read_b128 a[244:247], v171 offset:10240
    v_exp_f32 v71, v71
    v_exp_f32 v72, v72
    v_exp_f32 v73, v73
    v_exp_f32 v74, v74
    v_exp_f32 v75, v75
    v_exp_f32 v76, v76
    v_exp_f32 v77, v77
    v_exp_f32 v78, v78
    v_exp_f32 v79, v79
    v_mfma_f32_32x32x16_bf16 v[48:63], v[148:151], v[20:23], v[128:143]
    s_waitcnt lgkmcnt(0)
    ds_read_b128 a[232:235], v170 offset:0
    v_exp_f32 v32, v32
    v_exp_f32 v33, v33
    v_exp_f32 v34, v34
    v_smfmac_f32_32x32x32_bf16 v[96:111], v[152:155], v[64:71], v30
    ds_read_b128 v[160:163], v28 offset:29568
    ds_read_b128 a[248:251], v171 offset:0
    v_exp_f32 v35, v35
    v_exp_f32 v36, v36
    v_exp_f32 v37, v37
    v_exp_f32 v38, v38
    v_smfmac_f32_32x32x32_bf16 v[96:111], v[156:159], v[72:79], v30
    s_mov_b32 m0, s75
    ds_read_b128 v[164:167], v28 offset:30112
    v_exp_f32 v39, v39
    v_exp_f32 v40, v40
    v_exp_f32 v41, v41
    v_exp_f32 v42, v42
    v_exp_f32 v43, v43
    v_exp_f32 v44, v44
    v_exp_f32 v45, v45
    v_exp_f32 v46, v46
    v_exp_f32 v47, v47
    v_mfma_f32_32x32x16_bf16 v[64:79], v[144:147], v[16:19], v[112:127]
    s_waitcnt lgkmcnt(0)
    ds_read_b128 a[236:239], v170 offset:2048
    v_exp_f32 v48, v48
    v_exp_f32 v49, v49
    v_exp_f32 v50, v50
    v_smfmac_f32_32x32x32_bf16 v[80:95], v[160:163], v[32:39], v30
    buffer_load_dwordx4 v3, s[8:11], s74 offen offset:2048 sc1 lds
    buffer_load_dwordx4 v3, s[8:11], s74 offen offset:3072 sc1 lds
    s_add_u32 s74, s74, 4096
    s_add_u32 s75, s75, 4096
    v_exp_f32 v51, v51
    v_exp_f32 v52, v52
    v_exp_f32 v53, v53
    v_exp_f32 v54, v54
    v_smfmac_f32_32x32x32_bf16 v[80:95], v[164:167], v[40:47], v30
    ds_read_b128 v[148:151], v25 offset:33792
    ds_read_b128 a[252:255], v171 offset:2048
    v_exp_f32 v55, v55
    v_exp_f32 v56, v56
    v_exp_f32 v57, v57
    v_exp_f32 v58, v58
    v_exp_f32 v59, v59
    v_exp_f32 v60, v60
    v_exp_f32 v61, v61
    v_exp_f32 v62, v62
    v_exp_f32 v63, v63
    v_mfma_f32_32x32x16_bf16 v[32:47], v[144:147], v[20:23], v[128:143]
    s_waitcnt lgkmcnt(0)
    v_exp_f32 v64, v64
    v_exp_f32 v65, v65
    v_exp_f32 v66, v66
    v_smfmac_f32_32x32x32_bf16 v[96:111], v[160:163], v[48:55], v30
    ds_read_b128 v[152:155], v28 offset:31680
    v_exp_f32 v67, v67
    v_exp_f32 v68, v68
    v_exp_f32 v69, v69
    v_exp_f32 v70, v70
    v_smfmac_f32_32x32x32_bf16 v[96:111], v[164:167], v[56:63], v30
    s_mov_b32 m0, s75
    ds_read_b128 v[156:159], v28 offset:32224
    v_exp_f32 v71, v71
    v_exp_f32 v72, v72
    v_exp_f32 v73, v73
    v_exp_f32 v74, v74
    v_exp_f32 v75, v75
    v_exp_f32 v76, v76
    v_exp_f32 v77, v77
    v_exp_f32 v78, v78
    v_exp_f32 v79, v79
    v_mfma_f32_32x32x16_bf16 v[48:63], v[148:151], v[16:19], v[112:127]
    s_waitcnt lgkmcnt(0)
    s_barrier
    v_exp_f32 v32, v32
    v_exp_f32 v33, v33
    v_exp_f32 v34, v34
    v_smfmac_f32_32x32x32_bf16 v[80:95], v[152:155], v[64:71], v30
    buffer_load_dwordx4 v3, s[8:11], s74 offen offset:0 sc1 lds
    buffer_load_dwordx4 v3, s[8:11], s74 offen offset:1024 sc1 lds
    v_exp_f32 v35, v35
    v_exp_f32 v36, v36
    v_exp_f32 v37, v37
    v_exp_f32 v38, v38
    v_smfmac_f32_32x32x32_bf16 v[80:95], v[156:159], v[72:79], v30
    s_and_b32 s23, s46, 3
    s_lshl_b32 s23, s23, 2
    ds_read_b128 v[144:147], v25 offset:35904
    v_exp_f32 v39, v39
    v_exp_f32 v40, v40
    v_exp_f32 v41, v41
    v_exp_f32 v42, v42
    v_exp_f32 v43, v43
    v_exp_f32 v44, v44
    v_exp_f32 v45, v45
    v_exp_f32 v46, v46
    v_exp_f32 v47, v47
    v_mfma_f32_32x32x16_bf16 v[64:79], v[148:151], v[20:23], v[128:143]
    s_waitcnt lgkmcnt(0)
    v_exp_f32 v48, v48
    v_exp_f32 v49, v49
    v_exp_f32 v50, v50
    v_smfmac_f32_32x32x32_bf16 v[96:111], v[152:155], v[32:39], v30
    s_add_u32 s23, s23, s48
    s_lshl_b32 s3, s47, 5
    ds_read_b128 v[160:163], v28 offset:33792
    v_exp_f32 v51, v51
    v_exp_f32 v52, v52
    v_exp_f32 v53, v53
    v_exp_f32 v54, v54
    v_smfmac_f32_32x32x32_bf16 v[96:111], v[156:159], v[40:47], v30
    s_mov_b32 m0, s75
    s_add_u32 s23, s23, s3
    s_mul_i32 s23, s23, 7168
    ds_read_b128 v[164:167], v28 offset:34336
    v_exp_f32 v55, v55
    v_exp_f32 v56, v56
    v_exp_f32 v57, v57
    v_exp_f32 v58, v58
    v_exp_f32 v59, v59
    v_exp_f32 v60, v60
    v_exp_f32 v61, v61
    v_exp_f32 v62, v62
    v_exp_f32 v63, v63
    v_mfma_f32_32x32x16_bf16 v[32:47], v[144:147], v[16:19], v[112:127]
    s_waitcnt lgkmcnt(0)
    buffer_load_dword v201, v196, s[8:11], s38 offen sc1
    v_exp_f32 v64, v64
    v_exp_f32 v65, v65
    v_exp_f32 v66, v66
    v_smfmac_f32_32x32x32_bf16 v[80:95], v[160:163], v[48:55], v30
    buffer_load_dwordx4 v3, s[8:11], s74 offen offset:2048 sc1 lds
    v_exp_f32 v67, v67
    v_exp_f32 v68, v68
    v_exp_f32 v69, v69
    v_exp_f32 v70, v70
    v_smfmac_f32_32x32x32_bf16 v[80:95], v[164:167], v[56:63], v30
    s_add_u32 s23, s23, 16777216
    ds_read_b128 v[148:151], v25 offset:38016
    v_exp_f32 v71, v71
    v_exp_f32 v72, v72
    v_exp_f32 v73, v73
    v_exp_f32 v74, v74
    v_exp_f32 v75, v75
    v_exp_f32 v76, v76
    v_exp_f32 v77, v77
    v_exp_f32 v78, v78
    v_exp_f32 v79, v79
    v_mfma_f32_32x32x16_bf16 v[48:63], v[144:147], v[20:23], v[128:143]
    s_waitcnt lgkmcnt(0)
    v_exp_f32 v32, v32
    v_exp_f32 v33, v33
    v_exp_f32 v34, v34
    v_smfmac_f32_32x32x32_bf16 v[96:111], v[160:163], v[64:71], v30
    s_lshl_b32 s76, s48, 12
    s_and_b32 s74, s1, 0xffff
    s_add_u32 s74, s74, s69
    ds_read_b128 v[152:155], v28 offset:35904
    v_exp_f32 v35, v35
    v_exp_f32 v36, v36
    v_exp_f32 v37, v37
    v_exp_f32 v38, v38
    v_smfmac_f32_32x32x32_bf16 v[96:111], v[164:167], v[72:79], v30
    buffer_load_dword v200, v175, s[8:11], s23 offen sc1
    s_mov_b32 m0, s76
    ds_read_b128 v[156:159], v28 offset:36448
    v_exp_f32 v39, v39
    v_exp_f32 v40, v40
    v_exp_f32 v41, v41
    v_exp_f32 v42, v42
    v_exp_f32 v43, v43
    v_exp_f32 v44, v44
    v_exp_f32 v45, v45
    v_exp_f32 v46, v46
    v_exp_f32 v47, v47
    v_mfma_f32_32x32x16_bf16 v[64:79], v[148:151], v[16:19], v[112:127]
    s_waitcnt lgkmcnt(0)
    v_exp_f32 v48, v48
    v_exp_f32 v49, v49
    v_exp_f32 v50, v50
    v_smfmac_f32_32x32x32_bf16 v[80:95], v[152:155], v[32:39], v30
    buffer_load_dwordx4 v3, s[8:11], s74 offen offset:0 sc1 lds
    buffer_load_dwordx4 v3, s[8:11], s74 offen offset:1024 sc1 lds
    v_exp_f32 v51, v51
    v_exp_f32 v52, v52
    v_exp_f32 v53, v53
    v_exp_f32 v54, v54
    v_smfmac_f32_32x32x32_bf16 v[80:95], v[156:159], v[40:47], v30
    s_add_u32 s23, s23, 1792
    ds_read_b128 v[144:147], v25 offset:40128
    v_exp_f32 v55, v55
    v_exp_f32 v56, v56
    v_exp_f32 v57, v57
    v_exp_f32 v58, v58
    v_exp_f32 v59, v59
    v_exp_f32 v60, v60
    v_exp_f32 v61, v61
    v_exp_f32 v62, v62
    v_exp_f32 v63, v63
    v_mfma_f32_32x32x16_bf16 v[32:47], v[148:151], v[20:23], v[128:143]
    s_waitcnt lgkmcnt(0)
    v_exp_f32 v64, v64
    v_exp_f32 v65, v65
    v_exp_f32 v66, v66
    v_smfmac_f32_32x32x32_bf16 v[96:111], v[152:155], v[48:55], v30
    ds_read_b128 v[160:163], v28 offset:38016
    v_exp_f32 v67, v67
    v_exp_f32 v68, v68
    v_exp_f32 v69, v69
    v_exp_f32 v70, v70
    v_smfmac_f32_32x32x32_bf16 v[96:111], v[156:159], v[56:63], v30
    s_mov_b32 m0, s76
    ds_read_b128 v[164:167], v28 offset:38560
    v_exp_f32 v71, v71
    v_exp_f32 v72, v72
    v_exp_f32 v73, v73
    v_exp_f32 v74, v74
    v_exp_f32 v75, v75
    v_exp_f32 v76, v76
    v_exp_f32 v77, v77
    v_exp_f32 v78, v78
    v_exp_f32 v79, v79
    v_mfma_f32_32x32x16_bf16 v[48:63], v[144:147], v[16:19], v[112:127]
    s_waitcnt lgkmcnt(0)
    v_exp_f32 v32, v32
    v_exp_f32 v33, v33
    v_exp_f32 v34, v34
    v_smfmac_f32_32x32x32_bf16 v[80:95], v[160:163], v[64:71], v30
    buffer_load_dwordx4 v3, s[8:11], s74 offen offset:2048 sc1 lds
    buffer_load_dwordx4 v3, s[8:11], s74 offen offset:3072 sc1 lds
    s_add_u32 s1, s1, 16384
    s_add_u32 s76, s76, 16384
    v_exp_f32 v35, v35
    v_exp_f32 v36, v36
    v_exp_f32 v37, v37
    v_exp_f32 v38, v38
    v_smfmac_f32_32x32x32_bf16 v[80:95], v[164:167], v[72:79], v30
    ds_read_b128 v[148:151], v25 offset:42240
    v_exp_f32 v39, v39
    v_exp_f32 v40, v40
    v_exp_f32 v41, v41
    v_exp_f32 v42, v42
    v_exp_f32 v43, v43
    v_exp_f32 v44, v44
    v_exp_f32 v45, v45
    v_exp_f32 v46, v46
    v_exp_f32 v47, v47
    v_mfma_f32_32x32x16_bf16 v[64:79], v[144:147], v[20:23], v[128:143]
    s_waitcnt lgkmcnt(0)
    s_waitcnt vmcnt(6)
    v_cmp_gt_u32 vcc, 32, v201
    s_nop 1
    s_cmp_lg_u32 vcc_lo, 0
    s_cbranch_scc1 L_gwait
L_gok:
    buffer_load_dwordx4 v[204:207], v216, s[8:11], s25 offen sc1
    v_exp_f32 v48, v48
    v_exp_f32 v49, v49
    v_exp_f32 v50, v50
    v_smfmac_f32_32x32x32_bf16 v[96:111], v[160:163], v[32:39], v30
    s_and_b32 s74, s1, 0xffff
    s_add_u32 s74, s74, s69
    ds_read_b128 v[152:155], v28 offset:40128
    v_exp_f32 v51, v51
    v_exp_f32 v52, v52
    v_exp_f32 v53, v53
    v_exp_f32 v54, v54
    v_smfmac_f32_32x32x32_bf16 v[96:111], v[164:167], v[40:47], v30
    s_mov_b32 m0, s76
    ds_read_b128 v[156:159], v28 offset:40672
    v_exp_f32 v55, v55
    v_exp_f32 v56, v56
    v_exp_f32 v57, v57
    v_exp_f32 v58, v58
    v_exp_f32 v59, v59
    v_exp_f32 v60, v60
    v_exp_f32 v61, v61
    v_exp_f32 v62, v62
    v_exp_f32 v63, v63
    v_mfma_f32_32x32x16_bf16 v[32:47], v[148:151], v[16:19], v[112:127]
    s_waitcnt lgkmcnt(0)
    buffer_load_dwordx4 v[208:211], v216, s[8:11], s25 offen offset:64 sc1
    v_exp_f32 v64, v64
    v_exp_f32 v65, v65
    v_exp_f32 v66, v66
    v_smfmac_f32_32x32x32_bf16 v[80:95], v[152:155], v[48:55], v30
    buffer_load_dwordx4 v3, s[8:11], s74 offen offset:0 sc1 lds
    buffer_load_dwordx4 v3, s[8:11], s74 offen offset:1024 sc1 lds
    v_exp_f32 v67, v67
    v_exp_f32 v68, v68
    v_exp_f32 v69, v69
    v_exp_f32 v70, v70
    v_smfmac_f32_32x32x32_bf16 v[80:95], v[156:159], v[56:63], v30
    ds_read_b128 v[144:147], v25 offset:44352
    v_exp_f32 v71, v71
    v_exp_f32 v72, v72
    v_exp_f32 v73, v73
    v_exp_f32 v74, v74
    v_exp_f32 v75, v75
    v_exp_f32 v76, v76
    v_exp_f32 v77, v77
    v_exp_f32 v78, v78
    v_exp_f32 v79, v79
    v_mfma_f32_32x32x16_bf16 v[48:63], v[148:151], v[20:23], v[128:143]
    s_waitcnt lgkmcnt(0)
    v_exp_f32 v32, v32
    v_exp_f32 v33, v33
    v_exp_f32 v34, v34
    v_smfmac_f32_32x32x32_bf16 v[96:111], v[152:155], v[64:71], v30
    ds_read_b128 v[160:163], v28 offset:42240
    v_exp_f32 v35, v35
    v_exp_f32 v36, v36
    v_exp_f32 v37, v37
    v_exp_f32 v38, v38
    v_smfmac_f32_32x32x32_bf16 v[96:111], v[156:159], v[72:79], v30
    buffer_load_dword v200, v175, s[8:11], s23 offen sc1
    s_mov_b32 m0, s76
    ds_read_b128 v[164:167], v28 offset:42784
    v_exp_f32 v39, v39
    v_exp_f32 v40, v40
    v_exp_f32 v41, v41
    v_exp_f32 v42, v42
    v_exp_f32 v43, v43
    v_exp_f32 v44, v44
    v_exp_f32 v45, v45
    v_exp_f32 v46, v46
    v_exp_f32 v47, v47
    v_mfma_f32_32x32x16_bf16 v[64:79], v[144:147], v[16:19], v[112:127]
    s_waitcnt lgkmcnt(0)
    buffer_load_dwordx4 v[220:223], v218, s[8:11], s18 offen offset:0 sc1
    v_exp_f32 v48, v48
    v_exp_f32 v49, v49
    v_exp_f32 v50, v50
    v_smfmac_f32_32x32x32_bf16 v[80:95], v[160:163], v[32:39], v30
    buffer_load_dwordx4 v3, s[8:11], s74 offen offset:2048 sc1 lds
    buffer_load_dwordx4 v3, s[8:11], s74 offen offset:3072 sc1 lds
    s_add_u32 s1, s1, 16384
    s_add_u32 s76, s76, 16384
    v_exp_f32 v51, v51
    v_exp_f32 v52, v52
    v_exp_f32 v53, v53
    v_exp_f32 v54, v54
    v_smfmac_f32_32x32x32_bf16 v[80:95], v[164:167], v[40:47], v30
    s_add_u32 s23, s23, 1792
    ds_read_b128 v[148:151], v25 offset:46464
    v_exp_f32 v55, v55
    v_exp_f32 v56, v56
    v_exp_f32 v57, v57
    v_exp_f32 v58, v58
    v_exp_f32 v59, v59
    v_exp_f32 v60, v60
    v_exp_f32 v61, v61
    v_exp_f32 v62, v62
    v_exp_f32 v63, v63
    v_mfma_f32_32x32x16_bf16 v[32:47], v[144:147], v[20:23], v[128:143]
    s_waitcnt lgkmcnt(0)
    v_exp_f32 v64, v64
    v_exp_f32 v65, v65
    v_exp_f32 v66, v66
    v_smfmac_f32_32x32x32_bf16 v[96:111], v[160:163], v[48:55], v30
    s_and_b32 s74, s1, 0xffff
    s_add_u32 s74, s74, s69
    ds_read_b128 v[152:155], v28 offset:44352
    v_exp_f32 v67, v67
    v_exp_f32 v68, v68
    v_exp_f32 v69, v69
    v_exp_f32 v70, v70
    v_smfmac_f32_32x32x32_bf16 v[96:111], v[164:167], v[56:63], v30
    s_mov_b32 m0, s76
    ds_read_b128 v[156:159], v28 offset:44896
    v_exp_f32 v71, v71
    v_exp_f32 v72, v72
    v_exp_f32 v73, v73
    v_exp_f32 v74, v74
    v_exp_f32 v75, v75
    v_exp_f32 v76, v76
    v_exp_f32 v77, v77
    v_exp_f32 v78, v78
    v_exp_f32 v79, v79
    v_mfma_f32_32x32x16_bf16 v[48:63], v[148:151], v[16:19], v[112:127]
    s_waitcnt lgkmcnt(0)
    buffer_load_dwordx4 v[228:231], v218, s[8:11], s18 offen offset:128 sc1
    v_exp_f32 v32, v32
    v_exp_f32 v33, v33
    v_exp_f32 v34, v34
    v_smfmac_f32_32x32x32_bf16 v[80:95], v[152:155], v[64:71], v30
    buffer_load_dwordx4 v3, s[8:11], s74 offen offset:0 sc1 lds
    buffer_load_dwordx4 v3, s[8:11], s74 offen offset:1024 sc1 lds
    v_exp_f32 v35, v35
    v_exp_f32 v36, v36
    v_exp_f32 v37, v37
    v_exp_f32 v38, v38
    v_smfmac_f32_32x32x32_bf16 v[80:95], v[156:159], v[72:79], v30
    ds_read_b128 v[144:147], v25 offset:48576
    v_exp_f32 v39, v39
    v_exp_f32 v40, v40
    v_exp_f32 v41, v41
    v_exp_f32 v42, v42
    v_exp_f32 v43, v43
    v_exp_f32 v44, v44
    v_exp_f32 v45, v45
    v_exp_f32 v46, v46
    v_exp_f32 v47, v47
    v_mfma_f32_32x32x16_bf16 v[64:79], v[148:151], v[20:23], v[128:143]
    s_waitcnt lgkmcnt(0)
    v_exp_f32 v48, v48
    v_exp_f32 v49, v49
    v_exp_f32 v50, v50
    v_smfmac_f32_32x32x32_bf16 v[96:111], v[152:155], v[32:39], v30
    s_waitcnt vmcnt(9)
    ds_read_b128 v[160:163], v28 offset:46464
    v_cvt_pk_bf16_f32 v205, v204, v205
    v_lshlrev_b32 v204, 16, v205
    v_and_b32 v205, 0xffff0000, v205
    v_cvt_pk_bf16_f32 v207, v206, v207
    v_lshlrev_b32 v206, 16, v207
    v_and_b32 v207, 0xffff0000, v207
    v_cvt_pk_bf16_f32 v209, v208, v209
    v_lshlrev_b32 v208, 16, v209
    v_and_b32 v209, 0xffff0000, v209
    v_cvt_pk_bf16_f32 v211, v210, v211
    v_lshlrev_b32 v210, 16, v211
    v_and_b32 v211, 0xffff0000, v211
    v_exp_f32 v51, v51
    v_exp_f32 v52, v52
    v_exp_f32 v53, v53
    v_exp_f32 v54, v54
    v_smfmac_f32_32x32x32_bf16 v[96:111], v[156:159], v[40:47], v30
    s_mov_b32 m0, s76
    ds_read_b128 v[164:167], v28 offset:47008
    v_exp_f32 v55, v55
    v_exp_f32 v56, v56
    v_exp_f32 v57, v57
    v_exp_f32 v58, v58
    v_exp_f32 v59, v59
    v_exp_f32 v60, v60
    v_exp_f32 v61, v61
    v_exp_f32 v62, v62
    v_exp_f32 v63, v63
    v_mfma_f32_32x32x16_bf16 v[32:47], v[144:147], v[16:19], v[112:127]
    s_waitcnt lgkmcnt(0)
    buffer_load_dwordx4 v[232:235], v218, s[8:11], s18 offen offset:192 sc1
    v_exp_f32 v64, v64
    v_exp_f32 v65, v65
    v_exp_f32 v66, v66
    v_smfmac_f32_32x32x32_bf16 v[80:95], v[160:163], v[48:55], v30
    buffer_load_dwordx4 v3, s[8:11], s74 offen offset:2048 sc1 lds
    buffer_load_dwordx4 v3, s[8:11], s74 offen offset:3072 sc1 lds
    s_add_u32 s1, s1, 16384
    s_add_u32 s76, s76, 16384
    v_add_f32 v204, v219, v204
    v_add_f32 v205, v219, v205
    v_add_f32 v206, v219, v206
    v_add_f32 v207, v219, v207
    v_add_f32 v208, v219, v208
    v_add_f32 v209, v219, v209
    v_add_f32 v210, v219, v210
    v_add_f32 v211, v219, v211
    v_cvt_pk_bf16_f32 v204, v204, v205
    v_cvt_pk_bf16_f32 v205, v206, v207
    v_cvt_pk_bf16_f32 v206, v208, v209
    v_cvt_pk_bf16_f32 v207, v210, v211
    v_exp_f32 v67, v67
    v_exp_f32 v68, v68
    v_exp_f32 v69, v69
    v_exp_f32 v70, v70
    v_smfmac_f32_32x32x32_bf16 v[80:95], v[164:167], v[56:63], v30
    ds_read_b128 v[148:151], v25 offset:50688
    v_exp_f32 v71, v71
    v_exp_f32 v72, v72
    v_exp_f32 v73, v73
    v_exp_f32 v74, v74
    v_exp_f32 v75, v75
    v_exp_f32 v76, v76
    v_exp_f32 v77, v77
    v_exp_f32 v78, v78
    v_exp_f32 v79, v79
    v_mfma_f32_32x32x16_bf16 v[48:63], v[144:147], v[20:23], v[128:143]
    s_waitcnt lgkmcnt(0)
    v_exp_f32 v32, v32
    v_exp_f32 v33, v33
    v_exp_f32 v34, v34
    v_smfmac_f32_32x32x32_bf16 v[96:111], v[160:163], v[64:71], v30
    s_and_b32 s74, s1, 0xffff
    s_add_u32 s74, s74, s69
    ds_read_b128 v[152:155], v28 offset:48576
    v_mfma_f32_16x16x32_bf16 v[168:171], v[204:207], v[180:183], 0
    v_mfma_f32_16x16x32_bf16 v[208:211], v[204:207], v[184:187], 0
    v_mfma_f32_16x16x32_bf16 v[176:179], v[204:207], v[188:191], 0
    v_mfma_f32_16x16x32_bf16 v[224:227], v[204:207], v[192:195], 0
    v_exp_f32 v35, v35
    v_exp_f32 v36, v36
    v_exp_f32 v37, v37
    v_exp_f32 v38, v38
    v_smfmac_f32_32x32x32_bf16 v[96:111], v[164:167], v[72:79], v30
    s_mov_b32 m0, s76
    ds_read_b128 v[156:159], v28 offset:49120
    v_exp_f32 v39, v39
    v_exp_f32 v40, v40
    v_exp_f32 v41, v41
    v_exp_f32 v42, v42
    v_exp_f32 v43, v43
    v_exp_f32 v44, v44
    v_exp_f32 v45, v45
    v_exp_f32 v46, v46
    v_exp_f32 v47, v47
    v_mfma_f32_32x32x16_bf16 v[64:79], v[148:151], v[16:19], v[112:127]
    s_waitcnt lgkmcnt(0)
    buffer_load_dwordx4 v[236:239], v218, s[8:11], s30 offen offset:0 sc1
    v_exp_f32 v48, v48
    v_exp_f32 v49, v49
    v_exp_f32 v50, v50
    v_smfmac_f32_32x32x32_bf16 v[80:95], v[152:155], v[32:39], v30
    buffer_load_dwordx4 v3, s[8:11], s74 offen offset:0 sc1 lds
    buffer_load_dwordx4 v3, s[8:11], s74 offen offset:1024 sc1 lds
    v_exp_f32 v51, v51
    v_exp_f32 v52, v52
    v_exp_f32 v53, v53
    v_exp_f32 v54, v54
    v_smfmac_f32_32x32x32_bf16 v[80:95], v[156:159], v[40:47], v30
    ds_read_b128 v[144:147], v25 offset:52800
    v_exp_f32 v55, v55
    v_exp_f32 v56, v56
    v_exp_f32 v57, v57
    v_exp_f32 v58, v58
    v_exp_f32 v59, v59
    v_exp_f32 v60, v60
    v_exp_f32 v61, v61
    v_exp_f32 v62, v62
    v_exp_f32 v63, v63
    v_mfma_f32_32x32x16_bf16 v[32:47], v[148:151], v[20:23], v[128:143]
    s_waitcnt lgkmcnt(0)
    v_exp_f32 v64, v64
    v_exp_f32 v65, v65
    v_exp_f32 v66, v66
    v_smfmac_f32_32x32x32_bf16 v[96:111], v[152:155], v[48:55], v30
    ds_read_b128 v[160:163], v28 offset:50688
    s_mov_b32 exec_lo, 0xffff0000
    s_mov_b32 exec_hi, 0
    v_mov_b64 v[168:169], v[208:209]
    s_mov_b32 exec_lo, 0
    s_mov_b32 exec_hi, 0x0000ffff
    v_mov_b64 v[168:169], v[176:177]
    s_mov_b32 exec_hi, 0xffff0000
    v_mov_b64 v[168:169], v[224:225]
    s_mov_b64 exec, -1
    v_exp_f32 v67, v67
    v_exp_f32 v68, v68
    v_exp_f32 v69, v69
    v_exp_f32 v70, v70
    v_smfmac_f32_32x32x32_bf16 v[96:111], v[156:159], v[56:63], v30
    buffer_atomic_add_f32 v168, v215, s[8:11], s28 offen
    buffer_atomic_add_f32 v169, v215, s[8:11], s29 offen
    buffer_load_dword v200, v175, s[8:11], s23 offen sc1
    s_mov_b32 m0, s76
    ds_read_b128 v[164:167], v28 offset:51232
    v_exp_f32 v71, v71
    v_exp_f32 v72, v72
    v_exp_f32 v73, v73
    v_exp_f32 v74, v74
    v_exp_f32 v75, v75
    v_exp_f32 v76, v76
    v_exp_f32 v77, v77
    v_exp_f32 v78, v78
    v_exp_f32 v79, v79
    v_mfma_f32_32x32x16_bf16 v[48:63], v[144:147], v[16:19], v[112:127]
    s_waitcnt lgkmcnt(0)
    buffer_load_dwordx4 v[240:243], v218, s[8:11], s30 offen offset:64 sc1
    v_exp_f32 v32, v32
    v_exp_f32 v33, v33
    v_exp_f32 v34, v34
    v_smfmac_f32_32x32x32_bf16 v[80:95], v[160:163], v[64:71], v30
    buffer_load_dwordx4 v3, s[8:11], s74 offen offset:2048 sc1 lds
    buffer_load_dwordx4 v3, s[8:11], s74 offen offset:3072 sc1 lds
    s_add_u32 s1, s1, 16384
    s_add_u32 s76, s76, 16384
    v_exp_f32 v35, v35
    v_exp_f32 v36, v36
    v_exp_f32 v37, v37
    v_exp_f32 v38, v38
    v_smfmac_f32_32x32x32_bf16 v[80:95], v[164:167], v[72:79], v30
    s_add_u32 s23, s23, 1792
    ds_read_b128 v[148:151], v25 offset:54912
    v_exp_f32 v39, v39
    v_exp_f32 v40, v40
    v_exp_f32 v41, v41
    v_exp_f32 v42, v42
    v_exp_f32 v43, v43
    v_exp_f32 v44, v44
    v_exp_f32 v45, v45
    v_exp_f32 v46, v46
    v_exp_f32 v47, v47
    v_mfma_f32_32x32x16_bf16 v[64:79], v[144:147], v[20:23], v[128:143]
    s_waitcnt lgkmcnt(0)
    v_exp_f32 v48, v48
    v_exp_f32 v49, v49
    v_exp_f32 v50, v50
    v_smfmac_f32_32x32x32_bf16 v[96:111], v[160:163], v[32:39], v30
    s_add_u32 s74, s21, 4
    s_and_b32 s74, s74, 15
    s_add_u32 s74, s74, s22
    s_mul_i32 s74, s74, 7168
    s_add_u32 s74, s74, 16891904
    s_mul_i32 s75, s48, 7168
    s_add_u32 s75, s75, 94208
    ds_read_b128 v[152:155], v28 offset:52800
    v_exp_f32 v51, v51
    v_exp_f32 v52, v52
    v_exp_f32 v53, v53
    v_exp_f32 v54, v54
    v_smfmac_f32_32x32x32_bf16 v[96:111], v[164:167], v[40:47], v30
    s_mov_b32 m0, s75
    ds_read_b128 v[156:159], v28 offset:53344
    v_exp_f32 v55, v55
    v_exp_f32 v56, v56
    v_exp_f32 v57, v57
    v_exp_f32 v58, v58
    v_exp_f32 v59, v59
    v_exp_f32 v60, v60
    v_exp_f32 v61, v61
    v_exp_f32 v62, v62
    v_exp_f32 v63, v63
    v_mfma_f32_32x32x16_bf16 v[32:47], v[148:151], v[16:19], v[112:127]
    s_waitcnt lgkmcnt(0)
    buffer_load_dwordx4 v[244:247], v218, s[8:11], s30 offen offset:128 sc1
    v_exp_f32 v64, v64
    v_exp_f32 v65, v65
    v_exp_f32 v66, v66
    v_smfmac_f32_32x32x32_bf16 v[80:95], v[152:155], v[48:55], v30
    buffer_load_dwordx4 v3, s[8:11], s74 offen offset:0 sc1 lds
    buffer_load_dwordx4 v3, s[8:11], s74 offen offset:1024 sc1 lds
    v_exp_f32 v67, v67
    v_exp_f32 v68, v68
    v_exp_f32 v69, v69
    v_exp_f32 v70, v70
    v_smfmac_f32_32x32x32_bf16 v[80:95], v[156:159], v[56:63], v30
    ds_read_b128 v[144:147], v25 offset:57024
    v_exp_f32 v71, v71
    v_exp_f32 v72, v72
    v_exp_f32 v73, v73
    v_exp_f32 v74, v74
    v_exp_f32 v75, v75
    v_exp_f32 v76, v76
    v_exp_f32 v77, v77
    v_exp_f32 v78, v78
    v_exp_f32 v79, v79
    v_mfma_f32_32x32x16_bf16 v[48:63], v[148:151], v[20:23], v[128:143]
    s_waitcnt lgkmcnt(0)
    v_exp_f32 v32, v32
    v_exp_f32 v33, v33
    v_exp_f32 v34, v34
    v_smfmac_f32_32x32x32_bf16 v[96:111], v[152:155], v[64:71], v30
    s_lshl_b32 s27, s47, 8
    s_add_u32 s27, s27, 207872
    ds_read_b128 v[160:163], v28 offset:54912
    v_exp_f32 v35, v35
    v_exp_f32 v36, v36
    v_exp_f32 v37, v37
    v_exp_f32 v38, v38
    v_smfmac_f32_32x32x32_bf16 v[96:111], v[156:159], v[72:79], v30
    s_mov_b32 m0, s75
    ds_read_b128 v[164:167], v28 offset:55456
    v_exp_f32 v39, v39
    v_exp_f32 v40, v40
    v_exp_f32 v41, v41
    v_exp_f32 v42, v42
    v_exp_f32 v43, v43
    v_exp_f32 v44, v44
    v_exp_f32 v45, v45
    v_exp_f32 v46, v46
    v_exp_f32 v47, v47
    v_mfma_f32_32x32x16_bf16 v[64:79], v[144:147], v[16:19], v[112:127]
    s_waitcnt lgkmcnt(0)
    buffer_load_dwordx4 v[248:251], v218, s[8:11], s30 offen offset:192 sc1
    v_exp_f32 v48, v48
    v_exp_f32 v49, v49
    v_exp_f32 v50, v50
    v_smfmac_f32_32x32x32_bf16 v[80:95], v[160:163], v[32:39], v30
    buffer_load_dwordx4 v3, s[8:11], s74 offen offset:2048 sc1 lds
    buffer_load_dwordx4 v3, s[8:11], s74 offen offset:3072 sc1 lds
    s_add_u32 s74, s74, 4096
    s_add_u32 s75, s75, 4096
    v_exp_f32 v51, v51
    v_exp_f32 v52, v52
    v_exp_f32 v53, v53
    v_exp_f32 v54, v54
    v_smfmac_f32_32x32x32_bf16 v[80:95], v[164:167], v[40:47], v30
    s_lshl_b32 s28, s48, 7
    s_add_u32 s28, s28, s27
    ds_read_b128 v[148:151], v25 offset:59136
    v_exp_f32 v55, v55
    v_exp_f32 v56, v56
    v_exp_f32 v57, v57
    v_exp_f32 v58, v58
    v_exp_f32 v59, v59
    v_exp_f32 v60, v60
    v_exp_f32 v61, v61
    v_exp_f32 v62, v62
    v_exp_f32 v63, v63
    v_mfma_f32_32x32x16_bf16 v[32:47], v[144:147], v[20:23], v[128:143]
    s_waitcnt lgkmcnt(0)
    buffer_load_dwordx2 v[8:9], v172, s[12:15], 0 offen offset:0
    buffer_load_dwordx2 v[10:11], v172, s[12:15], 0 offen offset:32
    v_exp_f32 v64, v64
    v_exp_f32 v65, v65
    v_exp_f32 v66, v66
    v_smfmac_f32_32x32x32_bf16 v[96:111], v[160:163], v[48:55], v30
    s_cmp_lt_u32 s48, 2
    s_cselect_b32 s28, s28, 18874368
    ds_read_b128 v[152:155], v28 offset:57024
    v_exp_f32 v67, v67
    v_exp_f32 v68, v68
    v_exp_f32 v69, v69
    v_exp_f32 v70, v70
    v_smfmac_f32_32x32x32_bf16 v[96:111], v[164:167], v[56:63], v30
    buffer_load_dword v200, v175, s[8:11], s23 offen sc1
    s_mov_b32 m0, s75
    ds_read_b128 v[156:159], v28 offset:57568
    v_exp_f32 v71, v71
    v_exp_f32 v72, v72
    v_exp_f32 v73, v73
    v_exp_f32 v74, v74
    v_exp_f32 v75, v75
    v_exp_f32 v76, v76
    v_exp_f32 v77, v77
    v_exp_f32 v78, v78
    v_exp_f32 v79, v79
    v_mfma_f32_32x32x16_bf16 v[48:63], v[148:151], v[16:19], v[112:127]
    s_waitcnt lgkmcnt(0)
    s_waitcnt vmcnt(9)
    s_barrier
    buffer_load_dwordx4 v[224:227], v218, s[8:11], s18 offen offset:64 sc1
    v_exp_f32 v32, v32
    v_exp_f32 v33, v33
    v_exp_f32 v34, v34
    v_smfmac_f32_32x32x32_bf16 v[80:95], v[152:155], v[64:71], v30
    buffer_load_dwordx4 v3, s[8:11], s74 offen offset:0 sc1 lds
    buffer_load_dwordx4 v3, s[8:11], s74 offen offset:1024 sc1 lds
    v_exp_f32 v35, v35
    v_exp_f32 v36, v36
    v_exp_f32 v37, v37
    v_exp_f32 v38, v38
    v_smfmac_f32_32x32x32_bf16 v[80:95], v[156:159], v[72:79], v30
    s_add_u32 s23, s23, 1792
    ds_read_b128 v[144:147], v25 offset:61248
    v_exp_f32 v39, v39
    v_exp_f32 v40, v40
    v_exp_f32 v41, v41
    v_exp_f32 v42, v42
    v_exp_f32 v43, v43
    v_exp_f32 v44, v44
    v_exp_f32 v45, v45
    v_exp_f32 v46, v46
    v_exp_f32 v47, v47
    v_mfma_f32_32x32x16_bf16 v[64:79], v[148:151], v[20:23], v[128:143]
    s_waitcnt lgkmcnt(0)
    buffer_load_dwordx2 v[12:13], v172, s[12:15], 0 offen offset:64
    buffer_load_dwordx2 v[14:15], v172, s[12:15], 0 offen offset:96
    v_exp_f32 v48, v48
    v_exp_f32 v49, v49
    v_exp_f32 v50, v50
    v_smfmac_f32_32x32x32_bf16 v[96:111], v[152:155], v[32:39], v30
    ds_read_b128 v[160:163], v28 offset:59136
    v_exp_f32 v51, v51
    v_exp_f32 v52, v52
    v_exp_f32 v53, v53
    v_exp_f32 v54, v54
    v_smfmac_f32_32x32x32_bf16 v[96:111], v[156:159], v[40:47], v30
    s_waitcnt vmcnt(18)
    buffer_atomic_add v199, v198, s[8:11], s28 offen sc1
    s_mov_b32 m0, s75
    ds_read_b128 v[164:167], v28 offset:59680
    v_exp_f32 v55, v55
    v_exp_f32 v56, v56
    v_exp_f32 v57, v57
    v_exp_f32 v58, v58
    v_exp_f32 v59, v59
    v_exp_f32 v60, v60
    v_exp_f32 v61, v61
    v_exp_f32 v62, v62
    v_exp_f32 v63, v63
    v_mfma_f32_32x32x16_bf16 v[32:47], v[144:147], v[16:19], v[112:127]
    s_waitcnt lgkmcnt(0)
    v_exp_f32 v64, v64
    v_exp_f32 v65, v65
    v_exp_f32 v66, v66
    v_smfmac_f32_32x32x32_bf16 v[80:95], v[160:163], v[48:55], v30
    buffer_load_dwordx4 v3, s[8:11], s74 offen offset:2048 sc1 lds
    v_exp_f32 v67, v67
    v_exp_f32 v68, v68
    v_exp_f32 v69, v69
    v_exp_f32 v70, v70
    v_smfmac_f32_32x32x32_bf16 v[80:95], v[164:167], v[56:63], v30
    s_add_u32 s74, s21, 8
    s_and_b32 s74, s74, 15
    s_add_u32 s74, s74, s22
    s_mul_i32 s74, s74, 7168
    s_add_u32 s74, s74, 16891904
    s_mul_i32 s75, s48, 7168
    s_add_u32 s75, s75, 122880
    ds_read_b128 v[148:151], v25 offset:63360
    v_exp_f32 v71, v71
    v_exp_f32 v72, v72
    v_exp_f32 v73, v73
    v_exp_f32 v74, v74
    v_exp_f32 v75, v75
    v_exp_f32 v76, v76
    v_exp_f32 v77, v77
    v_exp_f32 v78, v78
    v_exp_f32 v79, v79
    v_mfma_f32_32x32x16_bf16 v[48:63], v[144:147], v[20:23], v[128:143]
    s_waitcnt lgkmcnt(0)
    v_exp_f32 v32, v32
    v_exp_f32 v33, v33
    v_exp_f32 v34, v34
    v_smfmac_f32_32x32x32_bf16 v[96:111], v[160:163], v[64:71], v30
    s_mov_b32 m0, s75
    ds_read_b128 v[152:155], v28 offset:61248
    v_exp_f32 v35, v35
    v_exp_f32 v36, v36
    v_exp_f32 v37, v37
    v_exp_f32 v38, v38
    v_smfmac_f32_32x32x32_bf16 v[96:111], v[164:167], v[72:79], v30
    buffer_load_dwordx4 v3, s[8:11], s74 offen offset:0 sc1 lds
    buffer_load_dwordx4 v3, s[8:11], s74 offen offset:1024 sc1 lds
    s_mov_b32 m0, s75
    ds_read_b128 v[156:159], v28 offset:61792
    v_exp_f32 v39, v39
    v_exp_f32 v40, v40
    v_exp_f32 v41, v41
    v_exp_f32 v42, v42
    v_exp_f32 v43, v43
    v_exp_f32 v44, v44
    v_exp_f32 v45, v45
    v_exp_f32 v46, v46
    v_exp_f32 v47, v47
    v_mfma_f32_32x32x16_bf16 v[64:79], v[148:151], v[16:19], v[112:127]
    s_waitcnt lgkmcnt(0)
    v_exp_f32 v48, v48
    v_exp_f32 v49, v49
    v_exp_f32 v50, v50
    v_smfmac_f32_32x32x32_bf16 v[80:95], v[152:155], v[32:39], v30
    buffer_load_dwordx4 v3, s[8:11], s74 offen offset:2048 sc1 lds
    buffer_load_dwordx4 v3, s[8:11], s74 offen offset:3072 sc1 lds
    s_add_u32 s74, s74, 4096
    s_add_u32 s75, s75, 4096
    v_exp_f32 v51, v51
    v_exp_f32 v52, v52
    v_exp_f32 v53, v53
    v_exp_f32 v54, v54
    v_smfmac_f32_32x32x32_bf16 v[80:95], v[156:159], v[40:47], v30
    ds_read_b128 v[144:147], v26 offset:0
    v_exp_f32 v55, v55
    v_exp_f32 v56, v56
    v_exp_f32 v57, v57
    v_exp_f32 v58, v58
    v_exp_f32 v59, v59
    v_exp_f32 v60, v60
    v_exp_f32 v61, v61
    v_exp_f32 v62, v62
    v_exp_f32 v63, v63
    v_mfma_f32_32x32x16_bf16 v[32:47], v[148:151], v[20:23], v[128:143]
    s_waitcnt lgkmcnt(0)
    v_exp_f32 v64, v64
    v_exp_f32 v65, v65
    v_exp_f32 v66, v66
    v_smfmac_f32_32x32x32_bf16 v[96:111], v[152:155], v[48:55], v30
    s_mov_b32 m0, s75
    ds_read_b128 v[160:163], v28 offset:63360
    v_exp_f32 v67, v67
    v_exp_f32 v68, v68
    v_exp_f32 v69, v69
    v_exp_f32 v70, v70
    v_smfmac_f32_32x32x32_bf16 v[96:111], v[156:159], v[56:63], v30
    buffer_load_dwordx4 v3, s[8:11], s74 offen offset:0 sc1 lds
    buffer_load_dwordx4 v3, s[8:11], s74 offen offset:1024 sc1 lds
    s_mov_b32 m0, s75
    ds_read_b128 v[164:167], v28 offset:63904
    v_exp_f32 v71, v71
    v_exp_f32 v72, v72
    v_exp_f32 v73, v73
    v_exp_f32 v74, v74
    v_exp_f32 v75, v75
    v_exp_f32 v76, v76
    v_exp_f32 v77, v77
    v_exp_f32 v78, v78
    v_exp_f32 v79, v79
    v_mfma_f32_32x32x16_bf16 v[48:63], v[144:147], v[16:19], v[112:127]
    s_waitcnt lgkmcnt(0)
    v_exp_f32 v32, v32
    v_exp_f32 v33, v33
    v_exp_f32 v34, v34
    v_smfmac_f32_32x32x32_bf16 v[80:95], v[160:163], v[64:71], v30
    buffer_load_dwordx4 v3, s[8:11], s74 offen offset:2048 sc1 lds
    v_exp_f32 v35, v35
    v_exp_f32 v36, v36
    v_exp_f32 v37, v37
    v_exp_f32 v38, v38
    v_smfmac_f32_32x32x32_bf16 v[80:95], v[164:167], v[72:79], v30
    ds_read_b128 v[148:151], v26 offset:2112
    v_exp_f32 v39, v39
    v_exp_f32 v40, v40
    v_exp_f32 v41, v41
    v_exp_f32 v42, v42
    v_exp_f32 v43, v43
    v_exp_f32 v44, v44
    v_exp_f32 v45, v45
    v_exp_f32 v46, v46
    v_exp_f32 v47, v47
    v_mfma_f32_32x32x16_bf16 v[64:79], v[144:147], v[20:23], v[128:143]
    s_waitcnt lgkmcnt(0)
    v_exp_f32 v48, v48
    v_exp_f32 v49, v49
    v_exp_f32 v50, v50
    v_smfmac_f32_32x32x32_bf16 v[96:111], v[160:163], v[32:39], v30
    ds_read_b128 v[152:155], v29 offset:0
    v_exp_f32 v51, v51
    v_exp_f32 v52, v52
    v_exp_f32 v53, v53
    v_exp_f32 v54, v54
    v_smfmac_f32_32x32x32_bf16 v[96:111], v[164:167], v[40:47], v30
    ds_read_b128 v[156:159], v29 offset:544
    v_exp_f32 v55, v55
    v_exp_f32 v56, v56
    v_exp_f32 v57, v57
    v_exp_f32 v58, v58
    v_exp_f32 v59, v59
    v_exp_f32 v60, v60
    v_exp_f32 v61, v61
    v_exp_f32 v62, v62
    v_exp_f32 v63, v63
    v_mfma_f32_32x32x16_bf16 v[32:47], v[148:151], v[16:19], v[112:127]
    s_waitcnt lgkmcnt(0)
    v_exp_f32 v64, v64
    v_exp_f32 v65, v65
    v_exp_f32 v66, v66
    v_smfmac_f32_32x32x32_bf16 v[80:95], v[152:155], v[48:55], v30
    v_exp_f32 v67, v67
    v_exp_f32 v68, v68
    v_exp_f32 v69, v69
    v_exp_f32 v70, v70
    v_smfmac_f32_32x32x32_bf16 v[80:95], v[156:159], v[56:63], v30
    v_exp_f32 v71, v71
    v_exp_f32 v72, v72
    v_exp_f32 v73, v73
    v_exp_f32 v74, v74
    v_exp_f32 v75, v75
    v_exp_f32 v76, v76
    v_exp_f32 v77, v77
    v_exp_f32 v78, v78
    v_exp_f32 v79, v79
    v_mfma_f32_32x32x16_bf16 v[48:63], v[148:151], v[20:23], v[128:143]
    s_waitcnt lgkmcnt(0)
    v_exp_f32 v32, v32
    v_exp_f32 v33, v33
    v_exp_f32 v34, v34
    v_smfmac_f32_32x32x32_bf16 v[96:111], v[152:155], v[64:71], v30
    ds_read_b128 v[160:163], v29 offset:2112
    v_exp_f32 v35, v35
    v_exp_f32 v36, v36
    v_exp_f32 v37, v37
    v_exp_f32 v38, v38
    v_smfmac_f32_32x32x32_bf16 v[96:111], v[156:159], v[72:79], v30
    ds_read_b128 v[164:167], v29 offset:2656
    v_exp_f32 v39, v39
    v_exp_f32 v40, v40
    v_exp_f32 v41, v41
    v_exp_f32 v42, v42
    v_exp_f32 v43, v43
    v_exp_f32 v44, v44
    v_exp_f32 v45, v45
    v_exp_f32 v46, v46
    v_exp_f32 v47, v47
    s_waitcnt lgkmcnt(0)
    v_exp_f32 v48, v48
    v_exp_f32 v49, v49
    v_exp_f32 v50, v50
    v_smfmac_f32_32x32x32_bf16 v[80:95], v[160:163], v[32:39], v30
    v_exp_f32 v51, v51
    v_exp_f32 v52, v52
    v_exp_f32 v53, v53
    v_exp_f32 v54, v54
    v_smfmac_f32_32x32x32_bf16 v[80:95], v[164:167], v[40:47], v30
    v_exp_f32 v55, v55
    v_exp_f32 v56, v56
    v_exp_f32 v57, v57
    v_exp_f32 v58, v58
    v_exp_f32 v59, v59
    v_exp_f32 v60, v60
    v_exp_f32 v61, v61
    v_exp_f32 v62, v62
    v_exp_f32 v63, v63
    v_smfmac_f32_32x32x32_bf16 v[96:111], v[160:163], v[48:55], v30
    s_nop 0
    v_smfmac_f32_32x32x32_bf16 v[96:111], v[164:167], v[56:63], v30
    s_add_u32 s3, s49, 1
    v_cmp_ne_u32 vcc, s3, v253
    s_lshl_b32 s65, s47, 2
    v_add_u32 v254, s65, v198
    v_lshlrev_b32 v255, 2, v0
    v_mov_b32 v29, v174
    s_and_b32 s3, vcc_lo, 0xff
    s_cselect_b32 s50, 0, 1
    v_mov_b32 v32, 0x53800000
    v_mov_b32 v4, v88
    v_mov_b32 v5, v88
    s_nop 0
    v_mov_b32 v6, v104
    v_mov_b32 v7, v104
    v_permlane32_swap_b32 v4, v5
    s_nop 0
    v_permlane32_swap_b32 v6, v7
    v_add_f32 v5, v4, v6
    v_cmp_nlt_f32 vcc, v5, v32
    s_cbranch_vccnz Lfb_25
Lok_26:
    v_rcp_f32 v4, v4
    v_rcp_f32 v6, v6
    v_pk_mul_f32 v[80:81], v[80:81], v[4:5] op_sel_hi:[1,0]
    v_pk_mul_f32 v[82:83], v[82:83], v[4:5] op_sel_hi:[1,0]
    v_pk_mul_f32 v[84:85], v[84:85], v[4:5] op_sel_hi:[1,0]
    v_pk_mul_f32 v[86:87], v[86:87], v[4:5] op_sel_hi:[1,0]
    v_pk_mul_f32 v[96:97], v[96:97], v[6:7] op_sel_hi:[1,0]
    v_pk_mul_f32 v[98:99], v[98:99], v[6:7] op_sel_hi:[1,0]
    v_pk_mul_f32 v[100:101], v[100:101], v[6:7] op_sel_hi:[1,0]
    v_pk_mul_f32 v[102:103], v[102:103], v[6:7] op_sel_hi:[1,0]
    v_cvt_pk_bf16_f32 v64, v80, v81
    v_cvt_pk_bf16_f32 v65, v82, v83
    v_cvt_pk_bf16_f32 v66, v84, v85
    v_cvt_pk_bf16_f32 v67, v86, v87
    v_cvt_pk_bf16_f32 v68, v96, v97
    v_cvt_pk_bf16_f32 v69, v98, v99
    v_cvt_pk_bf16_f32 v70, v100, v101
    v_cvt_pk_bf16_f32 v71, v102, v103
    buffer_store_dwordx4 v[64:67], v3, s[8:11], s16 offen offset:0 sc1
    buffer_store_dwordx4 v[68:71], v3, s[8:11], s16 offen offset:1024 sc1
    ds_read_b128 v[144:147], v3 offset:0
    ds_read_b128 v[148:151], v3 offset:1024
    ds_read_b128 v[152:155], v3 offset:2048
    ds_read_b128 v[156:159], v3 offset:3072
    ds_read_b128 v[160:163], v3 offset:4096
    ds_read_b128 v[164:167], v3 offset:5120
    ds_read_b128 v[168:171], v3 offset:6144
    ds_read_b128 v[172:175], v3 offset:7168
    v_mov_b32 v4, 1
    s_waitcnt vmcnt(0)
    s_cmp_eq_u32 s50, 0
    s_cbranch_scc1 Lslow_27
    buffer_store_dword v4, v254, s[8:11], s54 offen
    s_branch Lpub_28
Lslow_27:
    buffer_store_dword v4, v254, s[8:11], s54 offen sc1
Lpub_28:
    s_waitcnt lgkmcnt(4)
    v_mfma_f32_16x16x32_bf16 v[128:131], v[144:147], v[64:67], 0
    ds_read_b128 v[176:179], v3 offset:8192
    v_mfma_f32_16x16x32_bf16 v[132:135], v[148:151], v[64:67], 0
    ds_read_b128 v[180:183], v3 offset:9216
    v_mfma_f32_16x16x32_bf16 v[136:139], v[152:155], v[64:67], 0
    ds_read_b128 v[184:187], v3 offset:10240
    v_mfma_f32_16x16x32_bf16 v[140:143], v[156:159], v[64:67], 0
    ds_read_b128 v[188:191], v3 offset:11264
    s_waitcnt lgkmcnt(4)
    v_mfma_f32_16x16x32_bf16 v[128:131], v[160:163], v[68:71], v[128:131]
    ds_read_b128 v[144:147], v3 offset:12288
    v_mfma_f32_16x16x32_bf16 v[132:135], v[164:167], v[68:71], v[132:135]
    ds_read_b128 v[148:151], v3 offset:13312
    v_mfma_f32_16x16x32_bf16 v[136:139], v[168:171], v[68:71], v[136:139]
    ds_read_b128 v[152:155], v3 offset:14336
    v_mfma_f32_16x16x32_bf16 v[140:143], v[172:175], v[68:71], v[140:143]
    ds_read_b128 v[156:159], v3 offset:15360
    v_cvt_pk_bf16_f32 v221, v220, v221
    v_lshlrev_b32 v220, 16, v221
    v_and_b32 v221, 0xffff0000, v221
    v_cvt_pk_bf16_f32 v223, v222, v223
    v_lshlrev_b32 v222, 16, v223
    v_and_b32 v223, 0xffff0000, v223
    v_cvt_pk_bf16_f32 v225, v224, v225
    v_lshlrev_b32 v224, 16, v225
    v_and_b32 v225, 0xffff0000, v225
    v_cvt_pk_bf16_f32 v227, v226, v227
    v_lshlrev_b32 v226, 16, v227
    v_and_b32 v227, 0xffff0000, v227
    v_cvt_pk_bf16_f32 v229, v228, v229
    v_lshlrev_b32 v228, 16, v229
    v_and_b32 v229, 0xffff0000, v229
    v_cvt_pk_bf16_f32 v231, v230, v231
    v_lshlrev_b32 v230, 16, v231
    v_and_b32 v231, 0xffff0000, v231
    v_cvt_pk_bf16_f32 v233, v232, v233
    v_lshlrev_b32 v232, 16, v233
    v_and_b32 v233, 0xffff0000, v233
    v_cvt_pk_bf16_f32 v235, v234, v235
    v_lshlrev_b32 v234, 16, v235
    v_and_b32 v235, 0xffff0000, v235
    v_cvt_pk_bf16_f32 v237, v236, v237
    v_lshlrev_b32 v236, 16, v237
    v_and_b32 v237, 0xffff0000, v237
    v_cvt_pk_bf16_f32 v239, v238, v239
    v_lshlrev_b32 v238, 16, v239
    v_and_b32 v239, 0xffff0000, v239
    v_cvt_pk_bf16_f32 v241, v240, v241
    v_lshlrev_b32 v240, 16, v241
    v_and_b32 v241, 0xffff0000, v241
    v_cvt_pk_bf16_f32 v243, v242, v243
    v_lshlrev_b32 v242, 16, v243
    v_and_b32 v243, 0xffff0000, v243
    v_cvt_pk_bf16_f32 v245, v244, v245
    v_lshlrev_b32 v244, 16, v245
    v_and_b32 v245, 0xffff0000, v245
    v_cvt_pk_bf16_f32 v247, v246, v247
    v_lshlrev_b32 v246, 16, v247
    v_and_b32 v247, 0xffff0000, v247
    v_cvt_pk_bf16_f32 v249, v248, v249
    v_lshlrev_b32 v248, 16, v249
    v_and_b32 v249, 0xffff0000, v249
    v_cvt_pk_bf16_f32 v251, v250, v251
    v_lshlrev_b32 v250, 16, v251
    v_and_b32 v251, 0xffff0000, v251
    v_add_f32 v236, 1.0, v236
    v_add_f32 v237, 1.0, v237
    v_add_f32 v238, 1.0, v238
    v_add_f32 v239, 1.0, v239
    v_add_f32 v240, 1.0, v240
    v_add_f32 v241, 1.0, v241
    v_add_f32 v242, 1.0, v242
    v_add_f32 v243, 1.0, v243
    v_add_f32 v244, 1.0, v244
    v_add_f32 v245, 1.0, v245
    v_add_f32 v246, 1.0, v246
    v_add_f32 v247, 1.0, v247
    v_add_f32 v248, 1.0, v248
    v_add_f32 v249, 1.0, v249
    v_add_f32 v250, 1.0, v250
    v_add_f32 v251, 1.0, v251
    v_cvt_pk_bf16_f32 v237, v236, v237
    v_lshlrev_b32 v236, 16, v237
    v_and_b32 v237, 0xffff0000, v237
    v_cvt_pk_bf16_f32 v239, v238, v239
    v_lshlrev_b32 v238, 16, v239
    v_and_b32 v239, 0xffff0000, v239
    v_cvt_pk_bf16_f32 v241, v240, v241
    v_lshlrev_b32 v240, 16, v241
    v_and_b32 v241, 0xffff0000, v241
    v_cvt_pk_bf16_f32 v243, v242, v243
    v_lshlrev_b32 v242, 16, v243
    v_and_b32 v243, 0xffff0000, v243
    v_cvt_pk_bf16_f32 v245, v244, v245
    v_lshlrev_b32 v244, 16, v245
    v_and_b32 v245, 0xffff0000, v245
    v_cvt_pk_bf16_f32 v247, v246, v247
    v_lshlrev_b32 v246, 16, v247
    v_and_b32 v247, 0xffff0000, v247
    v_cvt_pk_bf16_f32 v249, v248, v249
    v_lshlrev_b32 v248, 16, v249
    v_and_b32 v249, 0xffff0000, v249
    v_cvt_pk_bf16_f32 v251, v250, v251
    v_lshlrev_b32 v250, 16, v251
    v_and_b32 v251, 0xffff0000, v251
    v_lshlrev_b32 v32, 16, v8
    v_and_b32 v33, 0xffff0000, v8
    v_lshlrev_b32 v34, 16, v9
    v_and_b32 v35, 0xffff0000, v9
    v_lshlrev_b32 v36, 16, v10
    v_and_b32 v37, 0xffff0000, v10
    v_lshlrev_b32 v38, 16, v11
    v_and_b32 v39, 0xffff0000, v11
    v_lshlrev_b32 v40, 16, v12
    v_and_b32 v41, 0xffff0000, v12
    v_lshlrev_b32 v42, 16, v13
    v_and_b32 v43, 0xffff0000, v13
    v_lshlrev_b32 v44, 16, v14
    v_and_b32 v45, 0xffff0000, v14
    v_lshlrev_b32 v46, 16, v15
    v_and_b32 v47, 0xffff0000, v15
    v_mov_b32 v31, v218
    s_lshl_b32 s77, s55, 1
    s_add_u32 s77, s77, 1048576
    s_lshr_b32 s68, s55, 4
    s_lshl_b32 s3, s47, 7
    s_add_u32 s69, s68, s3
    s_add_u32 s67, s69, 458752
    v_lshlrev_b32 v6, 3, v1
    s_add_u32 s3, s47, 1
    s_and_b32 s3, s3, 7
    s_mul_i32 s3, s3, 2048
    s_add_u32 s70, s3, s77
    s_add_u32 s3, s47, 2
    s_and_b32 s3, s3, 7
    s_mul_i32 s3, s3, 2048
    s_add_u32 s71, s3, s77
    s_add_u32 s3, s47, 3
    s_and_b32 s3, s3, 7
    s_mul_i32 s3, s3, 2048
    s_add_u32 s72, s3, s77
    s_add_u32 s3, s47, 4
    s_and_b32 s3, s3, 7
    s_mul_i32 s3, s3, 2048
    s_add_u32 s73, s3, s77
    s_add_u32 s3, s47, 5
    s_and_b32 s3, s3, 7
    s_mul_i32 s3, s3, 2048
    s_add_u32 s76, s3, s77
    s_add_u32 s3, s47, 6
    s_and_b32 s3, s3, 7
    s_mul_i32 s3, s3, 2048
    s_add_u32 s0, s3, s77
    s_add_u32 s3, s47, 7
    s_and_b32 s3, s3, 7
    s_mul_i32 s3, s3, 2048
    s_add_u32 s1, s3, s77
    s_mov_b64 exec, 0xff
    s_mov_b32 s3, 0
Lpoll_29:
    s_add_u32 s3, s3, 1
    s_cmp_gt_u32 s3, 131072
    s_cbranch_scc1 Lpollx_30
    buffer_load_dword v4, v255, s[8:11], s54 offen sc1
    s_waitcnt vmcnt(0)
    v_cmp_gt_u32 vcc, 1, v4
    s_cbranch_vccnz Lpoll_29
Lpollx_30:
    s_mov_b64 exec, -1
    buffer_load_dwordx4 v[72:75], v3, s[8:11], s70 offen offset:0 sc1
    buffer_load_dwordx4 v[76:79], v3, s[8:11], s70 offen offset:1024 sc1
    buffer_load_dwordx4 v[80:83], v3, s[8:11], s71 offen offset:0 sc1
    buffer_load_dwordx4 v[84:87], v3, s[8:11], s71 offen offset:1024 sc1
    buffer_load_dwordx4 v[88:91], v3, s[8:11], s72 offen offset:0 sc1
    buffer_load_dwordx4 v[92:95], v3, s[8:11], s72 offen offset:1024 sc1
    buffer_load_dwordx4 v[96:99], v3, s[8:11], s73 offen offset:0 sc1
    buffer_load_dwordx4 v[100:103], v3, s[8:11], s73 offen offset:1024 sc1
    s_waitcnt vmcnt(7) lgkmcnt(4)
    v_mfma_f32_16x16x32_bf16 v[128:131], v[176:179], v[72:75], v[128:131]
    buffer_load_dwordx4 v[104:107], v3, s[8:11], s76 offen offset:0 sc1
    ds_read_b128 v[160:163], v3 offset:16384
    v_mfma_f32_16x16x32_bf16 v[132:135], v[180:183], v[72:75], v[132:135]
    ds_read_b128 v[164:167], v3 offset:17408
    v_mfma_f32_16x16x32_bf16 v[136:139], v[184:187], v[72:75], v[136:139]
    ds_read_b128 v[168:171], v3 offset:18432
    v_mfma_f32_16x16x32_bf16 v[140:143], v[188:191], v[72:75], v[140:143]
    ds_read_b128 v[172:175], v3 offset:19456
    s_waitcnt vmcnt(7) lgkmcnt(4)
    v_mfma_f32_16x16x32_bf16 v[128:131], v[144:147], v[76:79], v[128:131]
    buffer_load_dwordx4 v[108:111], v3, s[8:11], s76 offen offset:1024 sc1
    ds_read_b128 v[176:179], v3 offset:20480
    v_mfma_f32_16x16x32_bf16 v[132:135], v[148:151], v[76:79], v[132:135]
    ds_read_b128 v[180:183], v3 offset:21504
    v_mfma_f32_16x16x32_bf16 v[136:139], v[152:155], v[76:79], v[136:139]
    ds_read_b128 v[184:187], v3 offset:22528
    v_mfma_f32_16x16x32_bf16 v[140:143], v[156:159], v[76:79], v[140:143]
    ds_read_b128 v[188:191], v3 offset:23552
    s_waitcnt vmcnt(7) lgkmcnt(4)
    v_mfma_f32_16x16x32_bf16 v[128:131], v[160:163], v[80:83], v[128:131]
    buffer_load_dwordx4 v[112:115], v3, s[8:11], s0 offen offset:0 sc1
    ds_read_b128 v[144:147], v3 offset:24576
    v_mfma_f32_16x16x32_bf16 v[132:135], v[164:167], v[80:83], v[132:135]
    ds_read_b128 v[148:151], v3 offset:25600
    v_mfma_f32_16x16x32_bf16 v[136:139], v[168:171], v[80:83], v[136:139]
    ds_read_b128 v[152:155], v3 offset:26624
    v_mfma_f32_16x16x32_bf16 v[140:143], v[172:175], v[80:83], v[140:143]
    ds_read_b128 v[156:159], v3 offset:27648
    s_waitcnt vmcnt(7) lgkmcnt(4)
    v_mfma_f32_16x16x32_bf16 v[128:131], v[176:179], v[84:87], v[128:131]
    buffer_load_dwordx4 v[116:119], v3, s[8:11], s0 offen offset:1024 sc1
    ds_read_b128 v[160:163], v3 offset:28672
    v_mfma_f32_16x16x32_bf16 v[132:135], v[180:183], v[84:87], v[132:135]
    ds_read_b128 v[164:167], v3 offset:29696
    v_mfma_f32_16x16x32_bf16 v[136:139], v[184:187], v[84:87], v[136:139]
    ds_read_b128 v[168:171], v3 offset:30720
    v_mfma_f32_16x16x32_bf16 v[140:143], v[188:191], v[84:87], v[140:143]
    ds_read_b128 v[172:175], v3 offset:31744
    s_waitcnt vmcnt(7) lgkmcnt(4)
    v_mfma_f32_16x16x32_bf16 v[128:131], v[144:147], v[88:91], v[128:131]
    buffer_load_dwordx4 v[120:123], v3, s[8:11], s1 offen offset:0 sc1
    ds_read_b128 v[176:179], v3 offset:32768
    v_mfma_f32_16x16x32_bf16 v[132:135], v[148:151], v[88:91], v[132:135]
    ds_read_b128 v[180:183], v3 offset:33792
    v_mfma_f32_16x16x32_bf16 v[136:139], v[152:155], v[88:91], v[136:139]
    ds_read_b128 v[184:187], v3 offset:34816
    v_mfma_f32_16x16x32_bf16 v[140:143], v[156:159], v[88:91], v[140:143]
    ds_read_b128 v[188:191], v3 offset:35840
    s_waitcnt vmcnt(7) lgkmcnt(4)
    v_mfma_f32_16x16x32_bf16 v[128:131], v[160:163], v[92:95], v[128:131]
    buffer_load_dwordx4 v[124:127], v3, s[8:11], s1 offen offset:1024 sc1
    ds_read_b128 v[144:147], v3 offset:36864
    v_mfma_f32_16x16x32_bf16 v[132:135], v[164:167], v[92:95], v[132:135]
    ds_read_b128 v[148:151], v3 offset:37888
    v_mfma_f32_16x16x32_bf16 v[136:139], v[168:171], v[92:95], v[136:139]
    ds_read_b128 v[152:155], v3 offset:38912
    v_mfma_f32_16x16x32_bf16 v[140:143], v[172:175], v[92:95], v[140:143]
    ds_read_b128 v[156:159], v3 offset:39936
    s_waitcnt vmcnt(7) lgkmcnt(4)
    v_mfma_f32_16x16x32_bf16 v[128:131], v[176:179], v[96:99], v[128:131]
    ds_read_b128 v[160:163], v3 offset:40960
    v_mfma_f32_16x16x32_bf16 v[132:135], v[180:183], v[96:99], v[132:135]
    ds_read_b128 v[164:167], v3 offset:41984
    v_mfma_f32_16x16x32_bf16 v[136:139], v[184:187], v[96:99], v[136:139]
    ds_read_b128 v[168:171], v3 offset:43008
    v_mfma_f32_16x16x32_bf16 v[140:143], v[188:191], v[96:99], v[140:143]
    ds_read_b128 v[172:175], v3 offset:44032
    s_waitcnt vmcnt(6) lgkmcnt(4)
    v_mfma_f32_16x16x32_bf16 v[128:131], v[144:147], v[100:103], v[128:131]
    ds_read_b128 v[176:179], v3 offset:45056
    v_mfma_f32_16x16x32_bf16 v[132:135], v[148:151], v[100:103], v[132:135]
    ds_read_b128 v[180:183], v3 offset:46080
    v_mfma_f32_16x16x32_bf16 v[136:139], v[152:155], v[100:103], v[136:139]
    ds_read_b128 v[184:187], v3 offset:47104
    v_mfma_f32_16x16x32_bf16 v[140:143], v[156:159], v[100:103], v[140:143]
    ds_read_b128 v[188:191], v3 offset:48128
    s_waitcnt vmcnt(5) lgkmcnt(4)
    v_mfma_f32_16x16x32_bf16 v[128:131], v[160:163], v[104:107], v[128:131]
    ds_read_b128 v[144:147], v3 offset:49152
    v_mfma_f32_16x16x32_bf16 v[132:135], v[164:167], v[104:107], v[132:135]
    ds_read_b128 v[148:151], v3 offset:50176
    v_mfma_f32_16x16x32_bf16 v[136:139], v[168:171], v[104:107], v[136:139]
    ds_read_b128 v[152:155], v3 offset:51200
    v_mfma_f32_16x16x32_bf16 v[140:143], v[172:175], v[104:107], v[140:143]
    ds_read_b128 v[156:159], v3 offset:52224
    s_waitcnt vmcnt(4) lgkmcnt(4)
    v_mfma_f32_16x16x32_bf16 v[128:131], v[176:179], v[108:111], v[128:131]
    ds_read_b128 v[160:163], v3 offset:53248
    v_mfma_f32_16x16x32_bf16 v[132:135], v[180:183], v[108:111], v[132:135]
    ds_read_b128 v[164:167], v3 offset:54272
    v_mfma_f32_16x16x32_bf16 v[136:139], v[184:187], v[108:111], v[136:139]
    ds_read_b128 v[168:171], v3 offset:55296
    v_mfma_f32_16x16x32_bf16 v[140:143], v[188:191], v[108:111], v[140:143]
    ds_read_b128 v[172:175], v3 offset:56320
    s_waitcnt vmcnt(3) lgkmcnt(4)
    v_mfma_f32_16x16x32_bf16 v[128:131], v[144:147], v[112:115], v[128:131]
    buffer_load_dword v252, v29, s[8:11], s27 offen sc1
    ds_read_b128 v[176:179], v3 offset:57344
    v_mfma_f32_16x16x32_bf16 v[132:135], v[148:151], v[112:115], v[132:135]
    ds_read_b128 v[180:183], v3 offset:58368
    v_mfma_f32_16x16x32_bf16 v[136:139], v[152:155], v[112:115], v[136:139]
    ds_read_b128 v[184:187], v3 offset:59392
    v_mfma_f32_16x16x32_bf16 v[140:143], v[156:159], v[112:115], v[140:143]
    ds_read_b128 v[188:191], v3 offset:60416
    s_waitcnt vmcnt(3) lgkmcnt(4)
    v_mfma_f32_16x16x32_bf16 v[128:131], v[160:163], v[116:119], v[128:131]
    ds_read_b128 v[144:147], v3 offset:61440
    v_mfma_f32_16x16x32_bf16 v[132:135], v[164:167], v[116:119], v[132:135]
    ds_read_b128 v[148:151], v3 offset:62464
    v_mfma_f32_16x16x32_bf16 v[136:139], v[168:171], v[116:119], v[136:139]
    ds_read_b128 v[152:155], v3 offset:63488
    v_mfma_f32_16x16x32_bf16 v[140:143], v[172:175], v[116:119], v[140:143]
    ds_read_b128 v[156:159], v3 offset:64512
    s_waitcnt vmcnt(2) lgkmcnt(4)
    v_mfma_f32_16x16x32_bf16 v[128:131], v[176:179], v[120:123], v[128:131]
    v_mfma_f32_16x16x32_bf16 v[132:135], v[180:183], v[120:123], v[132:135]
    v_mfma_f32_16x16x32_bf16 v[136:139], v[184:187], v[120:123], v[136:139]
    v_mfma_f32_16x16x32_bf16 v[140:143], v[188:191], v[120:123], v[140:143]
    s_waitcnt vmcnt(1) lgkmcnt(0)
    v_mfma_f32_16x16x32_bf16 v[128:131], v[144:147], v[124:127], v[128:131]
    v_mfma_f32_16x16x32_bf16 v[132:135], v[148:151], v[124:127], v[132:135]
    v_mfma_f32_16x16x32_bf16 v[136:139], v[152:155], v[124:127], v[136:139]
    v_mfma_f32_16x16x32_bf16 v[140:143], v[156:159], v[124:127], v[140:143]
    s_nop 4
    v_pk_fma_f32 v[32:33], v[128:129], v[220:221], v[32:33]
    v_pk_fma_f32 v[34:35], v[130:131], v[222:223], v[34:35]
    v_pk_fma_f32 v[36:37], v[132:133], v[224:225], v[36:37]
    v_pk_fma_f32 v[38:39], v[134:135], v[226:227], v[38:39]
    v_pk_fma_f32 v[40:41], v[136:137], v[228:229], v[40:41]
    v_pk_fma_f32 v[42:43], v[138:139], v[230:231], v[42:43]
    v_pk_fma_f32 v[44:45], v[140:141], v[232:233], v[44:45]
    v_pk_fma_f32 v[46:47], v[142:143], v[234:235], v[46:47]
    v_cvt_pk_bf16_f32 v8, v32, v33
    v_cvt_pk_bf16_f32 v9, v34, v35
    v_cvt_pk_bf16_f32 v10, v36, v37
    v_cvt_pk_bf16_f32 v11, v38, v39
    v_cvt_pk_bf16_f32 v12, v40, v41
    v_cvt_pk_bf16_f32 v13, v42, v43
    v_cvt_pk_bf16_f32 v14, v44, v45
    v_cvt_pk_bf16_f32 v15, v46, v47
    v_lshlrev_b32 v32, 16, v8
    v_and_b32 v33, 0xffff0000, v8
    v_lshlrev_b32 v34, 16, v9
    v_and_b32 v35, 0xffff0000, v9
    v_lshlrev_b32 v36, 16, v10
    v_and_b32 v37, 0xffff0000, v10
    v_lshlrev_b32 v38, 16, v11
    v_and_b32 v39, 0xffff0000, v11
    v_lshlrev_b32 v40, 16, v12
    v_and_b32 v41, 0xffff0000, v12
    v_lshlrev_b32 v42, 16, v13
    v_and_b32 v43, 0xffff0000, v13
    v_lshlrev_b32 v44, 16, v14
    v_and_b32 v45, 0xffff0000, v14
    v_lshlrev_b32 v46, 16, v15
    v_and_b32 v47, 0xffff0000, v15
    v_pk_mul_f32 v[236:237], v[236:237], v[32:33]
    v_pk_mul_f32 v[238:239], v[238:239], v[34:35]
    v_pk_mul_f32 v[240:241], v[240:241], v[36:37]
    v_pk_mul_f32 v[242:243], v[242:243], v[38:39]
    v_pk_mul_f32 v[244:245], v[244:245], v[40:41]
    v_pk_mul_f32 v[246:247], v[246:247], v[42:43]
    v_pk_mul_f32 v[248:249], v[248:249], v[44:45]
    v_pk_mul_f32 v[250:251], v[250:251], v[46:47]
    v_cvt_pk_bf16_f32 v64, v236, v237
    v_cvt_pk_bf16_f32 v65, v238, v239
    v_cvt_pk_bf16_f32 v66, v240, v241
    v_cvt_pk_bf16_f32 v67, v242, v243
    v_cvt_pk_bf16_f32 v68, v244, v245
    v_cvt_pk_bf16_f32 v69, v246, v247
    v_cvt_pk_bf16_f32 v70, v248, v249
    v_cvt_pk_bf16_f32 v71, v250, v251
    buffer_store_dwordx4 v[64:67], v3, s[8:11], s17 offen offset:0 sc1
    buffer_store_dwordx4 v[68:71], v3, s[8:11], s17 offen offset:1024 sc1
    v_pk_mul_f32 v[88:89], v[32:33], v[32:33]
    v_pk_add_f32 v[90:91], v[32:33], v[34:35]
    v_pk_mul_f32 v[94:95], v[34:35], v[34:35]
    v_pk_add_f32 v[96:97], v[36:37], v[38:39]
    v_pk_fma_f32 v[88:89], v[36:37], v[36:37], v[88:89]
    v_pk_fma_f32 v[94:95], v[38:39], v[38:39], v[94:95]
    v_pk_fma_f32 v[88:89], v[40:41], v[40:41], v[88:89]
    v_pk_fma_f32 v[94:95], v[42:43], v[42:43], v[94:95]
    v_pk_fma_f32 v[88:89], v[44:45], v[44:45], v[88:89]
    v_pk_fma_f32 v[94:95], v[46:47], v[46:47], v[94:95]
    v_pk_add_f32 v[90:91], v[90:91], v[40:41]
    v_pk_add_f32 v[96:97], v[96:97], v[42:43]
    v_pk_add_f32 v[90:91], v[90:91], v[44:45]
    v_pk_add_f32 v[96:97], v[96:97], v[46:47]
    v_pk_add_f32 v[88:89], v[88:89], v[94:95]
    v_pk_add_f32 v[90:91], v[90:91], v[96:97]
    v_add_f32 v93, v88, v89
    v_add_f32 v92, v90, v91
    v_mov_b32 v94, v92
    v_mov_b32 v95, v93
    s_nop 0
    v_permlane32_swap_b32 v92, v94
    v_permlane32_swap_b32 v93, v95
    v_add_f32 v92, v92, v94
    v_add_f32 v93, v93, v95
    v_mov_b32 v94, v92
    v_mov_b32 v95, v93
    s_nop 0
    v_permlane16_swap_b32 v92, v94
    v_permlane16_swap_b32 v93, v95
    v_add_f32 v92, v92, v94
    v_add_f32 v93, v93, v95
    s_mov_b64 exec, 0xffff
    buffer_store_dwordx2 v[92:93], v6, s[8:11], s67 offen sc1
    s_mov_b64 exec, -1
    v_add_u32 v25, 0xe000, v3
    v_add_u32 v26, 0xe000, v25
    v_and_b32 v4, 7, v1
    v_lshlrev_b32 v4, 7, v4
    v_lshl_add_u32 v30, v2, 5, v4
    v_lshlrev_b32 v4, 8, v2
    v_lshl_add_u32 v27, v1, 3, v4
    v_mov_b32 v4, 2
    s_waitcnt vmcnt(0)
    s_cmp_eq_u32 s50, 0
    s_cbranch_scc1 Lslow_31
    buffer_store_dword v4, v254, s[8:11], s54 offen
    s_branch Lpub_32
Lslow_31:
    buffer_store_dword v4, v254, s[8:11], s54 offen sc1
Lpub_32:
    s_barrier
    s_and_b32 s3, s48, 1
    s_mul_i32 s66, s3, 3584
    s_lshl_b32 s3, s3, 10
    s_add_u32 m0, s3, 158720
    s_mul_i32 s3, s47, 448
    s_add_u32 s66, s66, s3
    s_add_u32 s66, s66, 192512
    v_add_u32 v6, 6720, v3
    v_cmp_gt_u32 vcc, 28, v0
    s_nop 1
    v_cndmask_b32 v6, v6, v3, vcc
    v_cmp_gt_u32 vcc, 32, v252
    s_nop 1
    s_and_b32 s3, vcc_lo, 3
    s_cbranch_scc1 L_qwait
L_qok:
    buffer_load_dwordx4 v6, s[8:11], s66 offen sc1 lds
    s_add_u32 s74, s21, 12
    s_and_b32 s74, s74, 15
    s_add_u32 s74, s74, s22
    s_mul_i32 s74, s74, 7168
    s_add_u32 s74, s74, 16891904
    s_mul_i32 s75, s48, 7168
    s_sub_u32 s75, s75, 7168
    s_cmp_eq_u32 s48, 0
    s_cselect_b32 s75, 151552, s75
    s_mov_b32 m0, s75
    s_nop 0
    buffer_load_dwordx4 v3, s[8:11], s74 offen offset:0 sc1 lds
    buffer_load_dwordx4 v3, s[8:11], s74 offen offset:1024 sc1 lds
    s_mov_b32 m0, s75
    s_nop 0
    buffer_load_dwordx4 v3, s[8:11], s74 offen offset:2048 sc1 lds
    buffer_load_dwordx4 v3, s[8:11], s74 offen offset:3072 sc1 lds
    s_add_u32 s74, s74, 4096
    s_add_u32 s75, s75, 4096
    s_mov_b32 m0, s75
    s_nop 0
    buffer_load_dwordx4 v3, s[8:11], s74 offen offset:0 sc1 lds
    buffer_load_dwordx4 v3, s[8:11], s74 offen offset:1024 sc1 lds
    s_mov_b32 m0, s75
    s_nop 0
    buffer_load_dwordx4 v3, s[8:11], s74 offen offset:2048 sc1 lds
    ds_read_b128 v[32:35], v25 offset:8192
    ds_read_b128 v[36:39], v25 offset:9216
    ds_read_b128 v[40:43], v25 offset:10240
    ds_read_b128 v[44:47], v25 offset:11264
    ds_read_b128 v[48:51], v25 offset:12288
    ds_read_b128 v[52:55], v25 offset:13312
    ds_read_b128 v[56:59], v25 offset:14336
    v_add_u32 v29, 158720, v31
    v_lshlrev_b32 v24, 2, v1
    v_add_u32 v24, 159744, v24
    s_add_u32 s66, s68, 458752
    s_waitcnt lgkmcnt(6)
    v_mfma_f32_16x16x32_bf16 v[128:131], v[64:67], v[32:35], 0
    ds_read_b128 v[204:207], v25 offset:15360
    s_waitcnt lgkmcnt(6)
    v_mfma_f32_16x16x32_bf16 v[132:135], v[64:67], v[36:39], 0
    ds_read_b128 v[208:211], v25 offset:16384
    s_waitcnt lgkmcnt(6)
    v_mfma_f32_16x16x32_bf16 v[136:139], v[64:67], v[40:43], 0
    ds_read_b128 v[212:215], v25 offset:17408
    s_waitcnt lgkmcnt(6)
    v_mfma_f32_16x16x32_bf16 v[140:143], v[64:67], v[44:47], 0
    ds_read_b128 v[216:219], v25 offset:18432
    s_waitcnt lgkmcnt(6)
    v_mfma_f32_16x16x32_bf16 v[144:147], v[64:67], v[48:51], 0
    ds_read_b128 v[220:223], v25 offset:19456
    s_waitcnt lgkmcnt(6)
    v_mfma_f32_16x16x32_bf16 v[148:151], v[64:67], v[52:55], 0
    ds_read_b128 v[224:227], v25 offset:20480
    s_waitcnt lgkmcnt(6)
    v_mfma_f32_16x16x32_bf16 v[152:155], v[64:67], v[56:59], 0
    ds_read_b128 v[228:231], v25 offset:21504
    s_waitcnt lgkmcnt(6)
    v_mfma_f32_16x16x32_bf16 v[128:131], v[68:71], v[204:207], v[128:131]
    ds_read_b128 v[32:35], v25 offset:22528
    s_waitcnt lgkmcnt(6)
    v_mfma_f32_16x16x32_bf16 v[132:135], v[68:71], v[208:211], v[132:135]
    ds_read_b128 v[36:39], v25 offset:23552
    s_waitcnt lgkmcnt(6)
    v_mfma_f32_16x16x32_bf16 v[136:139], v[68:71], v[212:215], v[136:139]
    ds_read_b128 v[40:43], v25 offset:24576
    s_waitcnt lgkmcnt(6)
    v_mfma_f32_16x16x32_bf16 v[140:143], v[68:71], v[216:219], v[140:143]
    ds_read_b128 v[44:47], v25 offset:25600
    s_waitcnt lgkmcnt(6)
    v_mfma_f32_16x16x32_bf16 v[144:147], v[68:71], v[220:223], v[144:147]
    ds_read_b128 v[48:51], v25 offset:26624
    s_waitcnt lgkmcnt(6)
    v_mfma_f32_16x16x32_bf16 v[148:151], v[68:71], v[224:227], v[148:151]
    ds_read_b128 v[52:55], v25 offset:27648
    s_waitcnt lgkmcnt(6)
    v_mfma_f32_16x16x32_bf16 v[152:155], v[68:71], v[228:231], v[152:155]
    ds_read_b128 v[56:59], v25 offset:28672
    s_add_u32 s70, s70, 16384
    s_add_u32 s71, s71, 16384
    s_add_u32 s72, s72, 16384
    s_add_u32 s73, s73, 16384
    s_add_u32 s76, s76, 16384
    s_add_u32 s0, s0, 16384
    s_add_u32 s1, s1, 16384
    s_mov_b64 exec, 0xff
    s_mov_b32 s3, 0
Lpoll_33:
    s_add_u32 s3, s3, 1
    s_cmp_gt_u32 s3, 131072
    s_cbranch_scc1 Lpollx_34
    buffer_load_dword v4, v255, s[8:11], s54 offen sc1
    s_waitcnt vmcnt(0)
    v_cmp_gt_u32 vcc, 2, v4
    s_cbranch_vccnz Lpoll_33
Lpollx_34:
    s_mov_b64 exec, -1
    buffer_load_dwordx2 v[172:173], v27, s[8:11], s66 offen sc1
    buffer_load_dwordx2 v[174:175], v27, s[8:11], s66 offen offset:128 sc1
    buffer_load_dwordx4 v[72:75], v3, s[8:11], s70 offen offset:0 sc1
    buffer_load_dwordx4 v[76:79], v3, s[8:11], s70 offen offset:1024 sc1
    buffer_load_dwordx4 v[80:83], v3, s[8:11], s71 offen offset:0 sc1
    buffer_load_dwordx4 v[84:87], v3, s[8:11], s71 offen offset:1024 sc1
    buffer_load_dwordx4 v[88:91], v3, s[8:11], s72 offen offset:0 sc1
    buffer_load_dwordx4 v[92:95], v3, s[8:11], s72 offen offset:1024 sc1
    buffer_load_dwordx4 v[96:99], v3, s[8:11], s73 offen offset:0 sc1
    buffer_load_dwordx4 v[100:103], v3, s[8:11], s73 offen offset:1024 sc1
    v_lshlrev_b32 v4, 7, v0
    v_mov_b32 v27, 2147418112
    v_cmp_gt_u32 vcc, 14, v0
    s_nop 1
    v_cndmask_b32 v27, v27, v4, vcc
    s_waitcnt vmcnt(8)
    v_pk_add_f32 v[172:173], v[172:173], v[174:175]
    v_mov_b32 v174, v172
    v_mov_b32 v175, v173
    s_nop 0
    v_permlane32_swap_b32 v172, v174
    v_permlane32_swap_b32 v173, v175
    v_add_f32 v172, v172, v174
    v_add_f32 v173, v173, v175
    v_mov_b32 v174, v172
    v_mov_b32 v175, v173
    s_nop 0
    v_permlane16_swap_b32 v172, v174
    v_permlane16_swap_b32 v173, v175
    v_add_f32 v172, v172, v174
    v_add_f32 v173, v173, v175
    v_mul_f32 v62, 0xbb000000, v172
    v_mul_f32 v173, 0x3b000000, v173
    v_fma_f32 v173, -v62, v62, v173
    v_max_f32 v173, 0, v173
    v_add_f32 v173, 0x3727c5ac, v173
    v_rsq_f32 v28, v173
    s_nop 0
    v_mul_f32 v62, v62, v28
    v_mov_b32 v60, 0xc0135761
    v_mov_b32 v61, v60
    ds_bpermute_b32 v20, v31, v28 offset:0
    ds_bpermute_b32 v16, v31, v62 offset:0
    ds_bpermute_b32 v21, v31, v28 offset:4
    ds_bpermute_b32 v17, v31, v62 offset:4
    ds_bpermute_b32 v22, v31, v28 offset:8
    ds_bpermute_b32 v18, v31, v62 offset:8
    ds_bpermute_b32 v23, v31, v28 offset:12
    ds_bpermute_b32 v19, v31, v62 offset:12
    s_waitcnt vmcnt(7)
    s_waitcnt lgkmcnt(6)
    v_mfma_f32_16x16x32_bf16 v[128:131], v[72:75], v[32:35], v[128:131]
    ds_read_b128 v[204:207], v25 offset:29696
    buffer_load_dwordx4 v[104:107], v3, s[8:11], s76 offen offset:0 sc1
    s_waitcnt lgkmcnt(6)
    v_mfma_f32_16x16x32_bf16 v[132:135], v[72:75], v[36:39], v[132:135]
    ds_read_b128 v[208:211], v25 offset:30720
    s_waitcnt lgkmcnt(6)
    v_mfma_f32_16x16x32_bf16 v[136:139], v[72:75], v[40:43], v[136:139]
    ds_read_b128 v[212:215], v25 offset:31744
    s_waitcnt lgkmcnt(6)
    v_mfma_f32_16x16x32_bf16 v[140:143], v[72:75], v[44:47], v[140:143]
    ds_read_b128 v[216:219], v25 offset:32768
    s_waitcnt lgkmcnt(6)
    v_mfma_f32_16x16x32_bf16 v[144:147], v[72:75], v[48:51], v[144:147]
    ds_read_b128 v[220:223], v25 offset:33792
    s_waitcnt lgkmcnt(6)
    v_mfma_f32_16x16x32_bf16 v[148:151], v[72:75], v[52:55], v[148:151]
    ds_read_b128 v[224:227], v25 offset:34816
    s_waitcnt lgkmcnt(6)
    v_mfma_f32_16x16x32_bf16 v[152:155], v[72:75], v[56:59], v[152:155]
    ds_read_b128 v[228:231], v25 offset:35840
    s_waitcnt vmcnt(7)
    s_waitcnt lgkmcnt(6)
    v_mfma_f32_16x16x32_bf16 v[128:131], v[76:79], v[204:207], v[128:131]
    ds_read_b128 v[32:35], v25 offset:36864
    buffer_load_dwordx4 v[108:111], v3, s[8:11], s76 offen offset:1024 sc1
    s_waitcnt lgkmcnt(6)
    v_mfma_f32_16x16x32_bf16 v[132:135], v[76:79], v[208:211], v[132:135]
    ds_read_b128 v[36:39], v25 offset:37888
    s_waitcnt lgkmcnt(6)
    v_mfma_f32_16x16x32_bf16 v[136:139], v[76:79], v[212:215], v[136:139]
    ds_read_b128 v[40:43], v25 offset:38912
    s_waitcnt lgkmcnt(6)
    v_mfma_f32_16x16x32_bf16 v[140:143], v[76:79], v[216:219], v[140:143]
    ds_read_b128 v[44:47], v25 offset:39936
    s_waitcnt lgkmcnt(6)
    v_mfma_f32_16x16x32_bf16 v[144:147], v[76:79], v[220:223], v[144:147]
    ds_read_b128 v[48:51], v25 offset:40960
    s_waitcnt lgkmcnt(6)
    v_mfma_f32_16x16x32_bf16 v[148:151], v[76:79], v[224:227], v[148:151]
    ds_read_b128 v[52:55], v25 offset:41984
    s_waitcnt lgkmcnt(6)
    v_mfma_f32_16x16x32_bf16 v[152:155], v[76:79], v[228:231], v[152:155]
    ds_read_b128 v[56:59], v25 offset:43008
    s_waitcnt vmcnt(7)
    s_waitcnt lgkmcnt(6)
    v_mfma_f32_16x16x32_bf16 v[128:131], v[80:83], v[32:35], v[128:131]
    ds_read_b128 v[204:207], v25 offset:44032
    buffer_load_dwordx4 v[112:115], v3, s[8:11], s0 offen offset:0 sc1
    s_waitcnt lgkmcnt(6)
    v_mfma_f32_16x16x32_bf16 v[132:135], v[80:83], v[36:39], v[132:135]
    ds_read_b128 v[208:211], v25 offset:45056
    s_waitcnt lgkmcnt(6)
    v_mfma_f32_16x16x32_bf16 v[136:139], v[80:83], v[40:43], v[136:139]
    ds_read_b128 v[212:215], v25 offset:46080
    s_waitcnt lgkmcnt(6)
    v_mfma_f32_16x16x32_bf16 v[140:143], v[80:83], v[44:47], v[140:143]
    ds_read_b128 v[216:219], v25 offset:47104
    s_waitcnt lgkmcnt(6)
    v_mfma_f32_16x16x32_bf16 v[144:147], v[80:83], v[48:51], v[144:147]
    ds_read_b128 v[220:223], v25 offset:48128
    s_waitcnt lgkmcnt(6)
    v_mfma_f32_16x16x32_bf16 v[148:151], v[80:83], v[52:55], v[148:151]
    ds_read_b128 v[224:227], v25 offset:49152
    s_waitcnt lgkmcnt(6)
    v_mfma_f32_16x16x32_bf16 v[152:155], v[80:83], v[56:59], v[152:155]
    ds_read_b128 v[228:231], v25 offset:50176
    s_waitcnt vmcnt(7)
    s_waitcnt lgkmcnt(6)
    v_mfma_f32_16x16x32_bf16 v[128:131], v[84:87], v[204:207], v[128:131]
    ds_read_b128 v[32:35], v25 offset:51200
    buffer_load_dwordx4 v[116:119], v3, s[8:11], s0 offen offset:1024 sc1
    s_waitcnt lgkmcnt(6)
    v_mfma_f32_16x16x32_bf16 v[132:135], v[84:87], v[208:211], v[132:135]
    ds_read_b128 v[36:39], v25 offset:52224
    s_waitcnt lgkmcnt(6)
    v_mfma_f32_16x16x32_bf16 v[136:139], v[84:87], v[212:215], v[136:139]
    ds_read_b128 v[40:43], v25 offset:53248
    s_waitcnt lgkmcnt(6)
    v_mfma_f32_16x16x32_bf16 v[140:143], v[84:87], v[216:219], v[140:143]
    ds_read_b128 v[44:47], v25 offset:54272
    s_waitcnt lgkmcnt(6)
    v_mfma_f32_16x16x32_bf16 v[144:147], v[84:87], v[220:223], v[144:147]
    ds_read_b128 v[48:51], v25 offset:55296
    s_waitcnt lgkmcnt(6)
    v_mfma_f32_16x16x32_bf16 v[148:151], v[84:87], v[224:227], v[148:151]
    ds_read_b128 v[52:55], v25 offset:56320
    s_waitcnt lgkmcnt(6)
    v_mfma_f32_16x16x32_bf16 v[152:155], v[84:87], v[228:231], v[152:155]
    ds_read_b128 v[56:59], v26 offset:0
    s_waitcnt vmcnt(7)
    s_waitcnt lgkmcnt(6)
    v_mfma_f32_16x16x32_bf16 v[128:131], v[88:91], v[32:35], v[128:131]
    ds_read_b128 v[204:207], v26 offset:1024
    buffer_load_dwordx4 v[120:123], v3, s[8:11], s1 offen offset:0 sc1
    s_waitcnt lgkmcnt(6)
    v_mfma_f32_16x16x32_bf16 v[132:135], v[88:91], v[36:39], v[132:135]
    ds_read_b128 v[208:211], v26 offset:2048
    s_waitcnt lgkmcnt(6)
    v_mfma_f32_16x16x32_bf16 v[136:139], v[88:91], v[40:43], v[136:139]
    ds_read_b128 v[212:215], v26 offset:3072
    s_waitcnt lgkmcnt(6)
    v_mfma_f32_16x16x32_bf16 v[140:143], v[88:91], v[44:47], v[140:143]
    ds_read_b128 v[216:219], v26 offset:4096
    s_waitcnt lgkmcnt(6)
    v_mfma_f32_16x16x32_bf16 v[144:147], v[88:91], v[48:51], v[144:147]
    ds_read_b128 v[220:223], v26 offset:5120
    s_waitcnt lgkmcnt(6)
    v_mfma_f32_16x16x32_bf16 v[148:151], v[88:91], v[52:55], v[148:151]
    ds_read_b128 v[224:227], v26 offset:6144
    s_waitcnt lgkmcnt(6)
    v_mfma_f32_16x16x32_bf16 v[152:155], v[88:91], v[56:59], v[152:155]
    ds_read_b128 v[228:231], v26 offset:7168
    s_waitcnt vmcnt(7)
    s_waitcnt lgkmcnt(6)
    v_mfma_f32_16x16x32_bf16 v[128:131], v[92:95], v[204:207], v[128:131]
    ds_read_b128 v[32:35], v26 offset:8192
    buffer_load_dwordx4 v[124:127], v3, s[8:11], s1 offen offset:1024 sc1
    s_waitcnt lgkmcnt(6)
    v_mfma_f32_16x16x32_bf16 v[132:135], v[92:95], v[208:211], v[132:135]
    ds_read_b128 v[36:39], v26 offset:9216
    s_waitcnt lgkmcnt(6)
    v_mfma_f32_16x16x32_bf16 v[136:139], v[92:95], v[212:215], v[136:139]
    ds_read_b128 v[40:43], v26 offset:10240
    s_waitcnt lgkmcnt(6)
    v_mfma_f32_16x16x32_bf16 v[140:143], v[92:95], v[216:219], v[140:143]
    ds_read_b128 v[44:47], v26 offset:11264
    s_waitcnt lgkmcnt(6)
    v_mfma_f32_16x16x32_bf16 v[144:147], v[92:95], v[220:223], v[144:147]
    ds_read_b128 v[48:51], v26 offset:12288
    s_waitcnt lgkmcnt(6)
    v_mfma_f32_16x16x32_bf16 v[148:151], v[92:95], v[224:227], v[148:151]
    ds_read_b128 v[52:55], v26 offset:13312
    s_waitcnt lgkmcnt(6)
    v_mfma_f32_16x16x32_bf16 v[152:155], v[92:95], v[228:231], v[152:155]
    ds_read_b128 v[56:59], v26 offset:14336
    s_waitcnt vmcnt(7)
    s_waitcnt lgkmcnt(6)
    v_mfma_f32_16x16x32_bf16 v[128:131], v[96:99], v[32:35], v[128:131]
    ds_read_b128 v[204:207], v26 offset:15360
    s_waitcnt lgkmcnt(6)
    v_mfma_f32_16x16x32_bf16 v[132:135], v[96:99], v[36:39], v[132:135]
    ds_read_b128 v[208:211], v26 offset:16384
    s_waitcnt lgkmcnt(6)
    v_mfma_f32_16x16x32_bf16 v[136:139], v[96:99], v[40:43], v[136:139]
    ds_read_b128 v[212:215], v26 offset:17408
    s_waitcnt lgkmcnt(6)
    v_mfma_f32_16x16x32_bf16 v[140:143], v[96:99], v[44:47], v[140:143]
    ds_read_b128 v[216:219], v26 offset:18432
    s_add_u32 s74, s21, 0
    s_and_b32 s74, s74, 15
    s_add_u32 s74, s74, s22
    s_mul_i32 s74, s74, 7168
    s_add_u32 s74, s74, 16777216
    s_mul_i32 s75, s48, 7168
    s_add_u32 s75, s75, 21504
    s_mov_b32 m0, s75
    s_nop 0
    buffer_load_dwordx4 v3, s[8:11], s74 offen offset:0 sc1 lds
    buffer_load_dwordx4 v3, s[8:11], s74 offen offset:1024 sc1 lds
    s_waitcnt lgkmcnt(6)
    v_mfma_f32_16x16x32_bf16 v[144:147], v[96:99], v[48:51], v[144:147]
    ds_read_b128 v[220:223], v26 offset:19456
    s_waitcnt lgkmcnt(6)
    v_mfma_f32_16x16x32_bf16 v[148:151], v[96:99], v[52:55], v[148:151]
    ds_read_b128 v[224:227], v26 offset:20480
    s_waitcnt lgkmcnt(6)
    v_mfma_f32_16x16x32_bf16 v[152:155], v[96:99], v[56:59], v[152:155]
    ds_read_b128 v[228:231], v26 offset:21504
    s_waitcnt vmcnt(8)
    s_waitcnt lgkmcnt(6)
    v_mfma_f32_16x16x32_bf16 v[128:131], v[100:103], v[204:207], v[128:131]
    ds_read_b128 v[32:35], v26 offset:22528
    s_waitcnt lgkmcnt(6)
    v_mfma_f32_16x16x32_bf16 v[132:135], v[100:103], v[208:211], v[132:135]
    ds_read_b128 v[36:39], v26 offset:23552
    s_waitcnt lgkmcnt(6)
    v_mfma_f32_16x16x32_bf16 v[136:139], v[100:103], v[212:215], v[136:139]
    ds_read_b128 v[40:43], v26 offset:24576
    s_waitcnt lgkmcnt(6)
    v_mfma_f32_16x16x32_bf16 v[140:143], v[100:103], v[216:219], v[140:143]
    ds_read_b128 v[44:47], v26 offset:25600
    buffer_load_dword v252, v27, s[8:11], s26 offen sc1
    s_add_u32 s26, s26, 1792
    s_waitcnt lgkmcnt(6)
    v_mfma_f32_16x16x32_bf16 v[144:147], v[100:103], v[220:223], v[144:147]
    ds_read_b128 v[48:51], v26 offset:26624
    s_waitcnt lgkmcnt(6)
    v_mfma_f32_16x16x32_bf16 v[148:151], v[100:103], v[224:227], v[148:151]
    ds_read_b128 v[52:55], v26 offset:27648
    s_waitcnt lgkmcnt(6)
    v_mfma_f32_16x16x32_bf16 v[152:155], v[100:103], v[228:231], v[152:155]
    ds_read_b128 v[56:59], v26 offset:28672
    s_waitcnt vmcnt(8)
    s_waitcnt lgkmcnt(6)
    v_mfma_f32_16x16x32_bf16 v[128:131], v[104:107], v[32:35], v[128:131]
    ds_read_b128 v[204:207], v26 offset:29696
    s_waitcnt lgkmcnt(6)
    v_mfma_f32_16x16x32_bf16 v[132:135], v[104:107], v[36:39], v[132:135]
    ds_read_b128 v[208:211], v26 offset:30720
    s_waitcnt lgkmcnt(6)
    v_mfma_f32_16x16x32_bf16 v[136:139], v[104:107], v[40:43], v[136:139]
    ds_read_b128 v[212:215], v26 offset:31744
    s_waitcnt lgkmcnt(6)
    v_mfma_f32_16x16x32_bf16 v[140:143], v[104:107], v[44:47], v[140:143]
    ds_read_b128 v[216:219], v26 offset:32768
    s_mov_b32 m0, s75
    s_nop 0
    buffer_load_dwordx4 v3, s[8:11], s74 offen offset:2048 sc1 lds
    buffer_load_dwordx4 v3, s[8:11], s74 offen offset:3072 sc1 lds
    s_add_u32 s74, s74, 4096
    s_add_u32 s75, s75, 4096
    s_waitcnt lgkmcnt(6)
    v_mfma_f32_16x16x32_bf16 v[144:147], v[104:107], v[48:51], v[144:147]
    ds_read_b128 v[220:223], v26 offset:33792
    s_waitcnt lgkmcnt(6)
    v_mfma_f32_16x16x32_bf16 v[148:151], v[104:107], v[52:55], v[148:151]
    ds_read_b128 v[224:227], v26 offset:34816
    s_waitcnt lgkmcnt(6)
    v_mfma_f32_16x16x32_bf16 v[152:155], v[104:107], v[56:59], v[152:155]
    ds_read_b128 v[228:231], v26 offset:35840
    s_waitcnt lgkmcnt(0)
    s_barrier
    s_waitcnt vmcnt(9)
    s_waitcnt lgkmcnt(6)
    v_mfma_f32_16x16x32_bf16 v[128:131], v[108:111], v[204:207], v[128:131]
    ds_read_b128 v[32:35], v26 offset:36864
    s_waitcnt lgkmcnt(6)
    v_mfma_f32_16x16x32_bf16 v[132:135], v[108:111], v[208:211], v[132:135]
    ds_read_b128 v[36:39], v26 offset:37888
    s_waitcnt lgkmcnt(6)
    v_mfma_f32_16x16x32_bf16 v[136:139], v[108:111], v[212:215], v[136:139]
    ds_read_b128 v[40:43], v26 offset:38912
    s_waitcnt lgkmcnt(6)
    v_mfma_f32_16x16x32_bf16 v[140:143], v[108:111], v[216:219], v[140:143]
    ds_read_b128 v[44:47], v26 offset:39936
    buffer_load_dword v252, v27, s[8:11], s26 offen sc1
    s_add_u32 s26, s26, 1792
    s_waitcnt lgkmcnt(6)
    v_mfma_f32_16x16x32_bf16 v[144:147], v[108:111], v[220:223], v[144:147]
    ds_read_b128 v[48:51], v26 offset:40960
    s_waitcnt lgkmcnt(6)
    v_mfma_f32_16x16x32_bf16 v[148:151], v[108:111], v[224:227], v[148:151]
    ds_read_b128 v[52:55], v26 offset:41984
    s_waitcnt lgkmcnt(6)
    v_mfma_f32_16x16x32_bf16 v[152:155], v[108:111], v[228:231], v[152:155]
    ds_read_b128 v[56:59], v26 offset:43008
    s_waitcnt vmcnt(9)
    s_waitcnt lgkmcnt(6)
    v_mfma_f32_16x16x32_bf16 v[128:131], v[112:115], v[32:35], v[128:131]
    ds_read_b128 v[204:207], v3 offset:0
    s_waitcnt lgkmcnt(6)
    v_mfma_f32_16x16x32_bf16 v[132:135], v[112:115], v[36:39], v[132:135]
    ds_read_b128 v[208:211], v3 offset:1024
    s_waitcnt lgkmcnt(6)
    v_mfma_f32_16x16x32_bf16 v[136:139], v[112:115], v[40:43], v[136:139]
    ds_read_b128 v[212:215], v3 offset:2048
    s_waitcnt lgkmcnt(6)
    v_mfma_f32_16x16x32_bf16 v[140:143], v[112:115], v[44:47], v[140:143]
    ds_read_b128 v[216:219], v3 offset:3072
    s_mov_b32 m0, s75
    s_nop 0
    buffer_load_dwordx4 v3, s[8:11], s74 offen offset:0 sc1 lds
    buffer_load_dwordx4 v3, s[8:11], s74 offen offset:1024 sc1 lds
    s_waitcnt lgkmcnt(6)
    v_mfma_f32_16x16x32_bf16 v[144:147], v[112:115], v[48:51], v[144:147]
    ds_read_b128 v[220:223], v3 offset:4096
    s_waitcnt lgkmcnt(6)
    v_mfma_f32_16x16x32_bf16 v[148:151], v[112:115], v[52:55], v[148:151]
    ds_read_b128 v[224:227], v3 offset:5120
    s_waitcnt lgkmcnt(6)
    v_mfma_f32_16x16x32_bf16 v[152:155], v[112:115], v[56:59], v[152:155]
    ds_read_b128 v[228:231], v3 offset:6144
    s_waitcnt vmcnt(10)
    s_waitcnt lgkmcnt(6)
    v_mfma_f32_16x16x32_bf16 v[128:131], v[116:119], v[204:207], v[128:131]
    ds_read_b128 v[32:35], v3 offset:7168
    s_waitcnt lgkmcnt(6)
    v_mfma_f32_16x16x32_bf16 v[132:135], v[116:119], v[208:211], v[132:135]
    ds_read_b128 v[36:39], v3 offset:8192
    s_waitcnt lgkmcnt(6)
    v_mfma_f32_16x16x32_bf16 v[136:139], v[116:119], v[212:215], v[136:139]
    ds_read_b128 v[40:43], v3 offset:9216
    s_waitcnt lgkmcnt(6)
    v_mfma_f32_16x16x32_bf16 v[140:143], v[116:119], v[216:219], v[140:143]
    ds_read_b128 v[44:47], v3 offset:10240
    buffer_load_dword v252, v27, s[8:11], s26 offen sc1
    s_add_u32 s26, s26, 1792
    s_waitcnt lgkmcnt(6)
    v_mfma_f32_16x16x32_bf16 v[144:147], v[116:119], v[220:223], v[144:147]
    ds_read_b128 v[48:51], v3 offset:11264
    s_waitcnt lgkmcnt(6)
    v_mfma_f32_16x16x32_bf16 v[148:151], v[116:119], v[224:227], v[148:151]
    ds_read_b128 v[52:55], v3 offset:12288
    s_waitcnt lgkmcnt(6)
    v_mfma_f32_16x16x32_bf16 v[152:155], v[116:119], v[228:231], v[152:155]
    ds_read_b128 v[56:59], v3 offset:13312
    s_waitcnt vmcnt(10)
    s_waitcnt lgkmcnt(6)
    v_mfma_f32_16x16x32_bf16 v[128:131], v[120:123], v[32:35], v[128:131]
    ds_read_b128 v[204:207], v3 offset:14336
    s_waitcnt lgkmcnt(6)
    v_mfma_f32_16x16x32_bf16 v[132:135], v[120:123], v[36:39], v[132:135]
    ds_read_b128 v[208:211], v3 offset:15360
    s_waitcnt lgkmcnt(6)
    v_mfma_f32_16x16x32_bf16 v[136:139], v[120:123], v[40:43], v[136:139]
    ds_read_b128 v[212:215], v3 offset:16384
    s_waitcnt lgkmcnt(6)
    v_mfma_f32_16x16x32_bf16 v[140:143], v[120:123], v[44:47], v[140:143]
    ds_read_b128 v[216:219], v3 offset:17408
    s_mov_b32 m0, s75
    s_nop 0
    buffer_load_dwordx4 v3, s[8:11], s74 offen offset:2048 sc1 lds
    s_waitcnt lgkmcnt(6)
    v_mfma_f32_16x16x32_bf16 v[144:147], v[120:123], v[48:51], v[144:147]
    ds_read_b128 v[220:223], v3 offset:18432
    s_waitcnt lgkmcnt(6)
    v_mfma_f32_16x16x32_bf16 v[148:151], v[120:123], v[52:55], v[148:151]
    ds_read_b128 v[224:227], v3 offset:19456
    s_waitcnt lgkmcnt(6)
    v_mfma_f32_16x16x32_bf16 v[152:155], v[120:123], v[56:59], v[152:155]
    ds_read_b128 v[228:231], v3 offset:20480
    s_waitcnt vmcnt(10)
    s_waitcnt lgkmcnt(6)
    v_mfma_f32_16x16x32_bf16 v[128:131], v[124:127], v[204:207], v[128:131]
    s_waitcnt lgkmcnt(5)
    v_mfma_f32_16x16x32_bf16 v[132:135], v[124:127], v[208:211], v[132:135]
    s_waitcnt lgkmcnt(4)
    v_mfma_f32_16x16x32_bf16 v[136:139], v[124:127], v[212:215], v[136:139]
    s_waitcnt lgkmcnt(3)
    v_mfma_f32_16x16x32_bf16 v[140:143], v[124:127], v[216:219], v[140:143]
    buffer_load_dword v252, v27, s[8:11], s26 offen sc1
    s_add_u32 s26, s26, 1792
    s_waitcnt lgkmcnt(2)
    v_mfma_f32_16x16x32_bf16 v[144:147], v[124:127], v[220:223], v[144:147]
    s_waitcnt lgkmcnt(1)
    v_mfma_f32_16x16x32_bf16 v[148:151], v[124:127], v[224:227], v[148:151]
    s_waitcnt lgkmcnt(0)
    v_mfma_f32_16x16x32_bf16 v[152:155], v[124:127], v[228:231], v[152:155]
    ds_read2_b32 v[232:233], v24 offset0:0 offset1:112
    ds_read2_b32 v[234:235], v24 offset0:16 offset1:128
    ds_read2_b32 v[236:237], v24 offset0:32 offset1:144
    ds_read2_b32 v[238:239], v24 offset0:48 offset1:160
    ds_read2_b32 v[240:241], v24 offset0:64 offset1:176
    ds_read2_b32 v[242:243], v24 offset0:80 offset1:192
    ds_read2_b32 v[244:245], v24 offset0:96 offset1:208
    s_mov_b32 s64, 0xbdd2d3e8
    s_mov_b32 s65, s64
    s_mov_b32 s66, 1.0
    s_mov_b32 s67, 1.0
    s_waitcnt lgkmcnt(0)
    v_pk_fma_f32 v[32:33], v[16:17], v[232:233], v[232:233] op_sel:[0,0,1] op_sel_hi:[1,0,1]
    v_pk_fma_f32 v[34:35], v[18:19], v[232:233], v[232:233] op_sel:[0,0,1] op_sel_hi:[1,0,1]
    v_pk_fma_f32 v[36:37], v[16:17], v[234:235], v[234:235] op_sel:[0,0,1] op_sel_hi:[1,0,1]
    v_pk_fma_f32 v[38:39], v[18:19], v[234:235], v[234:235] op_sel:[0,0,1] op_sel_hi:[1,0,1]
    v_pk_fma_f32 v[40:41], v[16:17], v[236:237], v[236:237] op_sel:[0,0,1] op_sel_hi:[1,0,1]
    v_pk_fma_f32 v[42:43], v[18:19], v[236:237], v[236:237] op_sel:[0,0,1] op_sel_hi:[1,0,1]
    v_pk_fma_f32 v[44:45], v[16:17], v[238:239], v[238:239] op_sel:[0,0,1] op_sel_hi:[1,0,1]
    v_pk_fma_f32 v[46:47], v[18:19], v[238:239], v[238:239] op_sel:[0,0,1] op_sel_hi:[1,0,1]
    v_pk_fma_f32 v[48:49], v[16:17], v[240:241], v[240:241] op_sel:[0,0,1] op_sel_hi:[1,0,1]
    v_pk_fma_f32 v[50:51], v[18:19], v[240:241], v[240:241] op_sel:[0,0,1] op_sel_hi:[1,0,1]
    v_pk_fma_f32 v[52:53], v[16:17], v[242:243], v[242:243] op_sel:[0,0,1] op_sel_hi:[1,0,1]
    v_pk_fma_f32 v[54:55], v[18:19], v[242:243], v[242:243] op_sel:[0,0,1] op_sel_hi:[1,0,1]
    v_pk_fma_f32 v[56:57], v[16:17], v[244:245], v[244:245] op_sel:[0,0,1] op_sel_hi:[1,0,1]
    v_pk_fma_f32 v[58:59], v[18:19], v[244:245], v[244:245] op_sel:[0,0,1] op_sel_hi:[1,0,1]
    v_pk_fma_f32 v[128:129], v[128:129], v[20:21], v[32:33]
    v_pk_fma_f32 v[130:131], v[130:131], v[22:23], v[34:35]
    v_pk_fma_f32 v[132:133], v[132:133], v[20:21], v[36:37]
    v_pk_fma_f32 v[134:135], v[134:135], v[22:23], v[38:39]
    v_pk_fma_f32 v[136:137], v[136:137], v[20:21], v[40:41]
    v_pk_fma_f32 v[138:139], v[138:139], v[22:23], v[42:43]
    v_pk_fma_f32 v[140:141], v[140:141], v[20:21], v[44:45]
    v_pk_fma_f32 v[142:143], v[142:143], v[22:23], v[46:47]
    v_pk_fma_f32 v[144:145], v[144:145], v[20:21], v[48:49]
    v_pk_fma_f32 v[146:147], v[146:147], v[22:23], v[50:51]
    v_pk_fma_f32 v[148:149], v[148:149], v[20:21], v[52:53]
    v_pk_fma_f32 v[150:151], v[150:151], v[22:23], v[54:55]
    v_pk_fma_f32 v[152:153], v[152:153], v[20:21], v[56:57]
    v_pk_fma_f32 v[154:155], v[154:155], v[22:23], v[58:59]
    s_add_u32 s74, s21, 4
    s_and_b32 s74, s74, 15
    s_add_u32 s74, s74, s22
    s_mul_i32 s74, s74, 7168
    s_add_u32 s74, s74, 16777216
    s_mul_i32 s75, s48, 7168
    s_add_u32 s75, s75, 65536
    s_mov_b32 m0, s75
    s_nop 0
    buffer_load_dwordx4 v3, s[8:11], s74 offen offset:0 sc1 lds
    buffer_load_dwordx4 v3, s[8:11], s74 offen offset:1024 sc1 lds
    v_pk_mul_f32 v[32:33], v[128:129], v[128:129]
    v_pk_mul_f32 v[34:35], v[130:131], v[130:131]
    v_pk_mul_f32 v[36:37], v[132:133], v[132:133]
    v_pk_mul_f32 v[38:39], v[134:135], v[134:135]
    v_pk_mul_f32 v[40:41], v[136:137], v[136:137]
    v_pk_mul_f32 v[42:43], v[138:139], v[138:139]
    v_pk_mul_f32 v[44:45], v[140:141], v[140:141]
    v_pk_mul_f32 v[46:47], v[142:143], v[142:143]
    v_pk_mul_f32 v[48:49], v[144:145], v[144:145]
    v_pk_mul_f32 v[50:51], v[146:147], v[146:147]
    s_mov_b32 m0, s75
    s_nop 0
    buffer_load_dwordx4 v3, s[8:11], s74 offen offset:2048 sc1 lds
    buffer_load_dwordx4 v3, s[8:11], s74 offen offset:3072 sc1 lds
    s_add_u32 s74, s74, 4096
    s_add_u32 s75, s75, 4096
    v_pk_mul_f32 v[52:53], v[148:149], v[148:149]
    v_pk_mul_f32 v[54:55], v[150:151], v[150:151]
    v_pk_mul_f32 v[56:57], v[152:153], v[152:153]
    v_pk_mul_f32 v[58:59], v[154:155], v[154:155]
    v_pk_fma_f32 v[32:33], v[32:33], s[64:65], v[60:61]
    v_pk_fma_f32 v[34:35], v[34:35], s[64:65], v[60:61]
    v_pk_fma_f32 v[36:37], v[36:37], s[64:65], v[60:61]
    v_pk_fma_f32 v[38:39], v[38:39], s[64:65], v[60:61]
    v_pk_fma_f32 v[40:41], v[40:41], s[64:65], v[60:61]
    v_pk_fma_f32 v[42:43], v[42:43], s[64:65], v[60:61]
    s_mov_b32 m0, s75
    s_nop 0
    buffer_load_dwordx4 v3, s[8:11], s74 offen offset:0 sc1 lds
    buffer_load_dwordx4 v3, s[8:11], s74 offen offset:1024 sc1 lds
    v_pk_fma_f32 v[44:45], v[44:45], s[64:65], v[60:61]
    v_pk_fma_f32 v[46:47], v[46:47], s[64:65], v[60:61]
    v_pk_fma_f32 v[48:49], v[48:49], s[64:65], v[60:61]
    v_pk_fma_f32 v[50:51], v[50:51], s[64:65], v[60:61]
    v_pk_fma_f32 v[52:53], v[52:53], s[64:65], v[60:61]
    v_pk_fma_f32 v[54:55], v[54:55], s[64:65], v[60:61]
    v_pk_fma_f32 v[56:57], v[56:57], s[64:65], v[60:61]
    v_pk_fma_f32 v[58:59], v[58:59], s[64:65], v[60:61]
    v_pk_mul_f32 v[32:33], v[32:33], v[128:129]
    v_pk_mul_f32 v[34:35], v[34:35], v[130:131]
    s_mov_b32 m0, s75
    s_nop 0
    buffer_load_dwordx4 v3, s[8:11], s74 offen offset:2048 sc1 lds
    v_pk_mul_f32 v[36:37], v[36:37], v[132:133]
    v_pk_mul_f32 v[38:39], v[38:39], v[134:135]
    v_pk_mul_f32 v[40:41], v[40:41], v[136:137]
    v_pk_mul_f32 v[42:43], v[42:43], v[138:139]
    v_pk_mul_f32 v[44:45], v[44:45], v[140:141]
    v_pk_mul_f32 v[46:47], v[46:47], v[142:143]
    v_pk_mul_f32 v[48:49], v[48:49], v[144:145]
    v_pk_mul_f32 v[50:51], v[50:51], v[146:147]
    v_pk_mul_f32 v[52:53], v[52:53], v[148:149]
    v_pk_mul_f32 v[54:55], v[54:55], v[150:151]
    s_add_u32 s74, s21, 8
    s_and_b32 s74, s74, 15
    s_add_u32 s74, s74, s22
    s_mul_i32 s74, s74, 7168
    s_add_u32 s74, s74, 16777216
    s_mul_i32 s75, s48, 7168
    s_add_u32 s75, s75, 94208
    s_mov_b32 m0, s75
    s_nop 0
    buffer_load_dwordx4 v3, s[8:11], s74 offen offset:0 sc1 lds
    buffer_load_dwordx4 v3, s[8:11], s74 offen offset:1024 sc1 lds
    v_pk_mul_f32 v[56:57], v[56:57], v[152:153]
    v_pk_mul_f32 v[58:59], v[58:59], v[154:155]
    v_exp_f32 v32, v32
    v_exp_f32 v33, v33
    v_exp_f32 v34, v34
    v_exp_f32 v35, v35
    v_exp_f32 v36, v36
    v_exp_f32 v37, v37
    v_exp_f32 v38, v38
    v_exp_f32 v39, v39
    s_mov_b32 m0, s75
    s_nop 0
    buffer_load_dwordx4 v3, s[8:11], s74 offen offset:2048 sc1 lds
    buffer_load_dwordx4 v3, s[8:11], s74 offen offset:3072 sc1 lds
    s_add_u32 s74, s74, 4096
    s_add_u32 s75, s75, 4096
    v_exp_f32 v40, v40
    v_exp_f32 v41, v41
    v_exp_f32 v42, v42
    v_exp_f32 v43, v43
    v_exp_f32 v44, v44
    v_exp_f32 v45, v45
    v_exp_f32 v46, v46
    v_exp_f32 v47, v47
    v_exp_f32 v48, v48
    v_exp_f32 v49, v49
    s_mov_b32 m0, s75
    s_nop 0
    buffer_load_dwordx4 v3, s[8:11], s74 offen offset:0 sc1 lds
    buffer_load_dwordx4 v3, s[8:11], s74 offen offset:1024 sc1 lds
    v_exp_f32 v50, v50
    v_exp_f32 v51, v51
    v_exp_f32 v52, v52
    v_exp_f32 v53, v53
    v_exp_f32 v54, v54
    v_exp_f32 v55, v55
    v_exp_f32 v56, v56
    v_exp_f32 v57, v57
    v_exp_f32 v58, v58
    v_exp_f32 v59, v59
    s_mov_b32 m0, s75
    s_nop 0
    buffer_load_dwordx4 v3, s[8:11], s74 offen offset:2048 sc1 lds
    v_pk_add_f32 v[32:33], v[32:33], s[66:67]
    v_pk_add_f32 v[34:35], v[34:35], s[66:67]
    v_pk_add_f32 v[36:37], v[36:37], s[66:67]
    v_pk_add_f32 v[38:39], v[38:39], s[66:67]
    v_pk_add_f32 v[40:41], v[40:41], s[66:67]
    v_pk_add_f32 v[42:43], v[42:43], s[66:67]
    v_pk_add_f32 v[44:45], v[44:45], s[66:67]
    v_pk_add_f32 v[46:47], v[46:47], s[66:67]
    v_pk_add_f32 v[48:49], v[48:49], s[66:67]
    v_pk_add_f32 v[50:51], v[50:51], s[66:67]
    s_add_u32 s74, s21, 12
    s_and_b32 s74, s74, 15
    s_add_u32 s74, s74, s22
    s_mul_i32 s74, s74, 7168
    s_add_u32 s74, s74, 16777216
    s_mul_i32 s75, s48, 7168
    s_add_u32 s75, s75, 122880
    s_mov_b32 m0, s75
    s_nop 0
    buffer_load_dwordx4 v3, s[8:11], s74 offen offset:0 sc1 lds
    buffer_load_dwordx4 v3, s[8:11], s74 offen offset:1024 sc1 lds
    v_pk_add_f32 v[52:53], v[52:53], s[66:67]
    v_pk_add_f32 v[54:55], v[54:55], s[66:67]
    v_pk_add_f32 v[56:57], v[56:57], s[66:67]
    v_pk_add_f32 v[58:59], v[58:59], s[66:67]
    v_rcp_f32 v32, v32
    v_rcp_f32 v33, v33
    v_rcp_f32 v34, v34
    v_rcp_f32 v35, v35
    v_rcp_f32 v36, v36
    v_rcp_f32 v37, v37
    s_mov_b32 m0, s75
    s_nop 0
    buffer_load_dwordx4 v3, s[8:11], s74 offen offset:2048 sc1 lds
    buffer_load_dwordx4 v3, s[8:11], s74 offen offset:3072 sc1 lds
    s_add_u32 s74, s74, 4096
    s_add_u32 s75, s75, 4096
    v_rcp_f32 v38, v38
    v_rcp_f32 v39, v39
    v_rcp_f32 v40, v40
    v_rcp_f32 v41, v41
    v_rcp_f32 v42, v42
    v_rcp_f32 v43, v43
    v_rcp_f32 v44, v44
    v_rcp_f32 v45, v45
    v_rcp_f32 v46, v46
    v_rcp_f32 v47, v47
    s_mov_b32 m0, s75
    s_nop 0
    buffer_load_dwordx4 v3, s[8:11], s74 offen offset:0 sc1 lds
    buffer_load_dwordx4 v3, s[8:11], s74 offen offset:1024 sc1 lds
    v_rcp_f32 v48, v48
    v_rcp_f32 v49, v49
    v_rcp_f32 v50, v50
    v_rcp_f32 v51, v51
    v_rcp_f32 v52, v52
    v_rcp_f32 v53, v53
    v_rcp_f32 v54, v54
    v_rcp_f32 v55, v55
    v_rcp_f32 v56, v56
    v_rcp_f32 v57, v57
    s_mov_b32 m0, s75
    s_nop 0
    buffer_load_dwordx4 v3, s[8:11], s74 offen offset:2048 sc1 lds
    v_rcp_f32 v58, v58
    v_rcp_f32 v59, v59
    v_pk_mul_f32 v[128:129], v[128:129], v[32:33]
    v_pk_mul_f32 v[130:131], v[130:131], v[34:35]
    v_pk_mul_f32 v[132:133], v[132:133], v[36:37]
    v_pk_mul_f32 v[134:135], v[134:135], v[38:39]
    v_pk_mul_f32 v[136:137], v[136:137], v[40:41]
    v_pk_mul_f32 v[138:139], v[138:139], v[42:43]
    v_pk_mul_f32 v[140:141], v[140:141], v[44:45]
    v_pk_mul_f32 v[142:143], v[142:143], v[46:47]
    v_pk_mul_f32 v[144:145], v[144:145], v[48:49]
    v_pk_mul_f32 v[146:147], v[146:147], v[50:51]
    v_pk_mul_f32 v[148:149], v[148:149], v[52:53]
    v_pk_mul_f32 v[150:151], v[150:151], v[54:55]
    v_pk_mul_f32 v[152:153], v[152:153], v[56:57]
    v_pk_mul_f32 v[154:155], v[154:155], v[58:59]
    v_pk_add_f32 v[156:157], v[128:129], v[132:133]
    v_pk_mul_f32 v[160:161], v[128:129], v[128:129]
    v_pk_add_f32 v[158:159], v[130:131], v[134:135]
    v_pk_mul_f32 v[162:163], v[130:131], v[130:131]
    v_pk_fma_f32 v[160:161], v[132:133], v[132:133], v[160:161]
    v_pk_fma_f32 v[162:163], v[134:135], v[134:135], v[162:163]
    v_pk_add_f32 v[156:157], v[156:157], v[136:137]
    v_pk_fma_f32 v[160:161], v[136:137], v[136:137], v[160:161]
    v_pk_add_f32 v[158:159], v[158:159], v[138:139]
    v_pk_fma_f32 v[162:163], v[138:139], v[138:139], v[162:163]
    v_pk_add_f32 v[156:157], v[156:157], v[140:141]
    v_pk_fma_f32 v[160:161], v[140:141], v[140:141], v[160:161]
    v_pk_add_f32 v[158:159], v[158:159], v[142:143]
    v_pk_fma_f32 v[162:163], v[142:143], v[142:143], v[162:163]
    v_pk_add_f32 v[156:157], v[156:157], v[144:145]
    v_pk_fma_f32 v[160:161], v[144:145], v[144:145], v[160:161]
    v_pk_add_f32 v[158:159], v[158:159], v[146:147]
    v_pk_fma_f32 v[162:163], v[146:147], v[146:147], v[162:163]
    v_pk_add_f32 v[156:157], v[156:157], v[148:149]
    v_pk_fma_f32 v[160:161], v[148:149], v[148:149], v[160:161]
    v_pk_add_f32 v[158:159], v[158:159], v[150:151]
    v_pk_fma_f32 v[162:163], v[150:151], v[150:151], v[162:163]
    v_pk_add_f32 v[156:157], v[156:157], v[152:153]
    v_pk_fma_f32 v[160:161], v[152:153], v[152:153], v[160:161]
    v_pk_add_f32 v[158:159], v[158:159], v[154:155]
    v_pk_fma_f32 v[162:163], v[154:155], v[154:155], v[162:163]
    v_add_f32_dpp v156, v156, v156 row_ror:8 row_mask:0xf bank_mask:0xf
    v_add_f32_dpp v157, v157, v157 row_ror:8 row_mask:0xf bank_mask:0xf
    v_add_f32_dpp v158, v158, v158 row_ror:8 row_mask:0xf bank_mask:0xf
    v_add_f32_dpp v159, v159, v159 row_ror:8 row_mask:0xf bank_mask:0xf
    v_add_f32_dpp v160, v160, v160 row_ror:8 row_mask:0xf bank_mask:0xf
    v_add_f32_dpp v161, v161, v161 row_ror:8 row_mask:0xf bank_mask:0xf
    v_add_f32_dpp v162, v162, v162 row_ror:8 row_mask:0xf bank_mask:0xf
    v_add_f32_dpp v163, v163, v163 row_ror:8 row_mask:0xf bank_mask:0xf
    v_add_f32_dpp v156, v156, v156 row_ror:4 row_mask:0xf bank_mask:0xf
    v_add_f32_dpp v157, v157, v157 row_ror:4 row_mask:0xf bank_mask:0xf
    v_add_f32_dpp v158, v158, v158 row_ror:4 row_mask:0xf bank_mask:0xf
    v_add_f32_dpp v159, v159, v159 row_ror:4 row_mask:0xf bank_mask:0xf
    v_add_f32_dpp v160, v160, v160 row_ror:4 row_mask:0xf bank_mask:0xf
    v_add_f32_dpp v161, v161, v161 row_ror:4 row_mask:0xf bank_mask:0xf
    v_add_f32_dpp v162, v162, v162 row_ror:4 row_mask:0xf bank_mask:0xf
    v_add_f32_dpp v163, v163, v163 row_ror:4 row_mask:0xf bank_mask:0xf
    v_add_f32_dpp v156, v156, v156 row_ror:2 row_mask:0xf bank_mask:0xf
    v_add_f32_dpp v157, v157, v157 row_ror:2 row_mask:0xf bank_mask:0xf
    v_add_f32_dpp v158, v158, v158 row_ror:2 row_mask:0xf bank_mask:0xf
    v_add_f32_dpp v159, v159, v159 row_ror:2 row_mask:0xf bank_mask:0xf
    v_add_f32_dpp v160, v160, v160 row_ror:2 row_mask:0xf bank_mask:0xf
    v_add_f32_dpp v161, v161, v161 row_ror:2 row_mask:0xf bank_mask:0xf
    v_add_f32_dpp v162, v162, v162 row_ror:2 row_mask:0xf bank_mask:0xf
    v_add_f32_dpp v163, v163, v163 row_ror:2 row_mask:0xf bank_mask:0xf
    v_add_f32_dpp v156, v156, v156 row_ror:1 row_mask:0xf bank_mask:0xf
    v_add_f32_dpp v157, v157, v157 row_ror:1 row_mask:0xf bank_mask:0xf
    v_add_f32_dpp v158, v158, v158 row_ror:1 row_mask:0xf bank_mask:0xf
    v_add_f32_dpp v159, v159, v159 row_ror:1 row_mask:0xf bank_mask:0xf
    v_add_f32_dpp v160, v160, v160 row_ror:1 row_mask:0xf bank_mask:0xf
    v_add_f32_dpp v161, v161, v161 row_ror:1 row_mask:0xf bank_mask:0xf
    v_add_f32_dpp v162, v162, v162 row_ror:1 row_mask:0xf bank_mask:0xf
    v_add_f32_dpp v163, v163, v163 row_ror:1 row_mask:0xf bank_mask:0xf
    s_and_b32 s71, s42, 0xff
    s_movk_i32 s3, 0xff
    v_mov_b32 v4, s71
    v_bfi_b32 v156, s3, v4, v156
    v_bfi_b32 v157, s3, v4, v157
    v_bfi_b32 v158, s3, v4, v158
    v_bfi_b32 v159, s3, v4, v159
    v_bfi_b32 v160, s3, v4, v160
    v_bfi_b32 v161, s3, v4, v161
    v_bfi_b32 v162, s3, v4, v162
    v_bfi_b32 v163, s3, v4, v163
    s_add_u32 s70, s69, 589824
    v_lshlrev_b32 v6, 5, v2
    s_mov_b32 exec_lo, 0x00010001
    s_mov_b32 exec_hi, 0x00010001
    s_cmp_eq_u32 s50, 0
    s_cbranch_scc1 Lslow_35
    buffer_store_dwordx4 v[156:159], v6, s[8:11], s70 offen
    buffer_store_dwordx4 v[160:163], v6, s[8:11], s70 offen offset:16
    s_branch Lpub_36
Lslow_35:
    buffer_store_dwordx4 v[156:159], v6, s[8:11], s70 offen sc1
    buffer_store_dwordx4 v[160:163], v6, s[8:11], s70 offen offset:16 sc1
Lpub_36:
    s_mov_b64 exec, -1
    s_waitcnt vmcnt(24)
    s_barrier
    v_mov_b32 v17, 1
    v_mov_b32 v63, 2147418112
    v_cmp_eq_u32 vcc, 0, v0
    s_nop 1
    v_cndmask_b32 v63, v63, v0, vcc
    ds_read_b128 v[32:35], v3 offset:21504
    ds_read_b128 v[36:39], v3 offset:22528
    ds_read_b128 v[40:43], v3 offset:23552
    ds_read_b128 v[44:47], v3 offset:24576
    ds_read_b128 v[48:51], v3 offset:25600
    ds_read_b128 v[52:55], v3 offset:26624
    ds_read_b128 v[56:59], v3 offset:27648
    s_waitcnt lgkmcnt(6)
    v_mfma_f32_16x16x32_bf16 v[176:179], v[32:35], v[64:67], 0
    ds_read_b128 v[204:207], v3 offset:28672
    s_waitcnt lgkmcnt(6)
    v_mfma_f32_16x16x32_bf16 v[180:183], v[36:39], v[64:67], 0
    ds_read_b128 v[208:211], v3 offset:29696
    s_waitcnt lgkmcnt(6)
    v_mfma_f32_16x16x32_bf16 v[184:187], v[40:43], v[64:67], 0
    ds_read_b128 v[212:215], v3 offset:30720
    s_waitcnt lgkmcnt(6)
    v_mfma_f32_16x16x32_bf16 v[188:191], v[44:47], v[64:67], 0
    ds_read_b128 v[216:219], v3 offset:31744
    s_waitcnt lgkmcnt(6)
    v_mfma_f32_16x16x32_bf16 v[192:195], v[48:51], v[64:67], 0
    ds_read_b128 v[220:223], v3 offset:32768
    s_waitcnt lgkmcnt(6)
    v_mfma_f32_16x16x32_bf16 v[196:199], v[52:55], v[64:67], 0
    ds_read_b128 v[224:227], v3 offset:33792
    s_waitcnt lgkmcnt(6)
    v_mfma_f32_16x16x32_bf16 v[200:203], v[56:59], v[64:67], 0
    ds_read_b128 v[228:231], v3 offset:34816
    s_waitcnt lgkmcnt(6)
    v_mfma_f32_16x16x32_bf16 v[176:179], v[204:207], v[68:71], v[176:179]
    ds_read_b128 v[32:35], v3 offset:35840
    s_waitcnt lgkmcnt(6)
    v_mfma_f32_16x16x32_bf16 v[180:183], v[208:211], v[68:71], v[180:183]
    ds_read_b128 v[36:39], v3 offset:36864
    s_waitcnt lgkmcnt(6)
    v_mfma_f32_16x16x32_bf16 v[184:187], v[212:215], v[68:71], v[184:187]
    ds_read_b128 v[40:43], v3 offset:37888
    s_waitcnt lgkmcnt(6)
    v_mfma_f32_16x16x32_bf16 v[188:191], v[216:219], v[68:71], v[188:191]
    ds_read_b128 v[44:47], v3 offset:38912
    s_waitcnt lgkmcnt(6)
    v_mfma_f32_16x16x32_bf16 v[192:195], v[220:223], v[68:71], v[192:195]
    ds_read_b128 v[48:51], v3 offset:39936
    s_waitcnt lgkmcnt(6)
    v_mfma_f32_16x16x32_bf16 v[196:199], v[224:227], v[68:71], v[196:199]
    ds_read_b128 v[52:55], v3 offset:40960
    s_waitcnt lgkmcnt(6)
    v_mfma_f32_16x16x32_bf16 v[200:203], v[228:231], v[68:71], v[200:203]
    ds_read_b128 v[56:59], v3 offset:41984
    s_add_u32 s70, s68, 589824
    s_mov_b64 exec, -1
    s_mov_b32 s3, 0
Lpoll_37:
    s_add_u32 s3, s3, 1
    s_cmp_gt_u32 s3, 131072
    s_cbranch_scc1 Lpollx_38
    buffer_load_dwordx4 v[164:167], v30, s[8:11], s70 offen sc1
    buffer_load_dwordx4 v[168:171], v30, s[8:11], s70 offen offset:16 sc1
    s_waitcnt vmcnt(0)
    v_xor_b32 v164, s71, v164
    v_xor_b32 v165, s71, v165
    v_xor_b32 v166, s71, v166
    v_xor_b32 v167, s71, v167
    v_xor_b32 v168, s71, v168
    v_xor_b32 v169, s71, v169
    v_xor_b32 v170, s71, v170
    v_xor_b32 v171, s71, v171
    v_or3_b32 v4, v164, v165, v166
    v_or3_b32 v5, v167, v168, v169
    v_or3_b32 v4, v4, v170, v171
    v_or_b32 v4, v4, v5
    v_and_b32 v4, 0xff, v4
    v_cmp_ne_u32 vcc, 0, v4
    s_cbranch_vccnz Lpoll_37
Lpollx_38:
    s_mov_b64 exec, -1
    s_mov_b32 s12, s32
    s_mov_b32 s13, s33
    s_mov_b32 s14, 4096
    s_mov_b32 s15, 0x20000
    s_lshr_b32 s3, s55, 9
    v_lshlrev_b32 v4, 1, v1
    buffer_load_ushort v16, v4, s[12:15], s3 offen
    s_lshl_b32 s70, s47, 6
    s_lshl_b32 s3, s46, 1
    s_add_u32 s70, s70, s3
    s_lshr_b32 s3, s48, 1
    s_add_u32 s70, s70, s3
    s_mul_i32 s70, s70, 7168
    s_and_b32 s3, s48, 1
    s_lshl_b32 s3, s3, 9
    s_add_u32 s70, s70, s3
    s_add_u32 s70, s70, 5242880
    s_add_u32 s71, s70, 4096
    v_and_b32 v4, 1, v2
    v_lshlrev_b32 v4, 10, v4
    v_lshrrev_b32 v5, 1, v2
    v_lshl_add_u32 v4, v5, 8, v4
    v_lshl_add_u32 v6, v1, 4, v4
    v_add_f32_dpp v164, v164, v164 row_ror:4 row_mask:0xf bank_mask:0xf
    v_add_f32_dpp v165, v165, v165 row_ror:4 row_mask:0xf bank_mask:0xf
    v_add_f32_dpp v166, v166, v166 row_ror:4 row_mask:0xf bank_mask:0xf
    v_add_f32_dpp v167, v167, v167 row_ror:4 row_mask:0xf bank_mask:0xf
    v_add_f32_dpp v168, v168, v168 row_ror:4 row_mask:0xf bank_mask:0xf
    v_add_f32_dpp v169, v169, v169 row_ror:4 row_mask:0xf bank_mask:0xf
    v_add_f32_dpp v170, v170, v170 row_ror:4 row_mask:0xf bank_mask:0xf
    v_add_f32_dpp v171, v171, v171 row_ror:4 row_mask:0xf bank_mask:0xf
    v_add_f32_dpp v164, v164, v164 row_ror:2 row_mask:0xf bank_mask:0xf
    v_add_f32_dpp v165, v165, v165 row_ror:2 row_mask:0xf bank_mask:0xf
    v_add_f32_dpp v166, v166, v166 row_ror:2 row_mask:0xf bank_mask:0xf
    v_add_f32_dpp v167, v167, v167 row_ror:2 row_mask:0xf bank_mask:0xf
    v_add_f32_dpp v168, v168, v168 row_ror:2 row_mask:0xf bank_mask:0xf
    v_add_f32_dpp v169, v169, v169 row_ror:2 row_mask:0xf bank_mask:0xf
    v_add_f32_dpp v170, v170, v170 row_ror:2 row_mask:0xf bank_mask:0xf
    v_add_f32_dpp v171, v171, v171 row_ror:2 row_mask:0xf bank_mask:0xf
    v_add_f32_dpp v164, v164, v164 row_ror:1 row_mask:0xf bank_mask:0xf
    v_add_f32_dpp v165, v165, v165 row_ror:1 row_mask:0xf bank_mask:0xf
    v_add_f32_dpp v166, v166, v166 row_ror:1 row_mask:0xf bank_mask:0xf
    v_add_f32_dpp v167, v167, v167 row_ror:1 row_mask:0xf bank_mask:0xf
    v_add_f32_dpp v168, v168, v168 row_ror:1 row_mask:0xf bank_mask:0xf
    v_add_f32_dpp v169, v169, v169 row_ror:1 row_mask:0xf bank_mask:0xf
    v_add_f32_dpp v170, v170, v170 row_ror:1 row_mask:0xf bank_mask:0xf
    v_add_f32_dpp v171, v171, v171 row_ror:1 row_mask:0xf bank_mask:0xf
    v_mul_f32 v156, 0xba924925, v164
    v_mul_f32 v168, 0x3a924925, v168
    v_mul_f32 v157, 0xba924925, v165
    v_mul_f32 v169, 0x3a924925, v169
    v_mul_f32 v158, 0xba924925, v166
    v_mul_f32 v170, 0x3a924925, v170
    v_mul_f32 v159, 0xba924925, v167
    v_mul_f32 v171, 0x3a924925, v171
    v_fma_f32 v168, -v156, v156, v168
    v_fma_f32 v169, -v157, v157, v169
    v_fma_f32 v170, -v158, v158, v170
    v_fma_f32 v171, -v159, v159, v171
    v_max_f32 v168, 0, v168
    v_max_f32 v169, 0, v169
    v_max_f32 v170, 0, v170
    v_max_f32 v171, 0, v171
    v_add_f32 v168, 0x3727c5ac, v168
    v_add_f32 v169, 0x3727c5ac, v169
    v_add_f32 v170, 0x3727c5ac, v170
    v_add_f32 v171, 0x3727c5ac, v171
    v_rsq_f32 v160, v168
    v_rsq_f32 v161, v169
    v_rsq_f32 v162, v170
    v_rsq_f32 v163, v171
    v_pk_mul_f32 v[156:157], v[156:157], v[160:161]
    v_pk_mul_f32 v[158:159], v[158:159], v[162:163]
    v_pk_fma_f32 v[128:129], v[128:129], v[160:161], v[156:157]
    v_pk_fma_f32 v[130:131], v[130:131], v[162:163], v[158:159]
    v_pk_fma_f32 v[132:133], v[132:133], v[160:161], v[156:157]
    v_pk_fma_f32 v[134:135], v[134:135], v[162:163], v[158:159]
    v_pk_fma_f32 v[136:137], v[136:137], v[160:161], v[156:157]
    v_pk_fma_f32 v[138:139], v[138:139], v[162:163], v[158:159]
    v_pk_fma_f32 v[140:141], v[140:141], v[160:161], v[156:157]
    v_pk_fma_f32 v[142:143], v[142:143], v[162:163], v[158:159]
    v_pk_fma_f32 v[144:145], v[144:145], v[160:161], v[156:157]
    v_pk_fma_f32 v[146:147], v[146:147], v[162:163], v[158:159]
    v_pk_fma_f32 v[148:149], v[148:149], v[160:161], v[156:157]
    v_pk_fma_f32 v[150:151], v[150:151], v[162:163], v[158:159]
    v_pk_fma_f32 v[152:153], v[152:153], v[160:161], v[156:157]
    v_pk_fma_f32 v[154:155], v[154:155], v[162:163], v[158:159]
    v_cvt_pk_bf16_f32 v232, v128, v129
    v_cvt_pk_bf16_f32 v233, v130, v131
    v_cvt_pk_bf16_f32 v234, v132, v133
    v_cvt_pk_bf16_f32 v235, v134, v135
    v_cvt_pk_bf16_f32 v236, v136, v137
    v_cvt_pk_bf16_f32 v237, v138, v139
    v_cvt_pk_bf16_f32 v238, v140, v141
    v_cvt_pk_bf16_f32 v239, v142, v143
    v_cvt_pk_bf16_f32 v240, v144, v145
    v_cvt_pk_bf16_f32 v241, v146, v147
    v_cvt_pk_bf16_f32 v242, v148, v149
    v_cvt_pk_bf16_f32 v243, v150, v151
    v_cvt_pk_bf16_f32 v244, v152, v153
    v_cvt_pk_bf16_f32 v245, v154, v155
    v_mov_b32 v246, v244
    v_mov_b32 v247, v245
    v_permlane16_swap_b32 v232, v234
    v_permlane16_swap_b32 v233, v235
    v_permlane16_swap_b32 v236, v238
    v_permlane16_swap_b32 v237, v239
    v_permlane16_swap_b32 v240, v242
    v_permlane16_swap_b32 v241, v243
    v_permlane16_swap_b32 v244, v246
    v_permlane16_swap_b32 v245, v247
    buffer_store_dwordx4 v[232:235], v6, s[8:11], s70 offen sc1
    buffer_store_dwordx4 v[236:239], v6, s[8:11], s70 offen offset:2048 sc1
    buffer_store_dwordx4 v[240:243], v6, s[8:11], s71 offen sc1
    s_mov_b32 exec_lo, 0x0000ffff
    s_mov_b32 exec_hi, 0x0000ffff
    buffer_store_dwordx4 v[244:247], v6, s[8:11], s71 offen offset:2048 sc1
    s_mov_b64 exec, -1
    s_lshl_b32 s70, s46, 3
    s_add_u32 s70, s70, s47
    s_lshl_b32 s70, s70, 9
    s_lshl_b32 s3, s48, 7
    s_add_u32 s70, s70, s3
    s_add_u32 s70, s70, 61440
    s_waitcnt lgkmcnt(6)
    v_mfma_f32_16x16x32_bf16 v[176:179], v[32:35], v[72:75], v[176:179]
    ds_read_b128 v[204:207], v3 offset:43008
    s_waitcnt lgkmcnt(6)
    v_mfma_f32_16x16x32_bf16 v[180:183], v[36:39], v[72:75], v[180:183]
    ds_read_b128 v[208:211], v3 offset:44032
    s_waitcnt lgkmcnt(6)
    v_mfma_f32_16x16x32_bf16 v[184:187], v[40:43], v[72:75], v[184:187]
    ds_read_b128 v[212:215], v3 offset:45056
    s_waitcnt lgkmcnt(6)
    v_mfma_f32_16x16x32_bf16 v[188:191], v[44:47], v[72:75], v[188:191]
    ds_read_b128 v[216:219], v3 offset:46080
    s_waitcnt lgkmcnt(6)
    v_mfma_f32_16x16x32_bf16 v[192:195], v[48:51], v[72:75], v[192:195]
    ds_read_b128 v[220:223], v3 offset:47104
    s_waitcnt lgkmcnt(6)
    v_mfma_f32_16x16x32_bf16 v[196:199], v[52:55], v[72:75], v[196:199]
    ds_read_b128 v[224:227], v3 offset:48128
    s_waitcnt lgkmcnt(6)
    v_mfma_f32_16x16x32_bf16 v[200:203], v[56:59], v[72:75], v[200:203]
    ds_read_b128 v[228:231], v3 offset:49152
    s_barrier
    s_waitcnt lgkmcnt(6)
    v_mfma_f32_16x16x32_bf16 v[176:179], v[204:207], v[76:79], v[176:179]
    ds_read_b128 v[32:35], v25 offset:8192
    s_waitcnt lgkmcnt(6)
    v_mfma_f32_16x16x32_bf16 v[180:183], v[208:211], v[76:79], v[180:183]
    ds_read_b128 v[36:39], v25 offset:9216
    s_waitcnt lgkmcnt(6)
    v_mfma_f32_16x16x32_bf16 v[184:187], v[212:215], v[76:79], v[184:187]
    ds_read_b128 v[40:43], v25 offset:10240
    s_waitcnt lgkmcnt(6)
    v_mfma_f32_16x16x32_bf16 v[188:191], v[216:219], v[76:79], v[188:191]
    ds_read_b128 v[44:47], v25 offset:11264
    s_waitcnt lgkmcnt(6)
    v_mfma_f32_16x16x32_bf16 v[192:195], v[220:223], v[76:79], v[192:195]
    ds_read_b128 v[48:51], v25 offset:12288
    s_waitcnt lgkmcnt(6)
    v_mfma_f32_16x16x32_bf16 v[196:199], v[224:227], v[76:79], v[196:199]
    ds_read_b128 v[52:55], v25 offset:13312
    s_waitcnt lgkmcnt(6)
    v_mfma_f32_16x16x32_bf16 v[200:203], v[228:231], v[76:79], v[200:203]
    ds_read_b128 v[56:59], v25 offset:14336
    s_waitcnt lgkmcnt(0)
    s_barrier
    s_mul_i32 s3, s47, 114688
    s_lshl_b32 s76, s48, 10
    s_add_u32 s77, s3, s76
    s_add_u32 s77, s77, 14680064
    s_mul_i32 s75, s47, 12288
    s_waitcnt lgkmcnt(6)
    v_mfma_f32_16x16x32_bf16 v[176:179], v[32:35], v[80:83], v[176:179]
    ds_read_b128 v[204:207], v25 offset:15360
    s_waitcnt lgkmcnt(6)
    v_mfma_f32_16x16x32_bf16 v[180:183], v[36:39], v[80:83], v[180:183]
    ds_read_b128 v[208:211], v25 offset:16384
    s_waitcnt lgkmcnt(6)
    v_mfma_f32_16x16x32_bf16 v[184:187], v[40:43], v[80:83], v[184:187]
    ds_read_b128 v[212:215], v25 offset:17408
    s_waitcnt lgkmcnt(6)
    v_mfma_f32_16x16x32_bf16 v[188:191], v[44:47], v[80:83], v[188:191]
    ds_read_b128 v[216:219], v25 offset:18432
    s_waitcnt lgkmcnt(6)
    v_mfma_f32_16x16x32_bf16 v[192:195], v[48:51], v[80:83], v[192:195]
    ds_read_b128 v[220:223], v25 offset:19456
    s_waitcnt lgkmcnt(6)
    v_mfma_f32_16x16x32_bf16 v[196:199], v[52:55], v[80:83], v[196:199]
    ds_read_b128 v[224:227], v25 offset:20480
    s_waitcnt lgkmcnt(6)
    v_mfma_f32_16x16x32_bf16 v[200:203], v[56:59], v[80:83], v[200:203]
    ds_read_b128 v[228:231], v25 offset:21504
    s_waitcnt vmcnt(0)
    buffer_store_dword v17, v63, s[8:11], s70 offen sc1
    s_waitcnt lgkmcnt(6)
    v_mfma_f32_16x16x32_bf16 v[176:179], v[204:207], v[84:87], v[176:179]
    ds_read_b128 v[32:35], v25 offset:22528
    s_waitcnt lgkmcnt(6)
    v_mfma_f32_16x16x32_bf16 v[180:183], v[208:211], v[84:87], v[180:183]
    ds_read_b128 v[36:39], v25 offset:23552
    s_mov_b32 m0, s76
    s_add_u32 s74, s75, s77
    buffer_load_dwordx4 v3, s[8:11], s74 offen sc1 lds
    s_add_u32 s76, s76, 4096
    s_add_u32 s75, s75, 4096
    s_cmp_eq_u32 s75, 98304
    s_cselect_b32 s75, 0, s75
    s_waitcnt lgkmcnt(6)
    v_mfma_f32_16x16x32_bf16 v[184:187], v[212:215], v[84:87], v[184:187]
    ds_read_b128 v[40:43], v25 offset:24576
    s_waitcnt lgkmcnt(6)
    v_mfma_f32_16x16x32_bf16 v[188:191], v[216:219], v[84:87], v[188:191]
    ds_read_b128 v[44:47], v25 offset:25600
    s_waitcnt lgkmcnt(6)
    v_mfma_f32_16x16x32_bf16 v[192:195], v[220:223], v[84:87], v[192:195]
    ds_read_b128 v[48:51], v25 offset:26624
    s_mov_b32 m0, s76
    s_add_u32 s74, s75, s77
    buffer_load_dwordx4 v3, s[8:11], s74 offen sc1 lds
    s_add_u32 s76, s76, 4096
    s_add_u32 s75, s75, 4096
    s_cmp_eq_u32 s75, 98304
    s_cselect_b32 s75, 0, s75
    s_waitcnt lgkmcnt(6)
    v_mfma_f32_16x16x32_bf16 v[196:199], v[224:227], v[84:87], v[196:199]
    ds_read_b128 v[52:55], v25 offset:27648
    s_waitcnt lgkmcnt(6)
    v_mfma_f32_16x16x32_bf16 v[200:203], v[228:231], v[84:87], v[200:203]
    ds_read_b128 v[56:59], v25 offset:28672
    s_waitcnt lgkmcnt(6)
    v_mfma_f32_16x16x32_bf16 v[176:179], v[32:35], v[88:91], v[176:179]
    ds_read_b128 v[204:207], v25 offset:29696
    s_waitcnt lgkmcnt(6)
    v_mfma_f32_16x16x32_bf16 v[180:183], v[36:39], v[88:91], v[180:183]
    ds_read_b128 v[208:211], v25 offset:30720
    s_mov_b32 m0, s76
    s_add_u32 s74, s75, s77
    buffer_load_dwordx4 v3, s[8:11], s74 offen sc1 lds
    s_add_u32 s76, s76, 4096
    s_add_u32 s75, s75, 4096
    s_cmp_eq_u32 s75, 98304
    s_cselect_b32 s75, 0, s75
    s_waitcnt lgkmcnt(6)
    v_mfma_f32_16x16x32_bf16 v[184:187], v[40:43], v[88:91], v[184:187]
    ds_read_b128 v[212:215], v25 offset:31744
    s_waitcnt lgkmcnt(6)
    v_mfma_f32_16x16x32_bf16 v[188:191], v[44:47], v[88:91], v[188:191]
    ds_read_b128 v[216:219], v25 offset:32768
    s_waitcnt lgkmcnt(6)
    v_mfma_f32_16x16x32_bf16 v[192:195], v[48:51], v[88:91], v[192:195]
    ds_read_b128 v[220:223], v25 offset:33792
    s_mov_b32 m0, s76
    s_add_u32 s74, s75, s77
    buffer_load_dwordx4 v3, s[8:11], s74 offen sc1 lds
    s_add_u32 s76, s76, 4096
    s_add_u32 s75, s75, 4096
    s_cmp_eq_u32 s75, 98304
    s_cselect_b32 s75, 0, s75
    s_waitcnt lgkmcnt(6)
    v_mfma_f32_16x16x32_bf16 v[196:199], v[52:55], v[88:91], v[196:199]
    ds_read_b128 v[224:227], v25 offset:34816
    s_waitcnt lgkmcnt(6)
    v_mfma_f32_16x16x32_bf16 v[200:203], v[56:59], v[88:91], v[200:203]
    ds_read_b128 v[228:231], v25 offset:35840
    s_waitcnt lgkmcnt(6)
    v_mfma_f32_16x16x32_bf16 v[176:179], v[204:207], v[92:95], v[176:179]
    ds_read_b128 v[32:35], v25 offset:36864
    s_waitcnt lgkmcnt(6)
    v_mfma_f32_16x16x32_bf16 v[180:183], v[208:211], v[92:95], v[180:183]
    ds_read_b128 v[36:39], v25 offset:37888
    s_mov_b32 m0, s76
    s_add_u32 s74, s75, s77
    buffer_load_dwordx4 v3, s[8:11], s74 offen sc1 lds
    s_add_u32 s76, s76, 4096
    s_add_u32 s75, s75, 4096
    s_cmp_eq_u32 s75, 98304
    s_cselect_b32 s75, 0, s75
    s_waitcnt lgkmcnt(6)
    v_mfma_f32_16x16x32_bf16 v[184:187], v[212:215], v[92:95], v[184:187]
    ds_read_b128 v[40:43], v25 offset:38912
    s_waitcnt lgkmcnt(6)
    v_mfma_f32_16x16x32_bf16 v[188:191], v[216:219], v[92:95], v[188:191]
    ds_read_b128 v[44:47], v25 offset:39936
    s_waitcnt lgkmcnt(6)
    v_mfma_f32_16x16x32_bf16 v[192:195], v[220:223], v[92:95], v[192:195]
    ds_read_b128 v[48:51], v25 offset:40960
    s_mov_b32 m0, s76
    s_add_u32 s74, s75, s77
    buffer_load_dwordx4 v3, s[8:11], s74 offen sc1 lds
    s_add_u32 s76, s76, 4096
    s_add_u32 s75, s75, 4096
    s_cmp_eq_u32 s75, 98304
    s_cselect_b32 s75, 0, s75
    s_waitcnt lgkmcnt(6)
    v_mfma_f32_16x16x32_bf16 v[196:199], v[224:227], v[92:95], v[196:199]
    ds_read_b128 v[52:55], v25 offset:41984
    s_waitcnt lgkmcnt(6)
    v_mfma_f32_16x16x32_bf16 v[200:203], v[228:231], v[92:95], v[200:203]
    ds_read_b128 v[56:59], v25 offset:43008
    s_waitcnt lgkmcnt(6)
    v_mfma_f32_16x16x32_bf16 v[176:179], v[32:35], v[96:99], v[176:179]
    ds_read_b128 v[204:207], v25 offset:44032
    s_waitcnt lgkmcnt(6)
    v_mfma_f32_16x16x32_bf16 v[180:183], v[36:39], v[96:99], v[180:183]
    ds_read_b128 v[208:211], v25 offset:45056
    s_mov_b32 m0, s76
    s_add_u32 s74, s75, s77
    buffer_load_dwordx4 v3, s[8:11], s74 offen sc1 lds
    s_add_u32 s76, s76, 4096
    s_add_u32 s75, s75, 4096
    s_cmp_eq_u32 s75, 98304
    s_cselect_b32 s75, 0, s75
    s_waitcnt lgkmcnt(6)
    v_mfma_f32_16x16x32_bf16 v[184:187], v[40:43], v[96:99], v[184:187]
    ds_read_b128 v[212:215], v25 offset:46080
    s_waitcnt lgkmcnt(6)
    v_mfma_f32_16x16x32_bf16 v[188:191], v[44:47], v[96:99], v[188:191]
    ds_read_b128 v[216:219], v25 offset:47104
    s_waitcnt lgkmcnt(6)
    v_mfma_f32_16x16x32_bf16 v[192:195], v[48:51], v[96:99], v[192:195]
    ds_read_b128 v[220:223], v25 offset:48128
    s_mov_b32 m0, s76
    s_add_u32 s74, s75, s77
    buffer_load_dwordx4 v3, s[8:11], s74 offen sc1 lds
    s_add_u32 s76, s76, 4096
    s_add_u32 s75, s75, 4096
    s_cmp_eq_u32 s75, 98304
    s_cselect_b32 s75, 0, s75
    s_waitcnt lgkmcnt(6)
    v_mfma_f32_16x16x32_bf16 v[196:199], v[52:55], v[96:99], v[196:199]
    ds_read_b128 v[224:227], v25 offset:49152
    s_waitcnt lgkmcnt(6)
    v_mfma_f32_16x16x32_bf16 v[200:203], v[56:59], v[96:99], v[200:203]
    ds_read_b128 v[228:231], v25 offset:50176
    s_waitcnt lgkmcnt(6)
    v_mfma_f32_16x16x32_bf16 v[176:179], v[204:207], v[100:103], v[176:179]
    ds_read_b128 v[32:35], v25 offset:51200
    s_waitcnt lgkmcnt(6)
    v_mfma_f32_16x16x32_bf16 v[180:183], v[208:211], v[100:103], v[180:183]
    ds_read_b128 v[36:39], v25 offset:52224
    s_mov_b32 m0, s76
    s_add_u32 s74, s75, s77
    buffer_load_dwordx4 v3, s[8:11], s74 offen sc1 lds
    s_add_u32 s76, s76, 4096
    s_add_u32 s75, s75, 4096
    s_cmp_eq_u32 s75, 98304
    s_cselect_b32 s75, 0, s75
    s_waitcnt lgkmcnt(6)
    v_mfma_f32_16x16x32_bf16 v[184:187], v[212:215], v[100:103], v[184:187]
    ds_read_b128 v[40:43], v25 offset:53248
    s_waitcnt lgkmcnt(6)
    v_mfma_f32_16x16x32_bf16 v[188:191], v[216:219], v[100:103], v[188:191]
    ds_read_b128 v[44:47], v25 offset:54272
    s_waitcnt lgkmcnt(6)
    v_mfma_f32_16x16x32_bf16 v[192:195], v[220:223], v[100:103], v[192:195]
    ds_read_b128 v[48:51], v25 offset:55296
    s_mov_b32 m0, s76
    s_add_u32 s74, s75, s77
    buffer_load_dwordx4 v3, s[8:11], s74 offen sc1 lds
    s_add_u32 s76, s76, 4096
    s_add_u32 s75, s75, 4096
    s_cmp_eq_u32 s75, 98304
    s_cselect_b32 s75, 0, s75
    s_waitcnt lgkmcnt(6)
    v_mfma_f32_16x16x32_bf16 v[196:199], v[224:227], v[100:103], v[196:199]
    ds_read_b128 v[52:55], v25 offset:56320
    s_waitcnt lgkmcnt(6)
    v_mfma_f32_16x16x32_bf16 v[200:203], v[228:231], v[100:103], v[200:203]
    ds_read_b128 v[56:59], v26 offset:0
    s_waitcnt lgkmcnt(6)
    v_mfma_f32_16x16x32_bf16 v[176:179], v[32:35], v[104:107], v[176:179]
    ds_read_b128 v[204:207], v26 offset:1024
    s_waitcnt lgkmcnt(6)
    v_mfma_f32_16x16x32_bf16 v[180:183], v[36:39], v[104:107], v[180:183]
    ds_read_b128 v[208:211], v26 offset:2048
    s_mov_b32 m0, s76
    s_add_u32 s74, s75, s77
    buffer_load_dwordx4 v3, s[8:11], s74 offen sc1 lds
    s_add_u32 s76, s76, 4096
    s_add_u32 s75, s75, 4096
    s_cmp_eq_u32 s75, 98304
    s_cselect_b32 s75, 0, s75
    s_waitcnt lgkmcnt(6)
    v_mfma_f32_16x16x32_bf16 v[184:187], v[40:43], v[104:107], v[184:187]
    ds_read_b128 v[212:215], v26 offset:3072
    s_waitcnt lgkmcnt(6)
    v_mfma_f32_16x16x32_bf16 v[188:191], v[44:47], v[104:107], v[188:191]
    ds_read_b128 v[216:219], v26 offset:4096
    s_waitcnt lgkmcnt(6)
    v_mfma_f32_16x16x32_bf16 v[192:195], v[48:51], v[104:107], v[192:195]
    ds_read_b128 v[220:223], v26 offset:5120
    s_mov_b32 m0, s76
    s_add_u32 s74, s75, s77
    buffer_load_dwordx4 v3, s[8:11], s74 offen sc1 lds
    s_add_u32 s76, s76, 4096
    s_add_u32 s75, s75, 4096
    s_cmp_eq_u32 s75, 98304
    s_cselect_b32 s75, 0, s75
    s_waitcnt lgkmcnt(6)
    v_mfma_f32_16x16x32_bf16 v[196:199], v[52:55], v[104:107], v[196:199]
    ds_read_b128 v[224:227], v26 offset:6144
    s_waitcnt lgkmcnt(6)
    v_mfma_f32_16x16x32_bf16 v[200:203], v[56:59], v[104:107], v[200:203]
    ds_read_b128 v[228:231], v26 offset:7168
    s_waitcnt lgkmcnt(6)
    v_mfma_f32_16x16x32_bf16 v[176:179], v[204:207], v[108:111], v[176:179]
    ds_read_b128 v[32:35], v26 offset:8192
    s_waitcnt lgkmcnt(6)
    v_mfma_f32_16x16x32_bf16 v[180:183], v[208:211], v[108:111], v[180:183]
    ds_read_b128 v[36:39], v26 offset:9216
    s_mov_b32 m0, s76
    s_add_u32 s74, s75, s77
    buffer_load_dwordx4 v3, s[8:11], s74 offen sc1 lds
    s_add_u32 s76, s76, 4096
    s_add_u32 s75, s75, 4096
    s_cmp_eq_u32 s75, 98304
    s_cselect_b32 s75, 0, s75
    s_waitcnt lgkmcnt(6)
    v_mfma_f32_16x16x32_bf16 v[184:187], v[212:215], v[108:111], v[184:187]
    ds_read_b128 v[40:43], v26 offset:10240
    s_waitcnt lgkmcnt(6)
    v_mfma_f32_16x16x32_bf16 v[188:191], v[216:219], v[108:111], v[188:191]
    ds_read_b128 v[44:47], v26 offset:11264
    s_waitcnt lgkmcnt(6)
    v_mfma_f32_16x16x32_bf16 v[192:195], v[220:223], v[108:111], v[192:195]
    ds_read_b128 v[48:51], v26 offset:12288
    s_mov_b32 m0, s76
    s_add_u32 s74, s75, s77
    buffer_load_dwordx4 v3, s[8:11], s74 offen sc1 lds
    s_add_u32 s76, s76, 4096
    s_add_u32 s75, s75, 4096
    s_cmp_eq_u32 s75, 98304
    s_cselect_b32 s75, 0, s75
    s_waitcnt lgkmcnt(6)
    v_mfma_f32_16x16x32_bf16 v[196:199], v[224:227], v[108:111], v[196:199]
    ds_read_b128 v[52:55], v26 offset:13312
    s_waitcnt lgkmcnt(6)
    v_mfma_f32_16x16x32_bf16 v[200:203], v[228:231], v[108:111], v[200:203]
    ds_read_b128 v[56:59], v26 offset:14336
    s_waitcnt lgkmcnt(6)
    v_mfma_f32_16x16x32_bf16 v[176:179], v[32:35], v[112:115], v[176:179]
    ds_read_b128 v[204:207], v26 offset:15360
    s_waitcnt lgkmcnt(6)
    v_mfma_f32_16x16x32_bf16 v[180:183], v[36:39], v[112:115], v[180:183]
    ds_read_b128 v[208:211], v26 offset:16384
    s_mov_b32 m0, s76
    s_add_u32 s74, s75, s77
    buffer_load_dwordx4 v3, s[8:11], s74 offen sc1 lds
    s_add_u32 s76, s76, 4096
    s_add_u32 s75, s75, 4096
    s_cmp_eq_u32 s75, 98304
    s_cselect_b32 s75, 0, s75
    s_waitcnt lgkmcnt(6)
    v_mfma_f32_16x16x32_bf16 v[184:187], v[40:43], v[112:115], v[184:187]
    ds_read_b128 v[212:215], v26 offset:17408
    s_waitcnt lgkmcnt(6)
    v_mfma_f32_16x16x32_bf16 v[188:191], v[44:47], v[112:115], v[188:191]
    ds_read_b128 v[216:219], v26 offset:18432
    s_waitcnt lgkmcnt(6)
    v_mfma_f32_16x16x32_bf16 v[192:195], v[48:51], v[112:115], v[192:195]
    ds_read_b128 v[220:223], v26 offset:19456
    s_mov_b32 m0, s76
    s_add_u32 s74, s75, s77
    buffer_load_dwordx4 v3, s[8:11], s74 offen sc1 lds
    s_add_u32 s76, s76, 4096
    s_add_u32 s75, s75, 4096
    s_cmp_eq_u32 s75, 98304
    s_cselect_b32 s75, 0, s75
    s_waitcnt lgkmcnt(6)
    v_mfma_f32_16x16x32_bf16 v[196:199], v[52:55], v[112:115], v[196:199]
    ds_read_b128 v[224:227], v26 offset:20480
    s_waitcnt lgkmcnt(6)
    v_mfma_f32_16x16x32_bf16 v[200:203], v[56:59], v[112:115], v[200:203]
    ds_read_b128 v[228:231], v26 offset:21504
    s_waitcnt lgkmcnt(6)
    v_mfma_f32_16x16x32_bf16 v[176:179], v[204:207], v[116:119], v[176:179]
    ds_read_b128 v[32:35], v26 offset:22528
    s_waitcnt lgkmcnt(6)
    v_mfma_f32_16x16x32_bf16 v[180:183], v[208:211], v[116:119], v[180:183]
    ds_read_b128 v[36:39], v26 offset:23552
    s_waitcnt lgkmcnt(6)
    v_mfma_f32_16x16x32_bf16 v[184:187], v[212:215], v[116:119], v[184:187]
    ds_read_b128 v[40:43], v26 offset:24576
    s_waitcnt lgkmcnt(6)
    v_mfma_f32_16x16x32_bf16 v[188:191], v[216:219], v[116:119], v[188:191]
    ds_read_b128 v[44:47], v26 offset:25600
    s_waitcnt lgkmcnt(6)
    v_mfma_f32_16x16x32_bf16 v[192:195], v[220:223], v[116:119], v[192:195]
    ds_read_b128 v[48:51], v26 offset:26624
    s_waitcnt lgkmcnt(6)
    v_mfma_f32_16x16x32_bf16 v[196:199], v[224:227], v[116:119], v[196:199]
    ds_read_b128 v[52:55], v26 offset:27648
    s_waitcnt lgkmcnt(6)
    v_mfma_f32_16x16x32_bf16 v[200:203], v[228:231], v[116:119], v[200:203]
    ds_read_b128 v[56:59], v26 offset:28672
    s_lshl_b32 s70, s48, 15
    s_lshl_b32 s3, s47, 9
    s_add_u32 s70, s70, s3
    s_add_u32 s70, s70, 61440
    v_lshrrev_b32 v21, 2, v0
    v_lshlrev_b32 v21, 12, v21
    v_and_b32 v5, 3, v0
    v_lshl_add_u32 v21, v5, 7, v21
    s_mov_b32 exec_hi, 0
    buffer_load_dword v22, v21, s[8:11], s70 offen sc1
    s_mov_b64 exec, -1
    s_waitcnt lgkmcnt(6)
    v_mfma_f32_16x16x32_bf16 v[176:179], v[32:35], v[120:123], v[176:179]
    ds_read_b128 v[204:207], v26 offset:29696
    s_waitcnt lgkmcnt(6)
    v_mfma_f32_16x16x32_bf16 v[180:183], v[36:39], v[120:123], v[180:183]
    ds_read_b128 v[208:211], v26 offset:30720
    s_waitcnt lgkmcnt(6)
    v_mfma_f32_16x16x32_bf16 v[184:187], v[40:43], v[120:123], v[184:187]
    ds_read_b128 v[212:215], v26 offset:31744
    s_waitcnt lgkmcnt(6)
    v_mfma_f32_16x16x32_bf16 v[188:191], v[44:47], v[120:123], v[188:191]
    ds_read_b128 v[216:219], v26 offset:32768
    s_waitcnt lgkmcnt(6)
    v_mfma_f32_16x16x32_bf16 v[192:195], v[48:51], v[120:123], v[192:195]
    ds_read_b128 v[220:223], v26 offset:33792
    s_waitcnt lgkmcnt(6)
    v_mfma_f32_16x16x32_bf16 v[196:199], v[52:55], v[120:123], v[196:199]
    ds_read_b128 v[224:227], v26 offset:34816
    s_waitcnt lgkmcnt(6)
    v_mfma_f32_16x16x32_bf16 v[200:203], v[56:59], v[120:123], v[200:203]
    ds_read_b128 v[228:231], v26 offset:35840
    s_waitcnt lgkmcnt(6)
    v_mfma_f32_16x16x32_bf16 v[176:179], v[204:207], v[124:127], v[176:179]
    s_waitcnt lgkmcnt(5)
    v_mfma_f32_16x16x32_bf16 v[180:183], v[208:211], v[124:127], v[180:183]
    s_waitcnt lgkmcnt(4)
    v_mfma_f32_16x16x32_bf16 v[184:187], v[212:215], v[124:127], v[184:187]
    s_waitcnt lgkmcnt(3)
    v_mfma_f32_16x16x32_bf16 v[188:191], v[216:219], v[124:127], v[188:191]
    s_waitcnt lgkmcnt(2)
    v_mfma_f32_16x16x32_bf16 v[192:195], v[220:223], v[124:127], v[192:195]
    s_waitcnt lgkmcnt(1)
    v_mfma_f32_16x16x32_bf16 v[196:199], v[224:227], v[124:127], v[196:199]
    s_waitcnt lgkmcnt(0)
    v_mfma_f32_16x16x32_bf16 v[200:203], v[228:231], v[124:127], v[200:203]
    ds_read_b128 v[204:207], v29 offset:0
    ds_read_b128 v[128:131], v29 offset:448
    ds_read_b128 v[208:211], v29 offset:64
    ds_read_b128 v[132:135], v29 offset:512
    ds_read_b128 v[212:215], v29 offset:128
    ds_read_b128 v[136:139], v29 offset:576
    ds_read_b128 v[216:219], v29 offset:192
    ds_read_b128 v[140:143], v29 offset:640
    ds_read_b128 v[220:223], v29 offset:256
    ds_read_b128 v[144:147], v29 offset:704
    ds_read_b128 v[224:227], v29 offset:320
    ds_read_b128 v[148:151], v29 offset:768
    ds_read_b128 v[228:231], v29 offset:384
    ds_read_b128 v[152:155], v29 offset:832
    s_barrier
    s_lshl_b32 s72, s47, 2
    s_add_u32 s72, s72, s48
    s_mul_i32 s72, s72, 114688
    s_add_u32 s72, s72, 5242880
    s_add_u32 s73, s72, 4096
    s_add_u32 s3, s48, 1
    s_and_b32 s3, s3, 3
    s_mul_i32 s3, s3, 12288
    s_add_u32 s3, s3, 114688
    v_add_u32 v17, s3, v3
    s_add_u32 s3, s48, 2
    s_and_b32 s3, s3, 3
    s_mul_i32 s3, s3, 12288
    s_add_u32 s3, s3, 118784
    v_add_u32 v18, s3, v3
    s_add_u32 s3, s48, 3
    s_and_b32 s3, s3, 3
    s_mul_i32 s3, s3, 12288
    s_add_u32 s3, s3, 122880
    v_add_u32 v19, s3, v3
    s_mul_i32 s3, s48, 12288
    s_add_u32 s3, s3, 114688
    v_add_u32 v20, s3, v3
    v_lshlrev_b32 v16, 16, v16
    s_mov_b32 m0, s76
    s_add_u32 s74, s75, s77
    buffer_load_dwordx4 v3, s[8:11], s74 offen sc1 lds
    s_add_u32 s76, s76, 4096
    s_add_u32 s75, s75, 4096
    s_cmp_eq_u32 s75, 98304
    s_cselect_b32 s75, 0, s75
    s_mov_b32 m0, s76
    s_add_u32 s74, s75, s77
    buffer_load_dwordx4 v3, s[8:11], s74 offen sc1 lds
    s_add_u32 s76, s76, 4096
    s_add_u32 s75, s75, 4096
    s_cmp_eq_u32 s75, 98304
    s_cselect_b32 s75, 0, s75
    s_mov_b32 m0, s76
    s_add_u32 s74, s75, s77
    buffer_load_dwordx4 v3, s[8:11], s74 offen sc1 lds
    s_add_u32 s76, s76, 4096
    s_add_u32 s75, s75, 4096
    s_cmp_eq_u32 s75, 98304
    s_cselect_b32 s75, 0, s75
    s_mov_b32 m0, s76
    s_add_u32 s74, s75, s77
    buffer_load_dwordx4 v3, s[8:11], s74 offen sc1 lds
    s_add_u32 s76, s76, 4096
    s_add_u32 s75, s75, 4096
    s_cmp_eq_u32 s75, 98304
    s_cselect_b32 s75, 0, s75
    s_mov_b32 m0, s76
    s_add_u32 s74, s75, s77
    buffer_load_dwordx4 v3, s[8:11], s74 offen sc1 lds
    s_add_u32 s76, s76, 4096
    s_add_u32 s75, s75, 4096
    s_cmp_eq_u32 s75, 98304
    s_cselect_b32 s75, 0, s75
    s_mov_b32 m0, s76
    s_add_u32 s74, s75, s77
    buffer_load_dwordx4 v3, s[8:11], s74 offen sc1 lds
    s_add_u32 s76, s76, 4096
    s_add_u32 s75, s75, 4096
    s_cmp_eq_u32 s75, 98304
    s_cselect_b32 s75, 0, s75
    s_waitcnt vmcnt(6)
    v_cmp_gt_u32 vcc, 1, v22
    s_nop 1
    s_cmp_eq_u32 vcc_lo, 0
    s_cbranch_scc1 L_eok
    s_mov_b64 exec, 0xffffffff
    s_mov_b32 s3, 0
Lpoll_39:
    s_add_u32 s3, s3, 1
    s_cmp_gt_u32 s3, 131072
    s_cbranch_scc1 Lpollx_40
    buffer_load_dword v4, v21, s[8:11], s70 offen sc1
    s_waitcnt vmcnt(0)
    v_cmp_gt_u32 vcc, 1, v4
    s_cbranch_vccnz Lpoll_39
Lpollx_40:
    s_mov_b64 exec, -1
L_eok:
    buffer_load_dwordx4 v[64:67], v3, s[8:11], s72 offen offset:0 sc1
    buffer_load_dwordx4 v[68:71], v3, s[8:11], s72 offen offset:1024 sc1
    buffer_load_dwordx4 v[72:75], v3, s[8:11], s72 offen offset:2048 sc1
    buffer_load_dwordx4 v[76:79], v3, s[8:11], s72 offen offset:3072 sc1
    s_add_u32 s72, s72, 7168
    buffer_load_dwordx4 v[80:83], v3, s[8:11], s72 offen offset:0 sc1
    buffer_load_dwordx4 v[84:87], v3, s[8:11], s72 offen offset:1024 sc1
    buffer_load_dwordx4 v[88:91], v3, s[8:11], s72 offen offset:2048 sc1
    s_waitcnt lgkmcnt(0)
    v_pk_fma_f32 v[128:129], v[204:205], v[62:63], v[128:129] op_sel_hi:[1,0,1]
    v_pk_fma_f32 v[130:131], v[206:207], v[62:63], v[130:131] op_sel_hi:[1,0,1]
    v_pk_fma_f32 v[132:133], v[208:209], v[62:63], v[132:133] op_sel_hi:[1,0,1]
    v_pk_fma_f32 v[134:135], v[210:211], v[62:63], v[134:135] op_sel_hi:[1,0,1]
    v_pk_fma_f32 v[136:137], v[212:213], v[62:63], v[136:137] op_sel_hi:[1,0,1]
    v_pk_fma_f32 v[138:139], v[214:215], v[62:63], v[138:139] op_sel_hi:[1,0,1]
    v_pk_fma_f32 v[140:141], v[216:217], v[62:63], v[140:141] op_sel_hi:[1,0,1]
    v_pk_fma_f32 v[142:143], v[218:219], v[62:63], v[142:143] op_sel_hi:[1,0,1]
    v_pk_fma_f32 v[144:145], v[220:221], v[62:63], v[144:145] op_sel_hi:[1,0,1]
    v_pk_fma_f32 v[146:147], v[222:223], v[62:63], v[146:147] op_sel_hi:[1,0,1]
    v_pk_fma_f32 v[148:149], v[224:225], v[62:63], v[148:149] op_sel_hi:[1,0,1]
    v_pk_fma_f32 v[150:151], v[226:227], v[62:63], v[150:151] op_sel_hi:[1,0,1]
    v_pk_fma_f32 v[152:153], v[228:229], v[62:63], v[152:153] op_sel_hi:[1,0,1]
    v_pk_fma_f32 v[154:155], v[230:231], v[62:63], v[154:155] op_sel_hi:[1,0,1]
    v_pk_fma_f32 v[176:177], v[176:177], v[28:29], v[128:129] op_sel_hi:[1,0,1]
    v_pk_fma_f32 v[178:179], v[178:179], v[28:29], v[130:131] op_sel_hi:[1,0,1]
    v_pk_fma_f32 v[180:181], v[180:181], v[28:29], v[132:133] op_sel_hi:[1,0,1]
    v_pk_fma_f32 v[182:183], v[182:183], v[28:29], v[134:135] op_sel_hi:[1,0,1]
    v_pk_fma_f32 v[184:185], v[184:185], v[28:29], v[136:137] op_sel_hi:[1,0,1]
    v_pk_fma_f32 v[186:187], v[186:187], v[28:29], v[138:139] op_sel_hi:[1,0,1]
    v_pk_fma_f32 v[188:189], v[188:189], v[28:29], v[140:141] op_sel_hi:[1,0,1]
    v_pk_fma_f32 v[190:191], v[190:191], v[28:29], v[142:143] op_sel_hi:[1,0,1]
    v_pk_fma_f32 v[192:193], v[192:193], v[28:29], v[144:145] op_sel_hi:[1,0,1]
    v_pk_fma_f32 v[194:195], v[194:195], v[28:29], v[146:147] op_sel_hi:[1,0,1]
    v_pk_fma_f32 v[196:197], v[196:197], v[28:29], v[148:149] op_sel_hi:[1,0,1]
    v_pk_fma_f32 v[198:199], v[198:199], v[28:29], v[150:151] op_sel_hi:[1,0,1]
    v_pk_fma_f32 v[200:201], v[200:201], v[28:29], v[152:153] op_sel_hi:[1,0,1]
    v_pk_fma_f32 v[202:203], v[202:203], v[28:29], v[154:155] op_sel_hi:[1,0,1]
    v_pk_mul_f32 v[204:205], v[176:177], v[176:177]
    v_pk_mul_f32 v[206:207], v[178:179], v[178:179]
    v_pk_mul_f32 v[208:209], v[180:181], v[180:181]
    v_pk_mul_f32 v[210:211], v[182:183], v[182:183]
    v_pk_mul_f32 v[212:213], v[184:185], v[184:185]
    v_pk_mul_f32 v[214:215], v[186:187], v[186:187]
    v_pk_mul_f32 v[216:217], v[188:189], v[188:189]
    v_pk_mul_f32 v[218:219], v[190:191], v[190:191]
    v_pk_mul_f32 v[220:221], v[192:193], v[192:193]
    v_pk_mul_f32 v[222:223], v[194:195], v[194:195]
    v_pk_mul_f32 v[224:225], v[196:197], v[196:197]
    v_pk_mul_f32 v[226:227], v[198:199], v[198:199]
    v_pk_mul_f32 v[228:229], v[200:201], v[200:201]
    v_pk_mul_f32 v[230:231], v[202:203], v[202:203]
    v_pk_fma_f32 v[204:205], v[204:205], s[64:65], v[60:61]
    v_pk_fma_f32 v[206:207], v[206:207], s[64:65], v[60:61]
    v_pk_fma_f32 v[208:209], v[208:209], s[64:65], v[60:61]
    v_pk_fma_f32 v[210:211], v[210:211], s[64:65], v[60:61]
    v_pk_fma_f32 v[212:213], v[212:213], s[64:65], v[60:61]
    v_pk_fma_f32 v[214:215], v[214:215], s[64:65], v[60:61]
    v_pk_fma_f32 v[216:217], v[216:217], s[64:65], v[60:61]
    v_pk_fma_f32 v[218:219], v[218:219], s[64:65], v[60:61]
    v_pk_fma_f32 v[220:221], v[220:221], s[64:65], v[60:61]
    v_pk_fma_f32 v[222:223], v[222:223], s[64:65], v[60:61]
    v_pk_fma_f32 v[224:225], v[224:225], s[64:65], v[60:61]
    v_pk_fma_f32 v[226:227], v[226:227], s[64:65], v[60:61]
    v_pk_fma_f32 v[228:229], v[228:229], s[64:65], v[60:61]
    v_pk_fma_f32 v[230:231], v[230:231], s[64:65], v[60:61]
    v_pk_mul_f32 v[204:205], v[204:205], v[176:177]
    v_pk_mul_f32 v[206:207], v[206:207], v[178:179]
    v_pk_mul_f32 v[208:209], v[208:209], v[180:181]
    v_pk_mul_f32 v[210:211], v[210:211], v[182:183]
    v_pk_mul_f32 v[212:213], v[212:213], v[184:185]
    v_pk_mul_f32 v[214:215], v[214:215], v[186:187]
    v_pk_mul_f32 v[216:217], v[216:217], v[188:189]
    v_pk_mul_f32 v[218:219], v[218:219], v[190:191]
    v_pk_mul_f32 v[220:221], v[220:221], v[192:193]
    v_pk_mul_f32 v[222:223], v[222:223], v[194:195]
    v_pk_mul_f32 v[224:225], v[224:225], v[196:197]
    v_pk_mul_f32 v[226:227], v[226:227], v[198:199]
    v_pk_mul_f32 v[228:229], v[228:229], v[200:201]
    v_pk_mul_f32 v[230:231], v[230:231], v[202:203]
    v_exp_f32 v204, v204
    v_exp_f32 v205, v205
    v_exp_f32 v206, v206
    v_exp_f32 v207, v207
    v_exp_f32 v208, v208
    v_exp_f32 v209, v209
    v_exp_f32 v210, v210
    v_exp_f32 v211, v211
    v_exp_f32 v212, v212
    v_exp_f32 v213, v213
    v_exp_f32 v214, v214
    v_exp_f32 v215, v215
    v_exp_f32 v216, v216
    v_exp_f32 v217, v217
    v_exp_f32 v218, v218
    v_exp_f32 v219, v219
    v_exp_f32 v220, v220
    v_exp_f32 v221, v221
    v_exp_f32 v222, v222
    v_exp_f32 v223, v223
    v_exp_f32 v224, v224
    v_exp_f32 v225, v225
    v_exp_f32 v226, v226
    v_exp_f32 v227, v227
    v_exp_f32 v228, v228
    v_exp_f32 v229, v229
    v_exp_f32 v230, v230
    v_exp_f32 v231, v231
    buffer_load_dwordx4 v[92:95], v3, s[8:11], s72 offen offset:3072 sc1
    s_add_u32 s72, s72, 7168
    buffer_load_dwordx4 v[96:99], v3, s[8:11], s72 offen offset:0 sc1
    buffer_load_dwordx4 v[100:103], v3, s[8:11], s72 offen offset:1024 sc1
    buffer_load_dwordx4 v[104:107], v3, s[8:11], s72 offen offset:2048 sc1
    buffer_load_dwordx4 v[108:111], v3, s[8:11], s72 offen offset:3072 sc1
    s_add_u32 s72, s72, 7168
    buffer_load_dwordx4 v[112:115], v3, s[8:11], s72 offen offset:0 sc1
    buffer_load_dwordx4 v[116:119], v3, s[8:11], s72 offen offset:1024 sc1
    v_pk_add_f32 v[204:205], v[204:205], s[66:67]
    v_pk_add_f32 v[206:207], v[206:207], s[66:67]
    v_pk_add_f32 v[208:209], v[208:209], s[66:67]
    v_pk_add_f32 v[210:211], v[210:211], s[66:67]
    v_pk_add_f32 v[212:213], v[212:213], s[66:67]
    v_pk_add_f32 v[214:215], v[214:215], s[66:67]
    v_pk_add_f32 v[216:217], v[216:217], s[66:67]
    v_pk_add_f32 v[218:219], v[218:219], s[66:67]
    v_pk_add_f32 v[220:221], v[220:221], s[66:67]
    v_pk_add_f32 v[222:223], v[222:223], s[66:67]
    v_pk_add_f32 v[224:225], v[224:225], s[66:67]
    v_pk_add_f32 v[226:227], v[226:227], s[66:67]
    v_pk_add_f32 v[228:229], v[228:229], s[66:67]
    v_pk_add_f32 v[230:231], v[230:231], s[66:67]
    v_rcp_f32 v204, v204
    v_rcp_f32 v205, v205
    v_rcp_f32 v206, v206
    v_rcp_f32 v207, v207
    v_rcp_f32 v208, v208
    v_rcp_f32 v209, v209
    v_rcp_f32 v210, v210
    v_rcp_f32 v211, v211
    v_rcp_f32 v212, v212
    v_rcp_f32 v213, v213
    v_rcp_f32 v214, v214
    v_rcp_f32 v215, v215
    v_rcp_f32 v216, v216
    v_rcp_f32 v217, v217
    v_rcp_f32 v218, v218
    v_rcp_f32 v219, v219
    v_rcp_f32 v220, v220
    v_rcp_f32 v221, v221
    v_rcp_f32 v222, v222
    v_rcp_f32 v223, v223
    v_rcp_f32 v224, v224
    v_rcp_f32 v225, v225
    v_rcp_f32 v226, v226
    v_rcp_f32 v227, v227
    v_rcp_f32 v228, v228
    v_rcp_f32 v229, v229
    v_rcp_f32 v230, v230
    v_rcp_f32 v231, v231
    v_pk_mul_f32 v[176:177], v[176:177], v[204:205]
    v_pk_mul_f32 v[178:179], v[178:179], v[206:207]
    v_pk_mul_f32 v[180:181], v[180:181], v[208:209]
    v_pk_mul_f32 v[182:183], v[182:183], v[210:211]
    v_pk_mul_f32 v[184:185], v[184:185], v[212:213]
    v_pk_mul_f32 v[186:187], v[186:187], v[214:215]
    v_pk_mul_f32 v[188:189], v[188:189], v[216:217]
    v_pk_mul_f32 v[190:191], v[190:191], v[218:219]
    v_pk_mul_f32 v[192:193], v[192:193], v[220:221]
    v_pk_mul_f32 v[194:195], v[194:195], v[222:223]
    v_pk_mul_f32 v[196:197], v[196:197], v[224:225]
    v_pk_mul_f32 v[198:199], v[198:199], v[226:227]
    v_pk_mul_f32 v[200:201], v[200:201], v[228:229]
    v_pk_mul_f32 v[202:203], v[202:203], v[230:231]
    v_cvt_pk_bf16_f32 v240, v176, v177
    v_cvt_pk_bf16_f32 v241, v178, v179
    v_cvt_pk_bf16_f32 v242, v180, v181
    v_cvt_pk_bf16_f32 v243, v182, v183
    v_cvt_pk_bf16_f32 v244, v184, v185
    v_cvt_pk_bf16_f32 v245, v186, v187
    v_cvt_pk_bf16_f32 v246, v188, v189
    v_cvt_pk_bf16_f32 v247, v190, v191
    v_cvt_pk_bf16_f32 v248, v192, v193
    v_cvt_pk_bf16_f32 v249, v194, v195
    v_cvt_pk_bf16_f32 v250, v196, v197
    v_cvt_pk_bf16_f32 v251, v198, v199
    v_cvt_pk_bf16_f32 v252, v200, v201
    v_cvt_pk_bf16_f32 v253, v202, v203
    s_lshl_b32 s68, s55, 1
    s_add_u32 s68, s68, 1048576
    s_mul_i32 s64, s47, 3072
    s_add_u32 s64, s64, s68
    s_lshl_b32 s65, s47, 9
    s_add_u32 s65, s65, s68
    s_add_u32 s65, s65, 24576
    v_lshrrev_b32 v6, 5, v0
    v_lshlrev_b32 v6, 8, v6
    v_lshl_add_u32 v6, v1, 4, v6
    s_waitcnt vmcnt(13)
    v_mfma_f32_16x16x32_bf16 v[128:131], v[64:67], a[0:3], 0
    buffer_load_dwordx4 v[32:35], v3, s[8:11], s72 offen offset:2048 sc1
    v_mfma_f32_16x16x32_bf16 v[156:159], v[64:67], a[4:7], 0
    v_mfma_f32_16x16x32_bf16 v[184:187], v[64:67], a[8:11], 0
    v_mfma_f32_16x16x32_bf16 v[212:215], v[64:67], a[12:15], 0
    s_waitcnt vmcnt(13)
    v_mfma_f32_16x16x32_bf16 v[132:135], v[68:71], a[0:3], 0
    buffer_load_dwordx4 v[36:39], v3, s[8:11], s72 offen offset:3072 sc1
    s_add_u32 s72, s72, 7168
    v_mfma_f32_16x16x32_bf16 v[160:163], v[68:71], a[4:7], 0
    v_mfma_f32_16x16x32_bf16 v[188:191], v[68:71], a[8:11], 0
    s_mov_b32 m0, s76
    s_add_u32 s74, s75, s77
    buffer_load_dwordx4 v3, s[8:11], s74 offen sc1 lds
    s_add_u32 s76, s76, 4096
    s_add_u32 s75, s75, 4096
    s_cmp_eq_u32 s75, 98304
    s_cselect_b32 s75, 0, s75
    v_mfma_f32_16x16x32_bf16 v[216:219], v[68:71], a[12:15], 0
    s_waitcnt vmcnt(14)
    v_mfma_f32_16x16x32_bf16 v[136:139], v[72:75], a[0:3], 0
    buffer_load_dwordx4 v[40:43], v3, s[8:11], s72 offen offset:0 sc1
    v_mfma_f32_16x16x32_bf16 v[164:167], v[72:75], a[4:7], 0
    v_mfma_f32_16x16x32_bf16 v[192:195], v[72:75], a[8:11], 0
    v_mfma_f32_16x16x32_bf16 v[220:223], v[72:75], a[12:15], 0
    s_waitcnt vmcnt(14)
    v_mfma_f32_16x16x32_bf16 v[140:143], v[76:79], a[0:3], 0
    buffer_load_dwordx4 v[44:47], v3, s[8:11], s72 offen offset:1024 sc1
    v_mfma_f32_16x16x32_bf16 v[168:171], v[76:79], a[4:7], 0
    v_mfma_f32_16x16x32_bf16 v[196:199], v[76:79], a[8:11], 0
    v_mfma_f32_16x16x32_bf16 v[224:227], v[76:79], a[12:15], 0
    s_waitcnt vmcnt(14)
    v_mfma_f32_16x16x32_bf16 v[128:131], v[80:83], a[16:19], v[128:131]
    buffer_load_dwordx4 v[48:51], v3, s[8:11], s72 offen offset:2048 sc1
    v_mfma_f32_16x16x32_bf16 v[156:159], v[80:83], a[20:23], v[156:159]
    v_mfma_f32_16x16x32_bf16 v[184:187], v[80:83], a[24:27], v[184:187]
    v_mfma_f32_16x16x32_bf16 v[212:215], v[80:83], a[28:31], v[212:215]
    s_waitcnt vmcnt(14)
    v_mfma_f32_16x16x32_bf16 v[132:135], v[84:87], a[16:19], v[132:135]
    buffer_load_dwordx4 v[52:55], v3, s[8:11], s72 offen offset:3072 sc1
    s_add_u32 s72, s72, 7168
    v_mfma_f32_16x16x32_bf16 v[160:163], v[84:87], a[20:23], v[160:163]
    v_mfma_f32_16x16x32_bf16 v[188:191], v[84:87], a[24:27], v[188:191]
    s_mov_b32 m0, s76
    s_add_u32 s74, s75, s77
    buffer_load_dwordx4 v3, s[8:11], s74 offen sc1 lds
    s_add_u32 s76, s76, 4096
    v_mfma_f32_16x16x32_bf16 v[216:219], v[84:87], a[28:31], v[216:219]
    s_waitcnt vmcnt(15)
    v_mfma_f32_16x16x32_bf16 v[136:139], v[88:91], a[16:19], v[136:139]
    buffer_load_dwordx4 v[56:59], v3, s[8:11], s72 offen offset:0 sc1
    v_mfma_f32_16x16x32_bf16 v[164:167], v[88:91], a[20:23], v[164:167]
    v_mfma_f32_16x16x32_bf16 v[192:195], v[88:91], a[24:27], v[192:195]
    v_mfma_f32_16x16x32_bf16 v[220:223], v[88:91], a[28:31], v[220:223]
    s_waitcnt vmcnt(15)
    v_mfma_f32_16x16x32_bf16 v[140:143], v[92:95], a[16:19], v[140:143]
    buffer_load_dwordx4 v[64:67], v3, s[8:11], s72 offen offset:1024 sc1
    v_mfma_f32_16x16x32_bf16 v[168:171], v[92:95], a[20:23], v[168:171]
    v_mfma_f32_16x16x32_bf16 v[196:199], v[92:95], a[24:27], v[196:199]
    v_mfma_f32_16x16x32_bf16 v[224:227], v[92:95], a[28:31], v[224:227]
    s_waitcnt vmcnt(15)
    v_mfma_f32_16x16x32_bf16 v[128:131], v[96:99], a[32:35], v[128:131]
    buffer_load_dwordx4 v[68:71], v3, s[8:11], s72 offen offset:2048 sc1
    v_mfma_f32_16x16x32_bf16 v[156:159], v[96:99], a[36:39], v[156:159]
    v_mfma_f32_16x16x32_bf16 v[184:187], v[96:99], a[40:43], v[184:187]
    v_mfma_f32_16x16x32_bf16 v[212:215], v[96:99], a[44:47], v[212:215]
    s_waitcnt vmcnt(15)
    v_mfma_f32_16x16x32_bf16 v[132:135], v[100:103], a[32:35], v[132:135]
    buffer_load_dwordx4 v[72:75], v3, s[8:11], s72 offen offset:3072 sc1
    s_add_u32 s72, s72, 7168
    v_mfma_f32_16x16x32_bf16 v[160:163], v[100:103], a[36:39], v[160:163]
    v_mfma_f32_16x16x32_bf16 v[188:191], v[100:103], a[40:43], v[188:191]
    s_mov_b32 m0, s76
    s_add_u32 s74, s77, 98304
    buffer_load_dwordx4 v3, s[8:11], s74 offen sc1 lds
    s_add_u32 s76, s76, 4096
    v_mfma_f32_16x16x32_bf16 v[216:219], v[100:103], a[44:47], v[216:219]
    s_waitcnt vmcnt(16)
    v_mfma_f32_16x16x32_bf16 v[136:139], v[104:107], a[32:35], v[136:139]
    buffer_load_dwordx4 v[76:79], v3, s[8:11], s72 offen offset:0 sc1
    v_mfma_f32_16x16x32_bf16 v[164:167], v[104:107], a[36:39], v[164:167]
    v_mfma_f32_16x16x32_bf16 v[192:195], v[104:107], a[40:43], v[192:195]
    v_mfma_f32_16x16x32_bf16 v[220:223], v[104:107], a[44:47], v[220:223]
    s_waitcnt vmcnt(16)
    v_mfma_f32_16x16x32_bf16 v[140:143], v[108:111], a[32:35], v[140:143]
    buffer_load_dwordx4 v[80:83], v3, s[8:11], s72 offen offset:1024 sc1
    v_mfma_f32_16x16x32_bf16 v[168:171], v[108:111], a[36:39], v[168:171]
    v_mfma_f32_16x16x32_bf16 v[196:199], v[108:111], a[40:43], v[196:199]
    v_mfma_f32_16x16x32_bf16 v[224:227], v[108:111], a[44:47], v[224:227]
    s_waitcnt vmcnt(16)
    v_mfma_f32_16x16x32_bf16 v[128:131], v[112:115], a[48:51], v[128:131]
    buffer_load_dwordx4 v[84:87], v3, s[8:11], s72 offen offset:2048 sc1
    v_mfma_f32_16x16x32_bf16 v[156:159], v[112:115], a[52:55], v[156:159]
    v_mfma_f32_16x16x32_bf16 v[184:187], v[112:115], a[56:59], v[184:187]
    v_mfma_f32_16x16x32_bf16 v[212:215], v[112:115], a[60:63], v[212:215]
    s_waitcnt vmcnt(16)
    v_mfma_f32_16x16x32_bf16 v[132:135], v[116:119], a[48:51], v[132:135]
    buffer_load_dwordx4 v[88:91], v3, s[8:11], s72 offen offset:3072 sc1
    s_add_u32 s72, s72, 7168
    v_mfma_f32_16x16x32_bf16 v[160:163], v[116:119], a[52:55], v[160:163]
    v_mfma_f32_16x16x32_bf16 v[188:191], v[116:119], a[56:59], v[188:191]
    s_mov_b32 m0, s76
    s_add_u32 s74, s77, 102400
    buffer_load_dwordx4 v3, s[8:11], s74 offen sc1 lds
    s_add_u32 s76, s76, 4096
    v_mfma_f32_16x16x32_bf16 v[216:219], v[116:119], a[60:63], v[216:219]
    s_waitcnt vmcnt(17)
    v_mfma_f32_16x16x32_bf16 v[136:139], v[32:35], a[48:51], v[136:139]
    buffer_load_dwordx4 v[92:95], v3, s[8:11], s72 offen offset:0 sc1
    v_mfma_f32_16x16x32_bf16 v[164:167], v[32:35], a[52:55], v[164:167]
    v_mfma_f32_16x16x32_bf16 v[192:195], v[32:35], a[56:59], v[192:195]
    v_mfma_f32_16x16x32_bf16 v[220:223], v[32:35], a[60:63], v[220:223]
    s_waitcnt vmcnt(17)
    v_mfma_f32_16x16x32_bf16 v[140:143], v[36:39], a[48:51], v[140:143]
    buffer_load_dwordx4 v[96:99], v3, s[8:11], s72 offen offset:1024 sc1
    v_mfma_f32_16x16x32_bf16 v[168:171], v[36:39], a[52:55], v[168:171]
    v_mfma_f32_16x16x32_bf16 v[196:199], v[36:39], a[56:59], v[196:199]
    v_mfma_f32_16x16x32_bf16 v[224:227], v[36:39], a[60:63], v[224:227]
    s_waitcnt vmcnt(16)
    v_mfma_f32_16x16x32_bf16 v[128:131], v[40:43], a[64:67], v[128:131]
    buffer_load_dwordx4 v[100:103], v3, s[8:11], s72 offen offset:2048 sc1
    v_mfma_f32_16x16x32_bf16 v[156:159], v[40:43], a[68:71], v[156:159]
    v_mfma_f32_16x16x32_bf16 v[184:187], v[40:43], a[72:75], v[184:187]
    v_mfma_f32_16x16x32_bf16 v[212:215], v[40:43], a[76:79], v[212:215]
    s_waitcnt vmcnt(16)
    v_mfma_f32_16x16x32_bf16 v[132:135], v[44:47], a[64:67], v[132:135]
    buffer_load_dwordx4 v[104:107], v3, s[8:11], s72 offen offset:3072 sc1
    s_add_u32 s72, s72, 7168
    v_mfma_f32_16x16x32_bf16 v[160:163], v[44:47], a[68:71], v[160:163]
    v_mfma_f32_16x16x32_bf16 v[188:191], v[44:47], a[72:75], v[188:191]
    s_mov_b32 m0, s76
    s_add_u32 s74, s77, 106496
    buffer_load_dwordx4 v3, s[8:11], s74 offen sc1 lds
    s_add_u32 s76, s76, 4096
    v_mfma_f32_16x16x32_bf16 v[216:219], v[44:47], a[76:79], v[216:219]
    s_waitcnt vmcnt(17)
    v_mfma_f32_16x16x32_bf16 v[136:139], v[48:51], a[64:67], v[136:139]
    buffer_load_dwordx4 v[108:111], v3, s[8:11], s72 offen offset:0 sc1
    v_mfma_f32_16x16x32_bf16 v[164:167], v[48:51], a[68:71], v[164:167]
    v_mfma_f32_16x16x32_bf16 v[192:195], v[48:51], a[72:75], v[192:195]
    v_mfma_f32_16x16x32_bf16 v[220:223], v[48:51], a[76:79], v[220:223]
    s_waitcnt vmcnt(17)
    v_mfma_f32_16x16x32_bf16 v[140:143], v[52:55], a[64:67], v[140:143]
    buffer_load_dwordx4 v[112:115], v3, s[8:11], s72 offen offset:1024 sc1
    v_mfma_f32_16x16x32_bf16 v[168:171], v[52:55], a[68:71], v[168:171]
    v_mfma_f32_16x16x32_bf16 v[196:199], v[52:55], a[72:75], v[196:199]
    v_mfma_f32_16x16x32_bf16 v[224:227], v[52:55], a[76:79], v[224:227]
    s_waitcnt vmcnt(16)
    v_mfma_f32_16x16x32_bf16 v[128:131], v[56:59], a[80:83], v[128:131]
    buffer_load_dwordx4 v[116:119], v3, s[8:11], s72 offen offset:2048 sc1
    v_mfma_f32_16x16x32_bf16 v[156:159], v[56:59], a[84:87], v[156:159]
    v_mfma_f32_16x16x32_bf16 v[184:187], v[56:59], a[88:91], v[184:187]
    v_mfma_f32_16x16x32_bf16 v[212:215], v[56:59], a[92:95], v[212:215]
    s_waitcnt vmcnt(16)
    v_mfma_f32_16x16x32_bf16 v[132:135], v[64:67], a[80:83], v[132:135]
    buffer_load_dwordx4 v[32:35], v3, s[8:11], s72 offen offset:3072 sc1
    s_add_u32 s72, s72, 7168
    v_mfma_f32_16x16x32_bf16 v[160:163], v[64:67], a[84:87], v[160:163]
    v_mfma_f32_16x16x32_bf16 v[188:191], v[64:67], a[88:91], v[188:191]
    s_mov_b32 m0, s76
    s_add_u32 s74, s77, 110592
    buffer_load_dwordx4 v3, s[8:11], s74 offen sc1 lds
    s_add_u32 s76, s76, 4096
    v_mfma_f32_16x16x32_bf16 v[216:219], v[64:67], a[92:95], v[216:219]
    s_waitcnt vmcnt(17)
    v_mfma_f32_16x16x32_bf16 v[136:139], v[68:71], a[80:83], v[136:139]
    buffer_load_dwordx4 v[36:39], v3, s[8:11], s72 offen offset:0 sc1
    v_mfma_f32_16x16x32_bf16 v[164:167], v[68:71], a[84:87], v[164:167]
    v_mfma_f32_16x16x32_bf16 v[192:195], v[68:71], a[88:91], v[192:195]
    v_mfma_f32_16x16x32_bf16 v[220:223], v[68:71], a[92:95], v[220:223]
    s_waitcnt vmcnt(17)
    v_mfma_f32_16x16x32_bf16 v[140:143], v[72:75], a[80:83], v[140:143]
    buffer_load_dwordx4 v[40:43], v3, s[8:11], s72 offen offset:1024 sc1
    v_mfma_f32_16x16x32_bf16 v[168:171], v[72:75], a[84:87], v[168:171]
    v_mfma_f32_16x16x32_bf16 v[196:199], v[72:75], a[88:91], v[196:199]
    v_mfma_f32_16x16x32_bf16 v[224:227], v[72:75], a[92:95], v[224:227]
    s_waitcnt vmcnt(16)
    v_mfma_f32_16x16x32_bf16 v[128:131], v[76:79], a[96:99], v[128:131]
    buffer_load_dwordx4 v[44:47], v3, s[8:11], s72 offen offset:2048 sc1
    v_mfma_f32_16x16x32_bf16 v[156:159], v[76:79], a[100:103], v[156:159]
    v_mfma_f32_16x16x32_bf16 v[184:187], v[76:79], a[104:107], v[184:187]
    v_mfma_f32_16x16x32_bf16 v[212:215], v[76:79], a[108:111], v[212:215]
    s_waitcnt vmcnt(16)
    v_mfma_f32_16x16x32_bf16 v[132:135], v[80:83], a[96:99], v[132:135]
    buffer_load_dwordx4 v[48:51], v3, s[8:11], s72 offen offset:3072 sc1
    s_add_u32 s72, s72, 7168
    v_mfma_f32_16x16x32_bf16 v[160:163], v[80:83], a[100:103], v[160:163]
    v_mfma_f32_16x16x32_bf16 v[188:191], v[80:83], a[104:107], v[188:191]
    v_mfma_f32_16x16x32_bf16 v[216:219], v[80:83], a[108:111], v[216:219]
    s_waitcnt vmcnt(16)
    v_mfma_f32_16x16x32_bf16 v[136:139], v[84:87], a[96:99], v[136:139]
    buffer_load_dwordx4 v[52:55], v3, s[8:11], s72 offen offset:0 sc1
    v_mfma_f32_16x16x32_bf16 v[164:167], v[84:87], a[100:103], v[164:167]
    v_mfma_f32_16x16x32_bf16 v[192:195], v[84:87], a[104:107], v[192:195]
    v_mfma_f32_16x16x32_bf16 v[220:223], v[84:87], a[108:111], v[220:223]
    s_waitcnt vmcnt(16)
    v_mfma_f32_16x16x32_bf16 v[140:143], v[88:91], a[96:99], v[140:143]
    buffer_load_dwordx4 v[56:59], v3, s[8:11], s72 offen offset:1024 sc1
    v_mfma_f32_16x16x32_bf16 v[168:171], v[88:91], a[100:103], v[168:171]
    v_mfma_f32_16x16x32_bf16 v[196:199], v[88:91], a[104:107], v[196:199]
    v_mfma_f32_16x16x32_bf16 v[224:227], v[88:91], a[108:111], v[224:227]
    s_waitcnt vmcnt(15)
    v_mfma_f32_16x16x32_bf16 v[128:131], v[92:95], a[112:115], v[128:131]
    buffer_load_dwordx4 v[64:67], v3, s[8:11], s72 offen offset:2048 sc1
    v_mfma_f32_16x16x32_bf16 v[156:159], v[92:95], a[116:119], v[156:159]
    v_mfma_f32_16x16x32_bf16 v[184:187], v[92:95], a[120:123], v[184:187]
    v_mfma_f32_16x16x32_bf16 v[212:215], v[92:95], a[124:127], v[212:215]
    s_waitcnt vmcnt(15)
    v_mfma_f32_16x16x32_bf16 v[132:135], v[96:99], a[112:115], v[132:135]
    buffer_load_dwordx4 v[68:71], v3, s[8:11], s72 offen offset:3072 sc1
    s_add_u32 s72, s72, 7168
    v_mfma_f32_16x16x32_bf16 v[160:163], v[96:99], a[116:119], v[160:163]
    v_mfma_f32_16x16x32_bf16 v[188:191], v[96:99], a[120:123], v[188:191]
    v_mfma_f32_16x16x32_bf16 v[216:219], v[96:99], a[124:127], v[216:219]
    s_waitcnt vmcnt(15)
    v_mfma_f32_16x16x32_bf16 v[136:139], v[100:103], a[112:115], v[136:139]
    buffer_load_dwordx4 v[72:75], v3, s[8:11], s72 offen offset:0 sc1
    v_mfma_f32_16x16x32_bf16 v[164:167], v[100:103], a[116:119], v[164:167]
    v_mfma_f32_16x16x32_bf16 v[192:195], v[100:103], a[120:123], v[192:195]
    v_mfma_f32_16x16x32_bf16 v[220:223], v[100:103], a[124:127], v[220:223]
    s_waitcnt vmcnt(15)
    v_mfma_f32_16x16x32_bf16 v[140:143], v[104:107], a[112:115], v[140:143]
    buffer_load_dwordx4 v[76:79], v3, s[8:11], s72 offen offset:1024 sc1
    v_mfma_f32_16x16x32_bf16 v[168:171], v[104:107], a[116:119], v[168:171]
    v_mfma_f32_16x16x32_bf16 v[196:199], v[104:107], a[120:123], v[196:199]
    v_mfma_f32_16x16x32_bf16 v[224:227], v[104:107], a[124:127], v[224:227]
    s_waitcnt vmcnt(14)
    v_mfma_f32_16x16x32_bf16 v[128:131], v[108:111], a[128:131], v[128:131]
    buffer_load_dwordx4 v[80:83], v3, s[8:11], s72 offen offset:2048 sc1
    v_mfma_f32_16x16x32_bf16 v[156:159], v[108:111], a[132:135], v[156:159]
    v_mfma_f32_16x16x32_bf16 v[184:187], v[108:111], a[136:139], v[184:187]
    v_mfma_f32_16x16x32_bf16 v[212:215], v[108:111], a[140:143], v[212:215]
    s_waitcnt vmcnt(14)
    v_mfma_f32_16x16x32_bf16 v[132:135], v[112:115], a[128:131], v[132:135]
    buffer_load_dwordx4 v[84:87], v3, s[8:11], s72 offen offset:3072 sc1
    s_add_u32 s72, s72, 7168
    v_mfma_f32_16x16x32_bf16 v[160:163], v[112:115], a[132:135], v[160:163]
    v_mfma_f32_16x16x32_bf16 v[188:191], v[112:115], a[136:139], v[188:191]
    v_mfma_f32_16x16x32_bf16 v[216:219], v[112:115], a[140:143], v[216:219]
    s_waitcnt vmcnt(14)
    v_mfma_f32_16x16x32_bf16 v[136:139], v[116:119], a[128:131], v[136:139]
    buffer_load_dwordx4 v[88:91], v3, s[8:11], s72 offen offset:0 sc1
    v_mfma_f32_16x16x32_bf16 v[164:167], v[116:119], a[132:135], v[164:167]
    v_mfma_f32_16x16x32_bf16 v[192:195], v[116:119], a[136:139], v[192:195]
    v_mfma_f32_16x16x32_bf16 v[220:223], v[116:119], a[140:143], v[220:223]
    s_waitcnt vmcnt(14)
    v_mfma_f32_16x16x32_bf16 v[140:143], v[32:35], a[128:131], v[140:143]
    buffer_load_dwordx4 v[92:95], v3, s[8:11], s72 offen offset:1024 sc1
    v_mfma_f32_16x16x32_bf16 v[168:171], v[32:35], a[132:135], v[168:171]
    v_mfma_f32_16x16x32_bf16 v[196:199], v[32:35], a[136:139], v[196:199]
    v_mfma_f32_16x16x32_bf16 v[224:227], v[32:35], a[140:143], v[224:227]
    s_waitcnt vmcnt(13)
    v_mfma_f32_16x16x32_bf16 v[128:131], v[36:39], a[144:147], v[128:131]
    buffer_load_dwordx4 v[96:99], v3, s[8:11], s72 offen offset:2048 sc1
    v_mfma_f32_16x16x32_bf16 v[156:159], v[36:39], a[148:151], v[156:159]
    v_mfma_f32_16x16x32_bf16 v[184:187], v[36:39], a[152:155], v[184:187]
    v_mfma_f32_16x16x32_bf16 v[212:215], v[36:39], a[156:159], v[212:215]
    s_waitcnt vmcnt(13)
    v_mfma_f32_16x16x32_bf16 v[132:135], v[40:43], a[144:147], v[132:135]
    buffer_load_dwordx4 v[100:103], v3, s[8:11], s72 offen offset:3072 sc1
    s_add_u32 s72, s72, 7168
    v_mfma_f32_16x16x32_bf16 v[160:163], v[40:43], a[148:151], v[160:163]
    v_mfma_f32_16x16x32_bf16 v[188:191], v[40:43], a[152:155], v[188:191]
    v_mfma_f32_16x16x32_bf16 v[216:219], v[40:43], a[156:159], v[216:219]
    s_waitcnt vmcnt(13)
    v_mfma_f32_16x16x32_bf16 v[136:139], v[44:47], a[144:147], v[136:139]
    buffer_load_dwordx4 v[104:107], v3, s[8:11], s72 offen offset:0 sc1
    v_mfma_f32_16x16x32_bf16 v[164:167], v[44:47], a[148:151], v[164:167]
    v_mfma_f32_16x16x32_bf16 v[192:195], v[44:47], a[152:155], v[192:195]
    v_mfma_f32_16x16x32_bf16 v[220:223], v[44:47], a[156:159], v[220:223]
    s_waitcnt vmcnt(13)
    v_mfma_f32_16x16x32_bf16 v[140:143], v[48:51], a[144:147], v[140:143]
    buffer_load_dwordx4 v[108:111], v3, s[8:11], s72 offen offset:1024 sc1
    v_mfma_f32_16x16x32_bf16 v[168:171], v[48:51], a[148:151], v[168:171]
    v_mfma_f32_16x16x32_bf16 v[196:199], v[48:51], a[152:155], v[196:199]
    v_mfma_f32_16x16x32_bf16 v[224:227], v[48:51], a[156:159], v[224:227]
    s_waitcnt vmcnt(13)
    v_mfma_f32_16x16x32_bf16 v[128:131], v[52:55], a[160:163], v[128:131]
    buffer_load_dwordx4 v[112:115], v3, s[8:11], s72 offen offset:2048 sc1
    v_mfma_f32_16x16x32_bf16 v[156:159], v[52:55], a[164:167], v[156:159]
    v_mfma_f32_16x16x32_bf16 v[184:187], v[52:55], a[168:171], v[184:187]
    v_mfma_f32_16x16x32_bf16 v[212:215], v[52:55], a[172:175], v[212:215]
    s_waitcnt vmcnt(13)
    v_mfma_f32_16x16x32_bf16 v[132:135], v[56:59], a[160:163], v[132:135]
    buffer_load_dwordx4 v[116:119], v3, s[8:11], s72 offen offset:3072 sc1
    s_add_u32 s72, s72, 7168
    v_mfma_f32_16x16x32_bf16 v[160:163], v[56:59], a[164:167], v[160:163]
    v_mfma_f32_16x16x32_bf16 v[188:191], v[56:59], a[168:171], v[188:191]
    v_mfma_f32_16x16x32_bf16 v[216:219], v[56:59], a[172:175], v[216:219]
    s_waitcnt vmcnt(13)
    v_mfma_f32_16x16x32_bf16 v[136:139], v[64:67], a[160:163], v[136:139]
    buffer_load_dwordx4 v[32:35], v3, s[8:11], s72 offen offset:0 sc1
    v_mfma_f32_16x16x32_bf16 v[164:167], v[64:67], a[164:167], v[164:167]
    v_mfma_f32_16x16x32_bf16 v[192:195], v[64:67], a[168:171], v[192:195]
    v_mfma_f32_16x16x32_bf16 v[220:223], v[64:67], a[172:175], v[220:223]
    s_waitcnt vmcnt(13)
    v_mfma_f32_16x16x32_bf16 v[140:143], v[68:71], a[160:163], v[140:143]
    buffer_load_dwordx4 v[36:39], v3, s[8:11], s72 offen offset:1024 sc1
    v_mfma_f32_16x16x32_bf16 v[168:171], v[68:71], a[164:167], v[168:171]
    v_mfma_f32_16x16x32_bf16 v[196:199], v[68:71], a[168:171], v[196:199]
    v_mfma_f32_16x16x32_bf16 v[224:227], v[68:71], a[172:175], v[224:227]
    s_waitcnt vmcnt(13)
    v_mfma_f32_16x16x32_bf16 v[128:131], v[72:75], a[176:179], v[128:131]
    buffer_load_dwordx4 v[40:43], v3, s[8:11], s72 offen offset:2048 sc1
    v_mfma_f32_16x16x32_bf16 v[156:159], v[72:75], a[180:183], v[156:159]
    v_mfma_f32_16x16x32_bf16 v[184:187], v[72:75], a[184:187], v[184:187]
    v_mfma_f32_16x16x32_bf16 v[212:215], v[72:75], a[188:191], v[212:215]
    s_waitcnt vmcnt(13)
    v_mfma_f32_16x16x32_bf16 v[132:135], v[76:79], a[176:179], v[132:135]
    buffer_load_dwordx4 v[44:47], v3, s[8:11], s72 offen offset:3072 sc1
    s_add_u32 s72, s72, 7168
    v_mfma_f32_16x16x32_bf16 v[160:163], v[76:79], a[180:183], v[160:163]
    v_mfma_f32_16x16x32_bf16 v[188:191], v[76:79], a[184:187], v[188:191]
    v_mfma_f32_16x16x32_bf16 v[216:219], v[76:79], a[188:191], v[216:219]
    s_waitcnt vmcnt(13)
    v_mfma_f32_16x16x32_bf16 v[136:139], v[80:83], a[176:179], v[136:139]
    buffer_load_dwordx4 v[48:51], v3, s[8:11], s72 offen offset:0 sc1
    v_mfma_f32_16x16x32_bf16 v[164:167], v[80:83], a[180:183], v[164:167]
    v_mfma_f32_16x16x32_bf16 v[192:195], v[80:83], a[184:187], v[192:195]
    v_mfma_f32_16x16x32_bf16 v[220:223], v[80:83], a[188:191], v[220:223]
    s_waitcnt vmcnt(13)
    v_mfma_f32_16x16x32_bf16 v[140:143], v[84:87], a[176:179], v[140:143]
    buffer_load_dwordx4 v[52:55], v3, s[8:11], s72 offen offset:1024 sc1
    v_mfma_f32_16x16x32_bf16 v[168:171], v[84:87], a[180:183], v[168:171]
    v_mfma_f32_16x16x32_bf16 v[196:199], v[84:87], a[184:187], v[196:199]
    v_mfma_f32_16x16x32_bf16 v[224:227], v[84:87], a[188:191], v[224:227]
    s_waitcnt vmcnt(13)
    v_mfma_f32_16x16x32_bf16 v[128:131], v[88:91], a[192:195], v[128:131]
    buffer_load_dwordx4 v[56:59], v3, s[8:11], s72 offen offset:2048 sc1
    v_mfma_f32_16x16x32_bf16 v[156:159], v[88:91], a[196:199], v[156:159]
    v_mfma_f32_16x16x32_bf16 v[184:187], v[88:91], a[200:203], v[184:187]
    v_mfma_f32_16x16x32_bf16 v[212:215], v[88:91], a[204:207], v[212:215]
    s_waitcnt vmcnt(13)
    v_mfma_f32_16x16x32_bf16 v[132:135], v[92:95], a[192:195], v[132:135]
    buffer_load_dwordx4 v[64:67], v3, s[8:11], s72 offen offset:3072 sc1
    s_add_u32 s72, s72, 7168
    v_mfma_f32_16x16x32_bf16 v[160:163], v[92:95], a[196:199], v[160:163]
    v_mfma_f32_16x16x32_bf16 v[188:191], v[92:95], a[200:203], v[188:191]
    v_mfma_f32_16x16x32_bf16 v[216:219], v[92:95], a[204:207], v[216:219]
    s_waitcnt vmcnt(13)
    v_mfma_f32_16x16x32_bf16 v[136:139], v[96:99], a[192:195], v[136:139]
    buffer_load_dwordx4 v[68:71], v3, s[8:11], s73 offen offset:0 sc1
    v_mfma_f32_16x16x32_bf16 v[164:167], v[96:99], a[196:199], v[164:167]
    v_mfma_f32_16x16x32_bf16 v[192:195], v[96:99], a[200:203], v[192:195]
    v_mfma_f32_16x16x32_bf16 v[220:223], v[96:99], a[204:207], v[220:223]
    s_waitcnt vmcnt(13)
    v_mfma_f32_16x16x32_bf16 v[140:143], v[100:103], a[192:195], v[140:143]
    buffer_load_dwordx4 v[72:75], v3, s[8:11], s73 offen offset:1024 sc1
    v_mfma_f32_16x16x32_bf16 v[168:171], v[100:103], a[196:199], v[168:171]
    v_mfma_f32_16x16x32_bf16 v[196:199], v[100:103], a[200:203], v[196:199]
    v_mfma_f32_16x16x32_bf16 v[224:227], v[100:103], a[204:207], v[224:227]
    s_waitcnt vmcnt(13)
    v_mfma_f32_16x16x32_bf16 v[128:131], v[104:107], a[208:211], v[128:131]
    buffer_load_dwordx4 v[76:79], v3, s[8:11], s73 offen offset:2048 sc1
    s_add_u32 s73, s73, 7168
    v_mfma_f32_16x16x32_bf16 v[156:159], v[104:107], a[212:215], v[156:159]
    v_mfma_f32_16x16x32_bf16 v[184:187], v[104:107], a[216:219], v[184:187]
    v_mfma_f32_16x16x32_bf16 v[212:215], v[104:107], a[220:223], v[212:215]
    s_waitcnt vmcnt(13)
    v_mfma_f32_16x16x32_bf16 v[132:135], v[108:111], a[208:211], v[132:135]
    buffer_load_dwordx4 v[80:83], v3, s[8:11], s73 offen offset:0 sc1
    v_mfma_f32_16x16x32_bf16 v[160:163], v[108:111], a[212:215], v[160:163]
    v_mfma_f32_16x16x32_bf16 v[188:191], v[108:111], a[216:219], v[188:191]
    v_mfma_f32_16x16x32_bf16 v[216:219], v[108:111], a[220:223], v[216:219]
    s_waitcnt vmcnt(13)
    v_mfma_f32_16x16x32_bf16 v[136:139], v[112:115], a[208:211], v[136:139]
    buffer_load_dwordx4 v[84:87], v3, s[8:11], s73 offen offset:1024 sc1
    v_mfma_f32_16x16x32_bf16 v[164:167], v[112:115], a[212:215], v[164:167]
    v_mfma_f32_16x16x32_bf16 v[192:195], v[112:115], a[216:219], v[192:195]
    v_mfma_f32_16x16x32_bf16 v[220:223], v[112:115], a[220:223], v[220:223]
    s_waitcnt vmcnt(13)
    v_mfma_f32_16x16x32_bf16 v[140:143], v[116:119], a[208:211], v[140:143]
    buffer_load_dwordx4 v[88:91], v3, s[8:11], s73 offen offset:2048 sc1
    s_add_u32 s73, s73, 7168
    v_mfma_f32_16x16x32_bf16 v[168:171], v[116:119], a[212:215], v[168:171]
    v_mfma_f32_16x16x32_bf16 v[196:199], v[116:119], a[216:219], v[196:199]
    v_mfma_f32_16x16x32_bf16 v[224:227], v[116:119], a[220:223], v[224:227]
    s_waitcnt vmcnt(13)
    v_mfma_f32_16x16x32_bf16 v[128:131], v[32:35], a[224:227], v[128:131]
    buffer_load_dwordx4 v[92:95], v3, s[8:11], s73 offen offset:0 sc1
    v_mfma_f32_16x16x32_bf16 v[156:159], v[32:35], a[228:231], v[156:159]
    v_mfma_f32_16x16x32_bf16 v[184:187], v[32:35], a[232:235], v[184:187]
    v_mfma_f32_16x16x32_bf16 v[212:215], v[32:35], a[236:239], v[212:215]
    s_waitcnt vmcnt(13)
    v_mfma_f32_16x16x32_bf16 v[132:135], v[36:39], a[224:227], v[132:135]
    buffer_load_dwordx4 v[96:99], v3, s[8:11], s73 offen offset:1024 sc1
    v_mfma_f32_16x16x32_bf16 v[160:163], v[36:39], a[228:231], v[160:163]
    v_mfma_f32_16x16x32_bf16 v[188:191], v[36:39], a[232:235], v[188:191]
    v_mfma_f32_16x16x32_bf16 v[216:219], v[36:39], a[236:239], v[216:219]
    s_waitcnt vmcnt(13)
    v_mfma_f32_16x16x32_bf16 v[136:139], v[40:43], a[224:227], v[136:139]
    buffer_load_dwordx4 v[100:103], v3, s[8:11], s73 offen offset:2048 sc1
    s_add_u32 s73, s73, 7168
    v_mfma_f32_16x16x32_bf16 v[164:167], v[40:43], a[228:231], v[164:167]
    v_mfma_f32_16x16x32_bf16 v[192:195], v[40:43], a[232:235], v[192:195]
    v_mfma_f32_16x16x32_bf16 v[220:223], v[40:43], a[236:239], v[220:223]
    s_waitcnt vmcnt(13)
    v_mfma_f32_16x16x32_bf16 v[140:143], v[44:47], a[224:227], v[140:143]
    buffer_load_dwordx4 v[104:107], v3, s[8:11], s73 offen offset:0 sc1
    v_mfma_f32_16x16x32_bf16 v[168:171], v[44:47], a[228:231], v[168:171]
    v_mfma_f32_16x16x32_bf16 v[196:199], v[44:47], a[232:235], v[196:199]
    v_mfma_f32_16x16x32_bf16 v[224:227], v[44:47], a[236:239], v[224:227]
    s_waitcnt vmcnt(13)
    v_mfma_f32_16x16x32_bf16 v[128:131], v[48:51], a[240:243], v[128:131]
    buffer_load_dwordx4 v[108:111], v3, s[8:11], s73 offen offset:1024 sc1
    v_mfma_f32_16x16x32_bf16 v[156:159], v[48:51], a[244:247], v[156:159]
    v_mfma_f32_16x16x32_bf16 v[184:187], v[48:51], a[248:251], v[184:187]
    v_mfma_f32_16x16x32_bf16 v[212:215], v[48:51], a[252:255], v[212:215]
    s_waitcnt vmcnt(13)
    v_mfma_f32_16x16x32_bf16 v[132:135], v[52:55], a[240:243], v[132:135]
    buffer_load_dwordx4 v[112:115], v3, s[8:11], s73 offen offset:2048 sc1
    s_add_u32 s73, s73, 7168
    v_mfma_f32_16x16x32_bf16 v[160:163], v[52:55], a[244:247], v[160:163]
    v_mfma_f32_16x16x32_bf16 v[188:191], v[52:55], a[248:251], v[188:191]
    v_mfma_f32_16x16x32_bf16 v[216:219], v[52:55], a[252:255], v[216:219]
    s_waitcnt vmcnt(13)
    v_mfma_f32_16x16x32_bf16 v[136:139], v[56:59], a[240:243], v[136:139]
    buffer_load_dwordx4 v[116:119], v3, s[8:11], s73 offen offset:0 sc1
    v_mfma_f32_16x16x32_bf16 v[164:167], v[56:59], a[244:247], v[164:167]
    v_mfma_f32_16x16x32_bf16 v[192:195], v[56:59], a[248:251], v[192:195]
    v_mfma_f32_16x16x32_bf16 v[220:223], v[56:59], a[252:255], v[220:223]
    s_waitcnt vmcnt(13)
    v_mfma_f32_16x16x32_bf16 v[140:143], v[64:67], a[240:243], v[140:143]
    buffer_load_dwordx4 v[32:35], v3, s[8:11], s73 offen offset:1024 sc1
    v_mfma_f32_16x16x32_bf16 v[168:171], v[64:67], a[244:247], v[168:171]
    v_mfma_f32_16x16x32_bf16 v[196:199], v[64:67], a[248:251], v[196:199]
    v_mfma_f32_16x16x32_bf16 v[224:227], v[64:67], a[252:255], v[224:227]
    s_waitcnt vmcnt(13)
    v_mfma_f32_16x16x32_bf16 v[144:147], v[68:71], a[0:3], 0
    buffer_load_dwordx4 v[36:39], v3, s[8:11], s73 offen offset:2048 sc1
    s_add_u32 s73, s73, 7168
    v_mfma_f32_16x16x32_bf16 v[172:175], v[68:71], a[4:7], 0
    v_mfma_f32_16x16x32_bf16 v[200:203], v[68:71], a[8:11], 0
    v_mfma_f32_16x16x32_bf16 v[228:231], v[68:71], a[12:15], 0
    s_waitcnt vmcnt(13)
    v_mfma_f32_16x16x32_bf16 v[148:151], v[72:75], a[0:3], 0
    buffer_load_dwordx4 v[40:43], v3, s[8:11], s73 offen offset:0 sc1
    v_mfma_f32_16x16x32_bf16 v[176:179], v[72:75], a[4:7], 0
    ds_write_b128 v17, v[156:159] offset:0
    v_mfma_f32_16x16x32_bf16 v[204:207], v[72:75], a[8:11], 0
    v_mfma_f32_16x16x32_bf16 v[232:235], v[72:75], a[12:15], 0
    s_waitcnt vmcnt(13)
    v_mfma_f32_16x16x32_bf16 v[152:155], v[76:79], a[0:3], 0
    buffer_load_dwordx4 v[44:47], v3, s[8:11], s73 offen offset:1024 sc1
    v_mfma_f32_16x16x32_bf16 v[180:183], v[76:79], a[4:7], 0
    ds_write_b128 v17, v[160:163] offset:1024
    v_mfma_f32_16x16x32_bf16 v[208:211], v[76:79], a[8:11], 0
    v_mfma_f32_16x16x32_bf16 v[236:239], v[76:79], a[12:15], 0
    s_waitcnt vmcnt(13)
    v_mfma_f32_16x16x32_bf16 v[144:147], v[80:83], a[16:19], v[144:147]
    buffer_load_dwordx4 v[48:51], v3, s[8:11], s73 offen offset:2048 sc1
    s_add_u32 s73, s73, 7168
    v_mfma_f32_16x16x32_bf16 v[172:175], v[80:83], a[20:23], v[172:175]
    ds_write_b128 v17, v[164:167] offset:2048
    v_mfma_f32_16x16x32_bf16 v[200:203], v[80:83], a[24:27], v[200:203]
    v_mfma_f32_16x16x32_bf16 v[228:231], v[80:83], a[28:31], v[228:231]
    s_waitcnt vmcnt(13)
    v_mfma_f32_16x16x32_bf16 v[148:151], v[84:87], a[16:19], v[148:151]
    buffer_load_dwordx4 v[52:55], v3, s[8:11], s73 offen offset:0 sc1
    v_mfma_f32_16x16x32_bf16 v[176:179], v[84:87], a[20:23], v[176:179]
    ds_write_b128 v17, v[168:171] offset:3072
    v_mfma_f32_16x16x32_bf16 v[204:207], v[84:87], a[24:27], v[204:207]
    v_mfma_f32_16x16x32_bf16 v[232:235], v[84:87], a[28:31], v[232:235]
    s_waitcnt vmcnt(13)
    v_mfma_f32_16x16x32_bf16 v[152:155], v[88:91], a[16:19], v[152:155]
    buffer_load_dwordx4 v[56:59], v3, s[8:11], s73 offen offset:1024 sc1
    v_mfma_f32_16x16x32_bf16 v[180:183], v[88:91], a[20:23], v[180:183]
    ds_write_b128 v18, v[184:187] offset:0
    v_mfma_f32_16x16x32_bf16 v[208:211], v[88:91], a[24:27], v[208:211]
    v_mfma_f32_16x16x32_bf16 v[236:239], v[88:91], a[28:31], v[236:239]
    s_waitcnt vmcnt(13)
    v_mfma_f32_16x16x32_bf16 v[144:147], v[92:95], a[32:35], v[144:147]
    buffer_load_dwordx4 v[64:67], v3, s[8:11], s73 offen offset:2048 sc1
    s_add_u32 s73, s73, 7168
    v_mfma_f32_16x16x32_bf16 v[172:175], v[92:95], a[36:39], v[172:175]
    ds_write_b128 v18, v[188:191] offset:1024
    v_mfma_f32_16x16x32_bf16 v[200:203], v[92:95], a[40:43], v[200:203]
    v_mfma_f32_16x16x32_bf16 v[228:231], v[92:95], a[44:47], v[228:231]
    s_waitcnt vmcnt(13)
    v_mfma_f32_16x16x32_bf16 v[148:151], v[96:99], a[32:35], v[148:151]
    buffer_load_dwordx4 v[68:71], v3, s[8:11], s73 offen offset:0 sc1
    v_mfma_f32_16x16x32_bf16 v[176:179], v[96:99], a[36:39], v[176:179]
    ds_write_b128 v18, v[192:195] offset:2048
    v_mfma_f32_16x16x32_bf16 v[204:207], v[96:99], a[40:43], v[204:207]
    v_mfma_f32_16x16x32_bf16 v[232:235], v[96:99], a[44:47], v[232:235]
    s_waitcnt vmcnt(13)
    v_mfma_f32_16x16x32_bf16 v[152:155], v[100:103], a[32:35], v[152:155]
    buffer_load_dwordx4 v[72:75], v3, s[8:11], s73 offen offset:1024 sc1
    v_mfma_f32_16x16x32_bf16 v[180:183], v[100:103], a[36:39], v[180:183]
    ds_write_b128 v18, v[196:199] offset:3072
    v_mfma_f32_16x16x32_bf16 v[208:211], v[100:103], a[40:43], v[208:211]
    v_mfma_f32_16x16x32_bf16 v[236:239], v[100:103], a[44:47], v[236:239]
    s_waitcnt vmcnt(13)
    v_mfma_f32_16x16x32_bf16 v[144:147], v[104:107], a[48:51], v[144:147]
    buffer_load_dwordx4 v[76:79], v3, s[8:11], s73 offen offset:2048 sc1
    s_add_u32 s73, s73, 7168
    v_mfma_f32_16x16x32_bf16 v[172:175], v[104:107], a[52:55], v[172:175]
    ds_write_b128 v19, v[212:215] offset:0
    v_mfma_f32_16x16x32_bf16 v[200:203], v[104:107], a[56:59], v[200:203]
    v_mfma_f32_16x16x32_bf16 v[228:231], v[104:107], a[60:63], v[228:231]
    s_waitcnt vmcnt(13)
    v_mfma_f32_16x16x32_bf16 v[148:151], v[108:111], a[48:51], v[148:151]
    buffer_load_dwordx4 v[80:83], v3, s[8:11], s73 offen offset:0 sc1
    v_mfma_f32_16x16x32_bf16 v[176:179], v[108:111], a[52:55], v[176:179]
    ds_write_b128 v19, v[216:219] offset:1024
    v_mfma_f32_16x16x32_bf16 v[204:207], v[108:111], a[56:59], v[204:207]
    v_mfma_f32_16x16x32_bf16 v[232:235], v[108:111], a[60:63], v[232:235]
    s_waitcnt vmcnt(13)
    v_mfma_f32_16x16x32_bf16 v[152:155], v[112:115], a[48:51], v[152:155]
    buffer_load_dwordx4 v[84:87], v3, s[8:11], s73 offen offset:1024 sc1
    v_mfma_f32_16x16x32_bf16 v[180:183], v[112:115], a[52:55], v[180:183]
    ds_write_b128 v19, v[220:223] offset:2048
    v_mfma_f32_16x16x32_bf16 v[208:211], v[112:115], a[56:59], v[208:211]
    v_mfma_f32_16x16x32_bf16 v[236:239], v[112:115], a[60:63], v[236:239]
    s_waitcnt vmcnt(13)
    v_mfma_f32_16x16x32_bf16 v[144:147], v[116:119], a[64:67], v[144:147]
    buffer_load_dwordx4 v[88:91], v3, s[8:11], s73 offen offset:2048 sc1
    s_add_u32 s73, s73, 7168
    v_mfma_f32_16x16x32_bf16 v[172:175], v[116:119], a[68:71], v[172:175]
    ds_write_b128 v19, v[224:227] offset:3072
    v_mfma_f32_16x16x32_bf16 v[200:203], v[116:119], a[72:75], v[200:203]
    v_mfma_f32_16x16x32_bf16 v[228:231], v[116:119], a[76:79], v[228:231]
    s_waitcnt vmcnt(13)
    v_mfma_f32_16x16x32_bf16 v[148:151], v[32:35], a[64:67], v[148:151]
    buffer_load_dwordx4 v[92:95], v3, s[8:11], s73 offen offset:0 sc1
    v_mfma_f32_16x16x32_bf16 v[176:179], v[32:35], a[68:71], v[176:179]
    v_mfma_f32_16x16x32_bf16 v[204:207], v[32:35], a[72:75], v[204:207]
    v_mfma_f32_16x16x32_bf16 v[232:235], v[32:35], a[76:79], v[232:235]
    s_waitcnt lgkmcnt(0)
    s_barrier
    s_waitcnt vmcnt(13)
    v_mfma_f32_16x16x32_bf16 v[152:155], v[36:39], a[64:67], v[152:155]
    buffer_load_dwordx4 v[96:99], v3, s[8:11], s73 offen offset:1024 sc1
    v_mfma_f32_16x16x32_bf16 v[180:183], v[36:39], a[68:71], v[180:183]
    ds_read_b128 v[156:159], v20 offset:0
    v_mfma_f32_16x16x32_bf16 v[208:211], v[36:39], a[72:75], v[208:211]
    v_mfma_f32_16x16x32_bf16 v[236:239], v[36:39], a[76:79], v[236:239]
    s_waitcnt vmcnt(13)
    v_mfma_f32_16x16x32_bf16 v[144:147], v[40:43], a[80:83], v[144:147]
    buffer_load_dwordx4 v[100:103], v3, s[8:11], s73 offen offset:2048 sc1
    s_add_u32 s73, s73, 7168
    v_mfma_f32_16x16x32_bf16 v[172:175], v[40:43], a[84:87], v[172:175]
    ds_read_b128 v[184:187], v20 offset:4096
    v_mfma_f32_16x16x32_bf16 v[200:203], v[40:43], a[88:91], v[200:203]
    v_mfma_f32_16x16x32_bf16 v[228:231], v[40:43], a[92:95], v[228:231]
    s_waitcnt vmcnt(13)
    v_mfma_f32_16x16x32_bf16 v[148:151], v[44:47], a[80:83], v[148:151]
    buffer_load_dwordx4 v[104:107], v3, s[8:11], s73 offen offset:0 sc1
    v_mfma_f32_16x16x32_bf16 v[176:179], v[44:47], a[84:87], v[176:179]
    ds_read_b128 v[212:215], v20 offset:8192
    v_mfma_f32_16x16x32_bf16 v[204:207], v[44:47], a[88:91], v[204:207]
    v_mfma_f32_16x16x32_bf16 v[232:235], v[44:47], a[92:95], v[232:235]
    s_waitcnt vmcnt(13)
    v_mfma_f32_16x16x32_bf16 v[152:155], v[48:51], a[80:83], v[152:155]
    buffer_load_dwordx4 v[108:111], v3, s[8:11], s73 offen offset:1024 sc1
    v_mfma_f32_16x16x32_bf16 v[180:183], v[48:51], a[84:87], v[180:183]
    ds_read_b128 v[160:163], v20 offset:1024
    v_mfma_f32_16x16x32_bf16 v[208:211], v[48:51], a[88:91], v[208:211]
    v_mfma_f32_16x16x32_bf16 v[236:239], v[48:51], a[92:95], v[236:239]
    s_waitcnt vmcnt(13)
    v_mfma_f32_16x16x32_bf16 v[144:147], v[52:55], a[96:99], v[144:147]
    buffer_load_dwordx4 v[112:115], v3, s[8:11], s73 offen offset:2048 sc1
    s_add_u32 s73, s73, 7168
    v_mfma_f32_16x16x32_bf16 v[172:175], v[52:55], a[100:103], v[172:175]
    ds_read_b128 v[188:191], v20 offset:5120
    v_mfma_f32_16x16x32_bf16 v[200:203], v[52:55], a[104:107], v[200:203]
    v_mfma_f32_16x16x32_bf16 v[228:231], v[52:55], a[108:111], v[228:231]
    s_waitcnt vmcnt(13)
    v_mfma_f32_16x16x32_bf16 v[148:151], v[56:59], a[96:99], v[148:151]
    buffer_load_dwordx4 v[116:119], v3, s[8:11], s73 offen offset:0 sc1
    v_mfma_f32_16x16x32_bf16 v[176:179], v[56:59], a[100:103], v[176:179]
    ds_read_b128 v[216:219], v20 offset:9216
    v_mfma_f32_16x16x32_bf16 v[204:207], v[56:59], a[104:107], v[204:207]
    v_mfma_f32_16x16x32_bf16 v[232:235], v[56:59], a[108:111], v[232:235]
    s_waitcnt vmcnt(13)
    v_mfma_f32_16x16x32_bf16 v[152:155], v[64:67], a[96:99], v[152:155]
    buffer_load_dwordx4 v[32:35], v3, s[8:11], s73 offen offset:1024 sc1
    v_mfma_f32_16x16x32_bf16 v[180:183], v[64:67], a[100:103], v[180:183]
    ds_read_b128 v[164:167], v20 offset:2048
    v_mfma_f32_16x16x32_bf16 v[208:211], v[64:67], a[104:107], v[208:211]
    v_mfma_f32_16x16x32_bf16 v[236:239], v[64:67], a[108:111], v[236:239]
    s_waitcnt vmcnt(13)
    v_mfma_f32_16x16x32_bf16 v[144:147], v[68:71], a[112:115], v[144:147]
    buffer_load_dwordx4 v[36:39], v3, s[8:11], s73 offen offset:2048 sc1
    s_add_u32 s73, s73, 7168
    v_mfma_f32_16x16x32_bf16 v[172:175], v[68:71], a[116:119], v[172:175]
    ds_read_b128 v[192:195], v20 offset:6144
    v_mfma_f32_16x16x32_bf16 v[200:203], v[68:71], a[120:123], v[200:203]
    v_mfma_f32_16x16x32_bf16 v[228:231], v[68:71], a[124:127], v[228:231]
    s_waitcnt vmcnt(13)
    v_mfma_f32_16x16x32_bf16 v[148:151], v[72:75], a[112:115], v[148:151]
    buffer_load_dwordx4 v[40:43], v3, s[8:11], s73 offen offset:0 sc1
    v_mfma_f32_16x16x32_bf16 v[176:179], v[72:75], a[116:119], v[176:179]
    ds_read_b128 v[220:223], v20 offset:10240
    v_mfma_f32_16x16x32_bf16 v[204:207], v[72:75], a[120:123], v[204:207]
    v_mfma_f32_16x16x32_bf16 v[232:235], v[72:75], a[124:127], v[232:235]
    s_waitcnt vmcnt(13)
    v_mfma_f32_16x16x32_bf16 v[152:155], v[76:79], a[112:115], v[152:155]
    buffer_load_dwordx4 v[44:47], v3, s[8:11], s73 offen offset:1024 sc1
    v_mfma_f32_16x16x32_bf16 v[180:183], v[76:79], a[116:119], v[180:183]
    ds_read_b128 v[168:171], v20 offset:3072
    v_mfma_f32_16x16x32_bf16 v[208:211], v[76:79], a[120:123], v[208:211]
    v_mfma_f32_16x16x32_bf16 v[236:239], v[76:79], a[124:127], v[236:239]
    s_waitcnt vmcnt(13)
    v_mfma_f32_16x16x32_bf16 v[144:147], v[80:83], a[128:131], v[144:147]
    buffer_load_dwordx4 v[48:51], v3, s[8:11], s73 offen offset:2048 sc1
    s_add_u32 s73, s73, 7168
    v_mfma_f32_16x16x32_bf16 v[172:175], v[80:83], a[132:135], v[172:175]
    ds_read_b128 v[196:199], v20 offset:7168
    v_mfma_f32_16x16x32_bf16 v[200:203], v[80:83], a[136:139], v[200:203]
    v_mfma_f32_16x16x32_bf16 v[228:231], v[80:83], a[140:143], v[228:231]
    s_waitcnt vmcnt(13)
    v_mfma_f32_16x16x32_bf16 v[148:151], v[84:87], a[128:131], v[148:151]
    buffer_load_dwordx4 v[52:55], v3, s[8:11], s73 offen offset:0 sc1
    v_mfma_f32_16x16x32_bf16 v[176:179], v[84:87], a[132:135], v[176:179]
    ds_read_b128 v[224:227], v20 offset:11264
    v_mfma_f32_16x16x32_bf16 v[204:207], v[84:87], a[136:139], v[204:207]
    v_mfma_f32_16x16x32_bf16 v[232:235], v[84:87], a[140:143], v[232:235]
    s_waitcnt vmcnt(13)
    v_mfma_f32_16x16x32_bf16 v[152:155], v[88:91], a[128:131], v[152:155]
    buffer_load_dwordx4 v[56:59], v3, s[8:11], s73 offen offset:1024 sc1
    v_mfma_f32_16x16x32_bf16 v[180:183], v[88:91], a[132:135], v[180:183]
    v_mfma_f32_16x16x32_bf16 v[208:211], v[88:91], a[136:139], v[208:211]
    v_mfma_f32_16x16x32_bf16 v[236:239], v[88:91], a[140:143], v[236:239]
    s_waitcnt vmcnt(13)
    v_mfma_f32_16x16x32_bf16 v[144:147], v[92:95], a[144:147], v[144:147]
    buffer_load_dwordx4 v[64:67], v3, s[8:11], s73 offen offset:2048 sc1
    s_add_u32 s73, s73, 7168
    v_mfma_f32_16x16x32_bf16 v[172:175], v[92:95], a[148:151], v[172:175]
    v_mfma_f32_16x16x32_bf16 v[200:203], v[92:95], a[152:155], v[200:203]
    v_mfma_f32_16x16x32_bf16 v[228:231], v[92:95], a[156:159], v[228:231]
    s_waitcnt lgkmcnt(0)
    s_barrier
    s_waitcnt vmcnt(13)
    v_mfma_f32_16x16x32_bf16 v[148:151], v[96:99], a[144:147], v[148:151]
    buffer_load_dwordx4 v[68:71], v3, s[8:11], s73 offen offset:0 sc1
    v_mfma_f32_16x16x32_bf16 v[176:179], v[96:99], a[148:151], v[176:179]
    v_pk_add_f32 v[156:157], v[156:157], v[184:185]
    v_pk_add_f32 v[128:129], v[128:129], v[212:213]
    v_mfma_f32_16x16x32_bf16 v[204:207], v[96:99], a[152:155], v[204:207]
    v_pk_add_f32 v[158:159], v[158:159], v[186:187]
    v_pk_add_f32 v[130:131], v[130:131], v[214:215]
    v_mfma_f32_16x16x32_bf16 v[232:235], v[96:99], a[156:159], v[232:235]
    v_lshlrev_b32 v184, 16, v240
    v_and_b32 v185, 0xffff0000, v240
    s_waitcnt vmcnt(13)
    v_mfma_f32_16x16x32_bf16 v[152:155], v[100:103], a[144:147], v[152:155]
    buffer_load_dwordx4 v[72:75], v3, s[8:11], s73 offen offset:1024 sc1
    v_mfma_f32_16x16x32_bf16 v[180:183], v[100:103], a[148:151], v[180:183]
    v_lshlrev_b32 v186, 16, v241
    v_and_b32 v187, 0xffff0000, v241
    v_mfma_f32_16x16x32_bf16 v[208:211], v[100:103], a[152:155], v[208:211]
    v_pk_add_f32 v[156:157], v[156:157], v[16:17] op_sel_hi:[1,0]
    v_pk_add_f32 v[158:159], v[158:159], v[16:17] op_sel_hi:[1,0]
    v_mfma_f32_16x16x32_bf16 v[236:239], v[100:103], a[156:159], v[236:239]
    v_pk_add_f32 v[128:129], v[128:129], v[156:157]
    v_pk_add_f32 v[130:131], v[130:131], v[158:159]
    s_waitcnt vmcnt(13)
    v_mfma_f32_16x16x32_bf16 v[144:147], v[104:107], a[160:163], v[144:147]
    buffer_load_dwordx4 v[76:79], v3, s[8:11], s73 offen offset:2048 sc1
    s_add_u32 s73, s73, 7168
    v_mfma_f32_16x16x32_bf16 v[172:175], v[104:107], a[164:167], v[172:175]
    v_pk_mul_f32 v[128:129], v[128:129], v[184:185]
    v_pk_mul_f32 v[130:131], v[130:131], v[186:187]
    v_mfma_f32_16x16x32_bf16 v[200:203], v[104:107], a[168:171], v[200:203]
    v_cvt_pk_bf16_f32 v120, v128, v129
    v_cvt_pk_bf16_f32 v121, v130, v131
    v_mfma_f32_16x16x32_bf16 v[228:231], v[104:107], a[172:175], v[228:231]
    v_pk_add_f32 v[160:161], v[160:161], v[188:189]
    v_pk_add_f32 v[132:133], v[132:133], v[216:217]
    s_waitcnt vmcnt(13)
    v_mfma_f32_16x16x32_bf16 v[148:151], v[108:111], a[160:163], v[148:151]
    buffer_load_dwordx4 v[80:83], v3, s[8:11], s73 offen offset:0 sc1
    v_mfma_f32_16x16x32_bf16 v[176:179], v[108:111], a[164:167], v[176:179]
    v_pk_add_f32 v[162:163], v[162:163], v[190:191]
    v_pk_add_f32 v[134:135], v[134:135], v[218:219]
    v_mfma_f32_16x16x32_bf16 v[204:207], v[108:111], a[168:171], v[204:207]
    v_lshlrev_b32 v188, 16, v242
    v_and_b32 v189, 0xffff0000, v242
    v_mfma_f32_16x16x32_bf16 v[232:235], v[108:111], a[172:175], v[232:235]
    v_lshlrev_b32 v190, 16, v243
    v_and_b32 v191, 0xffff0000, v243
    s_waitcnt vmcnt(13)
    v_mfma_f32_16x16x32_bf16 v[152:155], v[112:115], a[160:163], v[152:155]
    buffer_load_dwordx4 v[84:87], v3, s[8:11], s73 offen offset:1024 sc1
    v_mfma_f32_16x16x32_bf16 v[180:183], v[112:115], a[164:167], v[180:183]
    v_pk_add_f32 v[160:161], v[160:161], v[16:17] op_sel_hi:[1,0]
    v_pk_add_f32 v[162:163], v[162:163], v[16:17] op_sel_hi:[1,0]
    v_mfma_f32_16x16x32_bf16 v[208:211], v[112:115], a[168:171], v[208:211]
    v_pk_add_f32 v[132:133], v[132:133], v[160:161]
    v_pk_add_f32 v[134:135], v[134:135], v[162:163]
    v_mfma_f32_16x16x32_bf16 v[236:239], v[112:115], a[172:175], v[236:239]
    v_pk_mul_f32 v[132:133], v[132:133], v[188:189]
    v_pk_mul_f32 v[134:135], v[134:135], v[190:191]
    s_waitcnt vmcnt(13)
    v_mfma_f32_16x16x32_bf16 v[144:147], v[116:119], a[176:179], v[144:147]
    buffer_load_dwordx4 v[88:91], v3, s[8:11], s73 offen offset:2048 sc1
    s_add_u32 s73, s73, 7168
    v_mfma_f32_16x16x32_bf16 v[172:175], v[116:119], a[180:183], v[172:175]
    v_cvt_pk_bf16_f32 v122, v132, v133
    v_cvt_pk_bf16_f32 v123, v134, v135
    v_mfma_f32_16x16x32_bf16 v[200:203], v[116:119], a[184:187], v[200:203]
    v_pk_add_f32 v[164:165], v[164:165], v[192:193]
    v_pk_add_f32 v[136:137], v[136:137], v[220:221]
    v_mfma_f32_16x16x32_bf16 v[228:231], v[116:119], a[188:191], v[228:231]
    v_pk_add_f32 v[166:167], v[166:167], v[194:195]
    v_pk_add_f32 v[138:139], v[138:139], v[222:223]
    s_waitcnt vmcnt(13)
    v_mfma_f32_16x16x32_bf16 v[148:151], v[32:35], a[176:179], v[148:151]
    v_mfma_f32_16x16x32_bf16 v[176:179], v[32:35], a[180:183], v[176:179]
    v_lshlrev_b32 v192, 16, v244
    v_and_b32 v193, 0xffff0000, v244
    v_mfma_f32_16x16x32_bf16 v[204:207], v[32:35], a[184:187], v[204:207]
    v_lshlrev_b32 v194, 16, v245
    v_and_b32 v195, 0xffff0000, v245
    v_mfma_f32_16x16x32_bf16 v[232:235], v[32:35], a[188:191], v[232:235]
    v_pk_add_f32 v[164:165], v[164:165], v[16:17] op_sel_hi:[1,0]
    v_pk_add_f32 v[166:167], v[166:167], v[16:17] op_sel_hi:[1,0]
    s_waitcnt vmcnt(12)
    v_mfma_f32_16x16x32_bf16 v[152:155], v[36:39], a[176:179], v[152:155]
    v_mfma_f32_16x16x32_bf16 v[180:183], v[36:39], a[180:183], v[180:183]
    v_pk_add_f32 v[136:137], v[136:137], v[164:165]
    v_pk_add_f32 v[138:139], v[138:139], v[166:167]
    v_mfma_f32_16x16x32_bf16 v[208:211], v[36:39], a[184:187], v[208:211]
    v_pk_mul_f32 v[136:137], v[136:137], v[192:193]
    v_pk_mul_f32 v[138:139], v[138:139], v[194:195]
    v_mfma_f32_16x16x32_bf16 v[236:239], v[36:39], a[188:191], v[236:239]
    v_cvt_pk_bf16_f32 v124, v136, v137
    v_cvt_pk_bf16_f32 v125, v138, v139
    s_waitcnt vmcnt(11)
    v_mfma_f32_16x16x32_bf16 v[144:147], v[40:43], a[192:195], v[144:147]
    v_mfma_f32_16x16x32_bf16 v[172:175], v[40:43], a[196:199], v[172:175]
    v_pk_add_f32 v[168:169], v[168:169], v[196:197]
    v_pk_add_f32 v[140:141], v[140:141], v[224:225]
    v_mfma_f32_16x16x32_bf16 v[200:203], v[40:43], a[200:203], v[200:203]
    v_pk_add_f32 v[170:171], v[170:171], v[198:199]
    v_pk_add_f32 v[142:143], v[142:143], v[226:227]
    v_mfma_f32_16x16x32_bf16 v[228:231], v[40:43], a[204:207], v[228:231]
    v_lshlrev_b32 v196, 16, v246
    v_and_b32 v197, 0xffff0000, v246
    s_waitcnt vmcnt(10)
    v_mfma_f32_16x16x32_bf16 v[148:151], v[44:47], a[192:195], v[148:151]
    v_mfma_f32_16x16x32_bf16 v[176:179], v[44:47], a[196:199], v[176:179]
    v_lshlrev_b32 v198, 16, v247
    v_and_b32 v199, 0xffff0000, v247
    v_mfma_f32_16x16x32_bf16 v[204:207], v[44:47], a[200:203], v[204:207]
    v_pk_add_f32 v[168:169], v[168:169], v[16:17] op_sel_hi:[1,0]
    v_pk_add_f32 v[170:171], v[170:171], v[16:17] op_sel_hi:[1,0]
    v_mfma_f32_16x16x32_bf16 v[232:235], v[44:47], a[204:207], v[232:235]
    v_pk_add_f32 v[140:141], v[140:141], v[168:169]
    v_pk_add_f32 v[142:143], v[142:143], v[170:171]
    s_waitcnt vmcnt(9)
    v_mfma_f32_16x16x32_bf16 v[152:155], v[48:51], a[192:195], v[152:155]
    v_mfma_f32_16x16x32_bf16 v[180:183], v[48:51], a[196:199], v[180:183]
    v_pk_mul_f32 v[140:141], v[140:141], v[196:197]
    v_pk_mul_f32 v[142:143], v[142:143], v[198:199]
    v_mfma_f32_16x16x32_bf16 v[208:211], v[48:51], a[200:203], v[208:211]
    v_cvt_pk_bf16_f32 v126, v140, v141
    v_cvt_pk_bf16_f32 v127, v142, v143
    v_mfma_f32_16x16x32_bf16 v[236:239], v[48:51], a[204:207], v[236:239]
    s_waitcnt vmcnt(8)
    v_mfma_f32_16x16x32_bf16 v[172:175], v[52:55], a[212:215], v[172:175]
    v_mfma_f32_16x16x32_bf16 v[200:203], v[52:55], a[216:219], v[200:203]
    v_mfma_f32_16x16x32_bf16 v[228:231], v[52:55], a[220:223], v[228:231]
    s_waitcnt vmcnt(7)
    v_mfma_f32_16x16x32_bf16 v[176:179], v[56:59], a[212:215], v[176:179]
    v_mfma_f32_16x16x32_bf16 v[204:207], v[56:59], a[216:219], v[204:207]
    v_mfma_f32_16x16x32_bf16 v[232:235], v[56:59], a[220:223], v[232:235]
    buffer_store_dwordx4 v[120:123], v3, s[8:11], s64 offen offset:0 sc1
    buffer_store_dwordx4 v[124:127], v3, s[8:11], s64 offen offset:1024 sc1
    s_waitcnt vmcnt(8)
    v_mfma_f32_16x16x32_bf16 v[180:183], v[64:67], a[212:215], v[180:183]
    v_mfma_f32_16x16x32_bf16 v[208:211], v[64:67], a[216:219], v[208:211]
    v_mfma_f32_16x16x32_bf16 v[236:239], v[64:67], a[220:223], v[236:239]
    s_waitcnt vmcnt(7)
    v_mfma_f32_16x16x32_bf16 v[172:175], v[68:71], a[228:231], v[172:175]
    v_mfma_f32_16x16x32_bf16 v[200:203], v[68:71], a[232:235], v[200:203]
    v_mfma_f32_16x16x32_bf16 v[228:231], v[68:71], a[236:239], v[228:231]
    s_waitcnt vmcnt(6)
    v_mfma_f32_16x16x32_bf16 v[176:179], v[72:75], a[228:231], v[176:179]
    v_mfma_f32_16x16x32_bf16 v[204:207], v[72:75], a[232:235], v[204:207]
    v_mfma_f32_16x16x32_bf16 v[232:235], v[72:75], a[236:239], v[232:235]
    s_waitcnt vmcnt(5)
    v_mfma_f32_16x16x32_bf16 v[180:183], v[76:79], a[228:231], v[180:183]
    v_mfma_f32_16x16x32_bf16 v[208:211], v[76:79], a[232:235], v[208:211]
    v_mfma_f32_16x16x32_bf16 v[236:239], v[76:79], a[236:239], v[236:239]
    s_waitcnt vmcnt(4)
    v_mfma_f32_16x16x32_bf16 v[172:175], v[80:83], a[244:247], v[172:175]
    v_mfma_f32_16x16x32_bf16 v[200:203], v[80:83], a[248:251], v[200:203]
    v_mfma_f32_16x16x32_bf16 v[228:231], v[80:83], a[252:255], v[228:231]
    s_waitcnt vmcnt(3)
    v_mfma_f32_16x16x32_bf16 v[176:179], v[84:87], a[244:247], v[176:179]
    v_mfma_f32_16x16x32_bf16 v[204:207], v[84:87], a[248:251], v[204:207]
    v_mfma_f32_16x16x32_bf16 v[232:235], v[84:87], a[252:255], v[232:235]
    s_waitcnt vmcnt(2)
    v_mfma_f32_16x16x32_bf16 v[180:183], v[88:91], a[244:247], v[180:183]
    v_mfma_f32_16x16x32_bf16 v[208:211], v[88:91], a[248:251], v[208:211]
    v_mfma_f32_16x16x32_bf16 v[236:239], v[88:91], a[252:255], v[236:239]
    ds_write_b128 v17, v[172:175] offset:0
    v_mfma_f32_16x16x32_bf16 v[144:147], v[52:55], a[208:211], v[144:147]
    ds_write_b128 v17, v[176:179] offset:1024
    v_mfma_f32_16x16x32_bf16 v[148:151], v[56:59], a[208:211], v[148:151]
    s_nop 1
    ds_write_b128 v17, v[180:183] offset:2048
    v_mfma_f32_16x16x32_bf16 v[152:155], v[64:67], a[208:211], v[152:155]
    ds_write_b128 v18, v[200:203] offset:0
    v_mfma_f32_16x16x32_bf16 v[144:147], v[68:71], a[224:227], v[144:147]
    ds_write_b128 v18, v[204:207] offset:1024
    v_mfma_f32_16x16x32_bf16 v[148:151], v[72:75], a[224:227], v[148:151]
    ds_write_b128 v18, v[208:211] offset:2048
    v_mfma_f32_16x16x32_bf16 v[152:155], v[76:79], a[224:227], v[152:155]
    ds_write_b128 v19, v[228:231] offset:0
    v_mfma_f32_16x16x32_bf16 v[144:147], v[80:83], a[240:243], v[144:147]
    ds_write_b128 v19, v[232:235] offset:1024
    v_mfma_f32_16x16x32_bf16 v[148:151], v[84:87], a[240:243], v[148:151]
    ds_write_b128 v19, v[236:239] offset:2048
    v_mfma_f32_16x16x32_bf16 v[152:155], v[88:91], a[240:243], v[152:155]
    s_waitcnt lgkmcnt(0)
    s_barrier
    ds_read_b128 v[172:175], v20 offset:0
    ds_read_b128 v[200:203], v20 offset:4096
    ds_read_b128 v[228:231], v20 offset:8192
    ds_read_b128 v[176:179], v20 offset:1024
    ds_read_b128 v[204:207], v20 offset:5120
    ds_read_b128 v[232:235], v20 offset:9216
    ds_read_b128 v[180:183], v20 offset:2048
    ds_read_b128 v[208:211], v20 offset:6144
    ds_read_b128 v[236:239], v20 offset:10240
    s_waitcnt lgkmcnt(6)
    v_pk_add_f32 v[172:173], v[172:173], v[200:201]
    v_pk_add_f32 v[144:145], v[144:145], v[228:229]
    v_pk_add_f32 v[174:175], v[174:175], v[202:203]
    v_pk_add_f32 v[146:147], v[146:147], v[230:231]
    v_lshlrev_b32 v200, 16, v248
    v_and_b32 v201, 0xffff0000, v248
    v_lshlrev_b32 v202, 16, v249
    v_and_b32 v203, 0xffff0000, v249
    v_pk_add_f32 v[172:173], v[172:173], v[16:17] op_sel_hi:[1,0]
    v_pk_add_f32 v[174:175], v[174:175], v[16:17] op_sel_hi:[1,0]
    v_pk_add_f32 v[144:145], v[144:145], v[172:173]
    v_pk_add_f32 v[146:147], v[146:147], v[174:175]
    v_pk_mul_f32 v[144:145], v[144:145], v[200:201]
    v_pk_mul_f32 v[146:147], v[146:147], v[202:203]
    v_cvt_pk_bf16_f32 v60, v144, v145
    v_cvt_pk_bf16_f32 v61, v146, v147
    s_waitcnt lgkmcnt(3)
    v_pk_add_f32 v[176:177], v[176:177], v[204:205]
    v_pk_add_f32 v[148:149], v[148:149], v[232:233]
    v_pk_add_f32 v[178:179], v[178:179], v[206:207]
    v_pk_add_f32 v[150:151], v[150:151], v[234:235]
    v_lshlrev_b32 v204, 16, v250
    v_and_b32 v205, 0xffff0000, v250
    v_lshlrev_b32 v206, 16, v251
    v_and_b32 v207, 0xffff0000, v251
    v_pk_add_f32 v[176:177], v[176:177], v[16:17] op_sel_hi:[1,0]
    v_pk_add_f32 v[178:179], v[178:179], v[16:17] op_sel_hi:[1,0]
    v_pk_add_f32 v[148:149], v[148:149], v[176:177]
    v_pk_add_f32 v[150:151], v[150:151], v[178:179]
    v_pk_mul_f32 v[148:149], v[148:149], v[204:205]
    v_pk_mul_f32 v[150:151], v[150:151], v[206:207]
    v_cvt_pk_bf16_f32 v62, v148, v149
    v_cvt_pk_bf16_f32 v63, v150, v151
    buffer_store_dwordx4 v[60:63], v3, s[8:11], s64 offen offset:2048 sc1
    s_waitcnt lgkmcnt(0)
    v_pk_add_f32 v[180:181], v[180:181], v[208:209]
    v_pk_add_f32 v[152:153], v[152:153], v[236:237]
    v_pk_add_f32 v[182:183], v[182:183], v[210:211]
    v_pk_add_f32 v[154:155], v[154:155], v[238:239]
    v_lshlrev_b32 v208, 16, v252
    v_and_b32 v209, 0xffff0000, v252
    v_lshlrev_b32 v210, 16, v253
    v_and_b32 v211, 0xffff0000, v253
    v_pk_add_f32 v[180:181], v[180:181], v[16:17] op_sel_hi:[1,0]
    v_pk_add_f32 v[182:183], v[182:183], v[16:17] op_sel_hi:[1,0]
    v_pk_add_f32 v[152:153], v[152:153], v[180:181]
    v_pk_add_f32 v[154:155], v[154:155], v[182:183]
    v_pk_mul_f32 v[152:153], v[152:153], v[208:209]
    v_pk_mul_f32 v[154:155], v[154:155], v[210:211]
    v_cvt_pk_bf16_f32 v24, v152, v153
    v_cvt_pk_bf16_f32 v25, v154, v155
    v_mov_b32 v26, v24
    v_mov_b32 v27, v25
    s_nop 0
    v_permlane16_swap_b32 v24, v26
    v_permlane16_swap_b32 v25, v27
    s_mov_b32 exec_lo, 0x0000ffff
    s_mov_b32 exec_hi, 0x0000ffff
    buffer_store_dwordx4 v[24:27], v6, s[8:11], s65 offen sc1
    s_mov_b64 exec, -1
    v_mov_b32 v4, 3
    s_waitcnt vmcnt(0)
    s_cmp_eq_u32 s50, 0
    s_cbranch_scc1 Lslow_41
    buffer_store_dword v4, v254, s[8:11], s54 offen
    s_branch Lpub_42
Lslow_41:
    buffer_store_dword v4, v254, s[8:11], s54 offen sc1
Lpub_42:
    v_add_u32 v25, 0xe000, v3
    v_add_u32 v26, 0xe000, v25
    s_barrier
    ds_read_b128 v[160:163], v3 offset:0
    ds_read_b128 v[164:167], v3 offset:1024
    ds_read_b128 v[168:171], v3 offset:2048
    ds_read_b128 v[172:175], v3 offset:3072
    ds_read_b128 v[176:179], v3 offset:4096
    ds_read_b128 v[180:183], v3 offset:5120
    ds_read_b128 v[184:187], v3 offset:6144
    ds_read_b128 v[188:191], v3 offset:7168
    s_waitcnt lgkmcnt(4)
    v_mfma_f32_16x16x32_bf16 v[144:147], v[160:163], v[120:123], 0
    ds_read_b128 v[232:235], v3 offset:8192
    v_mfma_f32_16x16x32_bf16 v[148:151], v[164:167], v[120:123], 0
    ds_read_b128 v[236:239], v3 offset:9216
    v_mfma_f32_16x16x32_bf16 v[152:155], v[168:171], v[120:123], 0
    ds_read_b128 v[240:243], v3 offset:10240
    v_mfma_f32_16x16x32_bf16 v[156:159], v[172:175], v[120:123], 0
    ds_read_b128 v[244:247], v3 offset:11264
    s_waitcnt lgkmcnt(4)
    v_mfma_f32_16x16x32_bf16 v[144:147], v[176:179], v[124:127], v[144:147]
    ds_read_b128 v[160:163], v3 offset:12288
    v_mfma_f32_16x16x32_bf16 v[148:151], v[180:183], v[124:127], v[148:151]
    ds_read_b128 v[164:167], v3 offset:13312
    v_mfma_f32_16x16x32_bf16 v[152:155], v[184:187], v[124:127], v[152:155]
    ds_read_b128 v[168:171], v3 offset:14336
    v_mfma_f32_16x16x32_bf16 v[156:159], v[188:191], v[124:127], v[156:159]
    ds_read_b128 v[172:175], v3 offset:15360
    s_waitcnt lgkmcnt(4)
    v_mfma_f32_16x16x32_bf16 v[144:147], v[232:235], v[60:63], v[144:147]
    ds_read_b128 v[176:179], v3 offset:16384
    v_mfma_f32_16x16x32_bf16 v[148:151], v[236:239], v[60:63], v[148:151]
    ds_read_b128 v[180:183], v3 offset:17408
    v_mfma_f32_16x16x32_bf16 v[152:155], v[240:243], v[60:63], v[152:155]
    ds_read_b128 v[184:187], v3 offset:18432
    v_mfma_f32_16x16x32_bf16 v[156:159], v[244:247], v[60:63], v[156:159]
    ds_read_b128 v[188:191], v3 offset:19456
    v_lshlrev_b32 v192, 16, v8
    v_and_b32 v193, 0xffff0000, v8
    v_lshlrev_b32 v194, 16, v9
    v_and_b32 v195, 0xffff0000, v9
    v_lshlrev_b32 v196, 16, v10
    v_and_b32 v197, 0xffff0000, v10
    v_lshlrev_b32 v198, 16, v11
    v_and_b32 v199, 0xffff0000, v11
    v_lshlrev_b32 v200, 16, v12
    v_and_b32 v201, 0xffff0000, v12
    v_lshlrev_b32 v202, 16, v13
    v_and_b32 v203, 0xffff0000, v13
    v_lshlrev_b32 v204, 16, v14
    v_and_b32 v205, 0xffff0000, v14
    v_lshlrev_b32 v206, 16, v15
    v_and_b32 v207, 0xffff0000, v15
    s_add_u32 s12, s40, s55
    s_addc_u32 s13, s41, 0
    s_sub_u32 s14, 2097152, s55
    s_mov_b32 s15, 0x20000
    v_lshlrev_b32 v7, 10, v1
    v_and_b32 v5, 1, v2
    v_lshl_add_u32 v7, v5, 5, v7
    v_lshrrev_b32 v5, 1, v2
    v_lshl_add_u32 v7, v5, 4, v7
    s_lshl_b32 s75, s47, 7
    s_add_u32 s3, s47, 1
    s_and_b32 s3, s3, 7
    s_mul_i32 s3, s3, 3072
    s_add_u32 s70, s3, s68
    s_add_u32 s3, s47, 2
    s_and_b32 s3, s3, 7
    s_mul_i32 s3, s3, 3072
    s_add_u32 s71, s3, s68
    s_add_u32 s3, s47, 3
    s_and_b32 s3, s3, 7
    s_mul_i32 s3, s3, 3072
    s_add_u32 s72, s3, s68
    s_add_u32 s3, s47, 4
    s_and_b32 s3, s3, 7
    s_mul_i32 s3, s3, 3072
    s_add_u32 s73, s3, s68
    s_add_u32 s3, s47, 5
    s_and_b32 s3, s3, 7
    s_mul_i32 s3, s3, 3072
    s_add_u32 s76, s3, s68
    s_add_u32 s3, s47, 6
    s_and_b32 s3, s3, 7
    s_mul_i32 s3, s3, 3072
    s_add_u32 s0, s3, s68
    s_add_u32 s3, s47, 7
    s_and_b32 s3, s3, 7
    s_mul_i32 s3, s3, 3072
    s_add_u32 s1, s3, s68
    s_add_u32 s64, s68, 24576
    s_lshl_b32 s74, s47, 8
    s_add_u32 s74, s74, 59392
    s_mov_b64 exec, 0xff
    s_mov_b32 s3, 0
Lpoll_43:
    s_add_u32 s3, s3, 1
    s_cmp_gt_u32 s3, 131072
    s_cbranch_scc1 Lpollx_44
    buffer_load_dword v4, v255, s[8:11], s54 offen sc1
    s_waitcnt vmcnt(0)
    v_cmp_gt_u32 vcc, 3, v4
    s_cbranch_vccnz Lpoll_43
Lpollx_44:
    s_mov_b64 exec, -1
    buffer_load_dwordx4 v[44:47], v3, s[8:11], s70 offen offset:0 sc1
    buffer_load_dwordx4 v[48:51], v3, s[8:11], s70 offen offset:1024 sc1
    buffer_load_dwordx4 v[52:55], v3, s[8:11], s70 offen offset:2048 sc1
    buffer_load_dwordx4 v[56:59], v3, s[8:11], s71 offen offset:0 sc1
    buffer_load_dwordx4 v[60:63], v3, s[8:11], s71 offen offset:1024 sc1
    buffer_load_dwordx4 v[64:67], v3, s[8:11], s71 offen offset:2048 sc1
    buffer_load_dwordx4 v[68:71], v3, s[8:11], s72 offen offset:0 sc1
    buffer_load_dwordx4 v[72:75], v3, s[8:11], s72 offen offset:1024 sc1
    s_waitcnt vmcnt(7) lgkmcnt(4)
    v_mfma_f32_16x16x32_bf16 v[144:147], v[160:163], v[44:47], v[144:147]
    buffer_load_dwordx4 v[76:79], v3, s[8:11], s72 offen offset:2048 sc1
    ds_read_b128 v[232:235], v3 offset:20480
    v_mfma_f32_16x16x32_bf16 v[148:151], v[164:167], v[44:47], v[148:151]
    ds_read_b128 v[236:239], v3 offset:21504
    v_mfma_f32_16x16x32_bf16 v[152:155], v[168:171], v[44:47], v[152:155]
    ds_read_b128 v[240:243], v3 offset:22528
    v_mfma_f32_16x16x32_bf16 v[156:159], v[172:175], v[44:47], v[156:159]
    ds_read_b128 v[244:247], v3 offset:23552
    s_waitcnt vmcnt(7) lgkmcnt(4)
    v_mfma_f32_16x16x32_bf16 v[144:147], v[176:179], v[48:51], v[144:147]
    buffer_load_dwordx4 v[80:83], v3, s[8:11], s73 offen offset:0 sc1
    ds_read_b128 v[160:163], v3 offset:24576
    v_mfma_f32_16x16x32_bf16 v[148:151], v[180:183], v[48:51], v[148:151]
    ds_read_b128 v[164:167], v3 offset:25600
    v_mfma_f32_16x16x32_bf16 v[152:155], v[184:187], v[48:51], v[152:155]
    ds_read_b128 v[168:171], v3 offset:26624
    v_mfma_f32_16x16x32_bf16 v[156:159], v[188:191], v[48:51], v[156:159]
    ds_read_b128 v[172:175], v3 offset:27648
    s_waitcnt vmcnt(7) lgkmcnt(4)
    v_mfma_f32_16x16x32_bf16 v[144:147], v[232:235], v[52:55], v[144:147]
    buffer_load_dwordx4 v[84:87], v3, s[8:11], s73 offen offset:1024 sc1
    ds_read_b128 v[176:179], v3 offset:28672
    v_mfma_f32_16x16x32_bf16 v[148:151], v[236:239], v[52:55], v[148:151]
    ds_read_b128 v[180:183], v3 offset:29696
    v_mfma_f32_16x16x32_bf16 v[152:155], v[240:243], v[52:55], v[152:155]
    ds_read_b128 v[184:187], v3 offset:30720
    v_mfma_f32_16x16x32_bf16 v[156:159], v[244:247], v[52:55], v[156:159]
    ds_read_b128 v[188:191], v3 offset:31744
    s_waitcnt vmcnt(7) lgkmcnt(4)
    v_mfma_f32_16x16x32_bf16 v[144:147], v[160:163], v[56:59], v[144:147]
    buffer_load_dwordx4 v[88:91], v3, s[8:11], s73 offen offset:2048 sc1
    ds_read_b128 v[232:235], v3 offset:32768
    v_mfma_f32_16x16x32_bf16 v[148:151], v[164:167], v[56:59], v[148:151]
    ds_read_b128 v[236:239], v3 offset:33792
    v_mfma_f32_16x16x32_bf16 v[152:155], v[168:171], v[56:59], v[152:155]
    ds_read_b128 v[240:243], v3 offset:34816
    v_mfma_f32_16x16x32_bf16 v[156:159], v[172:175], v[56:59], v[156:159]
    ds_read_b128 v[244:247], v3 offset:35840
    s_waitcnt vmcnt(7) lgkmcnt(4)
    v_mfma_f32_16x16x32_bf16 v[144:147], v[176:179], v[60:63], v[144:147]
    buffer_load_dwordx4 v[92:95], v3, s[8:11], s76 offen offset:0 sc1
    ds_read_b128 v[160:163], v3 offset:36864
    v_mfma_f32_16x16x32_bf16 v[148:151], v[180:183], v[60:63], v[148:151]
    ds_read_b128 v[164:167], v3 offset:37888
    v_mfma_f32_16x16x32_bf16 v[152:155], v[184:187], v[60:63], v[152:155]
    ds_read_b128 v[168:171], v3 offset:38912
    v_mfma_f32_16x16x32_bf16 v[156:159], v[188:191], v[60:63], v[156:159]
    ds_read_b128 v[172:175], v3 offset:39936
    s_waitcnt vmcnt(7) lgkmcnt(4)
    v_mfma_f32_16x16x32_bf16 v[144:147], v[232:235], v[64:67], v[144:147]
    buffer_load_dwordx4 v[96:99], v3, s[8:11], s76 offen offset:1024 sc1
    ds_read_b128 v[176:179], v3 offset:40960
    v_mfma_f32_16x16x32_bf16 v[148:151], v[236:239], v[64:67], v[148:151]
    ds_read_b128 v[180:183], v3 offset:41984
    v_mfma_f32_16x16x32_bf16 v[152:155], v[240:243], v[64:67], v[152:155]
    ds_read_b128 v[184:187], v3 offset:43008
    v_mfma_f32_16x16x32_bf16 v[156:159], v[244:247], v[64:67], v[156:159]
    ds_read_b128 v[188:191], v3 offset:44032
    s_waitcnt vmcnt(7) lgkmcnt(4)
    v_mfma_f32_16x16x32_bf16 v[144:147], v[160:163], v[68:71], v[144:147]
    buffer_load_dwordx4 v[100:103], v3, s[8:11], s76 offen offset:2048 sc1
    ds_read_b128 v[232:235], v3 offset:45056
    v_mfma_f32_16x16x32_bf16 v[148:151], v[164:167], v[68:71], v[148:151]
    ds_read_b128 v[236:239], v3 offset:46080
    v_mfma_f32_16x16x32_bf16 v[152:155], v[168:171], v[68:71], v[152:155]
    ds_read_b128 v[240:243], v3 offset:47104
    v_mfma_f32_16x16x32_bf16 v[156:159], v[172:175], v[68:71], v[156:159]
    ds_read_b128 v[244:247], v3 offset:48128
    s_waitcnt vmcnt(7) lgkmcnt(4)
    v_mfma_f32_16x16x32_bf16 v[144:147], v[176:179], v[72:75], v[144:147]
    buffer_load_dwordx4 v[104:107], v3, s[8:11], s0 offen offset:0 sc1
    ds_read_b128 v[160:163], v3 offset:49152
    v_mfma_f32_16x16x32_bf16 v[148:151], v[180:183], v[72:75], v[148:151]
    ds_read_b128 v[164:167], v3 offset:50176
    v_mfma_f32_16x16x32_bf16 v[152:155], v[184:187], v[72:75], v[152:155]
    ds_read_b128 v[168:171], v3 offset:51200
    v_mfma_f32_16x16x32_bf16 v[156:159], v[188:191], v[72:75], v[156:159]
    ds_read_b128 v[172:175], v3 offset:52224
    s_waitcnt vmcnt(7) lgkmcnt(4)
    v_mfma_f32_16x16x32_bf16 v[144:147], v[232:235], v[76:79], v[144:147]
    buffer_load_dwordx4 v[108:111], v3, s[8:11], s0 offen offset:1024 sc1
    ds_read_b128 v[176:179], v3 offset:53248
    v_mfma_f32_16x16x32_bf16 v[148:151], v[236:239], v[76:79], v[148:151]
    ds_read_b128 v[180:183], v3 offset:54272
    v_mfma_f32_16x16x32_bf16 v[152:155], v[240:243], v[76:79], v[152:155]
    ds_read_b128 v[184:187], v3 offset:55296
    v_mfma_f32_16x16x32_bf16 v[156:159], v[244:247], v[76:79], v[156:159]
    ds_read_b128 v[188:191], v3 offset:56320
    s_waitcnt vmcnt(7) lgkmcnt(4)
    v_mfma_f32_16x16x32_bf16 v[144:147], v[160:163], v[80:83], v[144:147]
    buffer_load_dwordx4 v[112:115], v3, s[8:11], s0 offen offset:2048 sc1
    ds_read_b128 v[232:235], v25 offset:0
    v_mfma_f32_16x16x32_bf16 v[148:151], v[164:167], v[80:83], v[148:151]
    ds_read_b128 v[236:239], v25 offset:1024
    v_mfma_f32_16x16x32_bf16 v[152:155], v[168:171], v[80:83], v[152:155]
    ds_read_b128 v[240:243], v25 offset:2048
    v_mfma_f32_16x16x32_bf16 v[156:159], v[172:175], v[80:83], v[156:159]
    ds_read_b128 v[244:247], v25 offset:3072
    s_waitcnt vmcnt(7) lgkmcnt(4)
    v_mfma_f32_16x16x32_bf16 v[144:147], v[176:179], v[84:87], v[144:147]
    buffer_load_dwordx4 v[116:119], v3, s[8:11], s1 offen offset:0 sc1
    ds_read_b128 v[160:163], v25 offset:4096
    v_mfma_f32_16x16x32_bf16 v[148:151], v[180:183], v[84:87], v[148:151]
    ds_read_b128 v[164:167], v25 offset:5120
    v_mfma_f32_16x16x32_bf16 v[152:155], v[184:187], v[84:87], v[152:155]
    ds_read_b128 v[168:171], v25 offset:6144
    v_mfma_f32_16x16x32_bf16 v[156:159], v[188:191], v[84:87], v[156:159]
    ds_read_b128 v[172:175], v25 offset:7168
    s_waitcnt vmcnt(7) lgkmcnt(4)
    v_mfma_f32_16x16x32_bf16 v[144:147], v[232:235], v[88:91], v[144:147]
    buffer_load_dwordx4 v[120:123], v3, s[8:11], s1 offen offset:1024 sc1
    ds_read_b128 v[176:179], v25 offset:8192
    v_mfma_f32_16x16x32_bf16 v[148:151], v[236:239], v[88:91], v[148:151]
    ds_read_b128 v[180:183], v25 offset:9216
    v_mfma_f32_16x16x32_bf16 v[152:155], v[240:243], v[88:91], v[152:155]
    ds_read_b128 v[184:187], v25 offset:10240
    v_mfma_f32_16x16x32_bf16 v[156:159], v[244:247], v[88:91], v[156:159]
    ds_read_b128 v[188:191], v25 offset:11264
    s_waitcnt vmcnt(7) lgkmcnt(4)
    v_mfma_f32_16x16x32_bf16 v[144:147], v[160:163], v[92:95], v[144:147]
    buffer_load_dwordx4 v[124:127], v3, s[8:11], s1 offen offset:2048 sc1
    ds_read_b128 v[232:235], v25 offset:12288
    v_mfma_f32_16x16x32_bf16 v[148:151], v[164:167], v[92:95], v[148:151]
    ds_read_b128 v[236:239], v25 offset:13312
    v_mfma_f32_16x16x32_bf16 v[152:155], v[168:171], v[92:95], v[152:155]
    ds_read_b128 v[240:243], v25 offset:14336
    v_mfma_f32_16x16x32_bf16 v[156:159], v[172:175], v[92:95], v[156:159]
    ds_read_b128 v[244:247], v25 offset:15360
    s_waitcnt vmcnt(7) lgkmcnt(4)
    v_mfma_f32_16x16x32_bf16 v[144:147], v[176:179], v[96:99], v[144:147]
    buffer_load_dwordx4 v[128:131], v3, s[8:11], s64 offen offset:0 sc1
    ds_read_b128 v[160:163], v25 offset:16384
    v_mfma_f32_16x16x32_bf16 v[148:151], v[180:183], v[96:99], v[148:151]
    ds_read_b128 v[164:167], v25 offset:17408
    v_mfma_f32_16x16x32_bf16 v[152:155], v[184:187], v[96:99], v[152:155]
    ds_read_b128 v[168:171], v25 offset:18432
    v_mfma_f32_16x16x32_bf16 v[156:159], v[188:191], v[96:99], v[156:159]
    ds_read_b128 v[172:175], v25 offset:19456
    s_waitcnt vmcnt(7) lgkmcnt(4)
    v_mfma_f32_16x16x32_bf16 v[144:147], v[232:235], v[100:103], v[144:147]
    buffer_load_dwordx4 v[132:135], v3, s[8:11], s64 offen offset:1024 sc1
    ds_read_b128 v[176:179], v25 offset:20480
    v_mfma_f32_16x16x32_bf16 v[148:151], v[236:239], v[100:103], v[148:151]
    ds_read_b128 v[180:183], v25 offset:21504
    v_mfma_f32_16x16x32_bf16 v[152:155], v[240:243], v[100:103], v[152:155]
    ds_read_b128 v[184:187], v25 offset:22528
    v_mfma_f32_16x16x32_bf16 v[156:159], v[244:247], v[100:103], v[156:159]
    ds_read_b128 v[188:191], v25 offset:23552
    s_waitcnt vmcnt(7) lgkmcnt(4)
    v_mfma_f32_16x16x32_bf16 v[144:147], v[160:163], v[104:107], v[144:147]
    buffer_load_dwordx4 v[136:139], v3, s[8:11], s64 offen offset:2048 sc1
    ds_read_b128 v[232:235], v25 offset:24576
    v_mfma_f32_16x16x32_bf16 v[148:151], v[164:167], v[104:107], v[148:151]
    ds_read_b128 v[236:239], v25 offset:25600
    v_mfma_f32_16x16x32_bf16 v[152:155], v[168:171], v[104:107], v[152:155]
    ds_read_b128 v[240:243], v25 offset:26624
    v_mfma_f32_16x16x32_bf16 v[156:159], v[172:175], v[104:107], v[156:159]
    ds_read_b128 v[244:247], v25 offset:27648
    s_waitcnt vmcnt(7) lgkmcnt(4)
    v_mfma_f32_16x16x32_bf16 v[144:147], v[176:179], v[108:111], v[144:147]
    buffer_load_dwordx4 v[140:143], v3, s[8:11], s64 offen offset:3072 sc1
    ds_read_b128 v[160:163], v25 offset:28672
    v_mfma_f32_16x16x32_bf16 v[148:151], v[180:183], v[108:111], v[148:151]
    ds_read_b128 v[164:167], v25 offset:29696
    v_mfma_f32_16x16x32_bf16 v[152:155], v[184:187], v[108:111], v[152:155]
    ds_read_b128 v[168:171], v25 offset:30720
    v_mfma_f32_16x16x32_bf16 v[156:159], v[188:191], v[108:111], v[156:159]
    ds_read_b128 v[172:175], v25 offset:31744
    s_waitcnt vmcnt(7) lgkmcnt(4)
    v_mfma_f32_16x16x32_bf16 v[144:147], v[232:235], v[112:115], v[144:147]
    buffer_load_dwordx4 v[216:219], v31, s[8:11], s74 offen offset:0 sc1
    ds_read_b128 v[176:179], v25 offset:32768
    v_mfma_f32_16x16x32_bf16 v[148:151], v[236:239], v[112:115], v[148:151]
    ds_read_b128 v[180:183], v25 offset:33792
    v_mfma_f32_16x16x32_bf16 v[152:155], v[240:243], v[112:115], v[152:155]
    ds_read_b128 v[184:187], v25 offset:34816
    v_mfma_f32_16x16x32_bf16 v[156:159], v[244:247], v[112:115], v[156:159]
    ds_read_b128 v[188:191], v25 offset:35840
    s_waitcnt vmcnt(7) lgkmcnt(4)
    v_mfma_f32_16x16x32_bf16 v[144:147], v[160:163], v[116:119], v[144:147]
    buffer_load_dwordx4 v[220:223], v31, s[8:11], s74 offen offset:64 sc1
    ds_read_b128 v[232:235], v25 offset:36864
    v_mfma_f32_16x16x32_bf16 v[148:151], v[164:167], v[116:119], v[148:151]
    ds_read_b128 v[236:239], v25 offset:37888
    v_mfma_f32_16x16x32_bf16 v[152:155], v[168:171], v[116:119], v[152:155]
    ds_read_b128 v[240:243], v25 offset:38912
    v_mfma_f32_16x16x32_bf16 v[156:159], v[172:175], v[116:119], v[156:159]
    ds_read_b128 v[244:247], v25 offset:39936
    s_waitcnt vmcnt(7) lgkmcnt(4)
    v_mfma_f32_16x16x32_bf16 v[144:147], v[176:179], v[120:123], v[144:147]
    buffer_load_dwordx4 v[224:227], v31, s[8:11], s74 offen offset:128 sc1
    ds_read_b128 v[160:163], v25 offset:40960
    v_mfma_f32_16x16x32_bf16 v[148:151], v[180:183], v[120:123], v[148:151]
    ds_read_b128 v[164:167], v25 offset:41984
    v_mfma_f32_16x16x32_bf16 v[152:155], v[184:187], v[120:123], v[152:155]
    ds_read_b128 v[168:171], v25 offset:43008
    v_mfma_f32_16x16x32_bf16 v[156:159], v[188:191], v[120:123], v[156:159]
    ds_read_b128 v[172:175], v25 offset:44032
    s_waitcnt vmcnt(7) lgkmcnt(4)
    v_mfma_f32_16x16x32_bf16 v[144:147], v[232:235], v[124:127], v[144:147]
    buffer_load_dwordx4 v[228:231], v31, s[8:11], s74 offen offset:192 sc1
    ds_read_b128 v[176:179], v25 offset:45056
    v_mfma_f32_16x16x32_bf16 v[148:151], v[236:239], v[124:127], v[148:151]
    ds_read_b128 v[180:183], v25 offset:46080
    v_mfma_f32_16x16x32_bf16 v[152:155], v[240:243], v[124:127], v[152:155]
    ds_read_b128 v[184:187], v25 offset:47104
    v_mfma_f32_16x16x32_bf16 v[156:159], v[244:247], v[124:127], v[156:159]
    ds_read_b128 v[188:191], v25 offset:48128
    s_waitcnt vmcnt(7) lgkmcnt(4)
    v_mfma_f32_16x16x32_bf16 v[144:147], v[160:163], v[128:131], v[144:147]
    ds_read_b128 v[232:235], v25 offset:49152
    v_mfma_f32_16x16x32_bf16 v[148:151], v[164:167], v[128:131], v[148:151]
    ds_read_b128 v[236:239], v25 offset:50176
    v_mfma_f32_16x16x32_bf16 v[152:155], v[168:171], v[128:131], v[152:155]
    ds_read_b128 v[240:243], v25 offset:51200
    v_mfma_f32_16x16x32_bf16 v[156:159], v[172:175], v[128:131], v[156:159]
    ds_read_b128 v[244:247], v25 offset:52224
    s_waitcnt vmcnt(6) lgkmcnt(4)
    v_mfma_f32_16x16x32_bf16 v[144:147], v[176:179], v[132:135], v[144:147]
    ds_read_b128 v[160:163], v25 offset:53248
    v_mfma_f32_16x16x32_bf16 v[148:151], v[180:183], v[132:135], v[148:151]
    ds_read_b128 v[164:167], v25 offset:54272
    v_mfma_f32_16x16x32_bf16 v[152:155], v[184:187], v[132:135], v[152:155]
    ds_read_b128 v[168:171], v25 offset:55296
    v_mfma_f32_16x16x32_bf16 v[156:159], v[188:191], v[132:135], v[156:159]
    ds_read_b128 v[172:175], v25 offset:56320
    s_waitcnt vmcnt(5) lgkmcnt(4)
    v_mfma_f32_16x16x32_bf16 v[144:147], v[232:235], v[136:139], v[144:147]
    v_mfma_f32_16x16x32_bf16 v[148:151], v[236:239], v[136:139], v[148:151]
    v_mfma_f32_16x16x32_bf16 v[152:155], v[240:243], v[136:139], v[152:155]
    v_mfma_f32_16x16x32_bf16 v[156:159], v[244:247], v[136:139], v[156:159]
    s_waitcnt vmcnt(4) lgkmcnt(0)
    v_mfma_f32_16x16x32_bf16 v[144:147], v[160:163], v[140:143], v[144:147]
    v_mfma_f32_16x16x32_bf16 v[148:151], v[164:167], v[140:143], v[148:151]
    v_mfma_f32_16x16x32_bf16 v[152:155], v[168:171], v[140:143], v[152:155]
    v_mfma_f32_16x16x32_bf16 v[156:159], v[172:175], v[140:143], v[156:159]
    s_waitcnt vmcnt(0)
    s_nop 3
    v_pk_fma_f32 v[192:193], v[144:145], v[216:217], v[192:193]
    v_pk_fma_f32 v[194:195], v[146:147], v[218:219], v[194:195]
    v_pk_fma_f32 v[196:197], v[148:149], v[220:221], v[196:197]
    v_pk_fma_f32 v[198:199], v[150:151], v[222:223], v[198:199]
    v_pk_fma_f32 v[200:201], v[152:153], v[224:225], v[200:201]
    v_pk_fma_f32 v[202:203], v[154:155], v[226:227], v[202:203]
    v_pk_fma_f32 v[204:205], v[156:157], v[228:229], v[204:205]
    v_pk_fma_f32 v[206:207], v[158:159], v[230:231], v[206:207]
    v_cvt_pk_bf16_f32 v48, v192, v193
    v_cvt_pk_bf16_f32 v49, v194, v195
    v_cvt_pk_bf16_f32 v50, v196, v197
    v_cvt_pk_bf16_f32 v51, v198, v199
    v_cvt_pk_bf16_f32 v52, v200, v201
    v_cvt_pk_bf16_f32 v53, v202, v203
    v_cvt_pk_bf16_f32 v54, v204, v205
    v_cvt_pk_bf16_f32 v55, v206, v207
    v_permlane16_swap_b32 v48, v50
    v_permlane16_swap_b32 v49, v51
    v_permlane16_swap_b32 v52, v54
    v_permlane16_swap_b32 v53, v55
    buffer_store_dwordx4 v[48:51], v7, s[12:15], s75 offen offset:0 sc1
    buffer_store_dwordx4 v[52:55], v7, s[12:15], s75 offen offset:64 sc1
    s_endpgm
L_qwait:
    s_mov_b64 exec, 3
    s_mov_b32 s3, 0
Lpoll_45:
    s_add_u32 s3, s3, 1
    s_cmp_gt_u32 s3, 131072
    s_cbranch_scc1 Lpollx_46
    s_sleep 4
    buffer_load_dword v252, v29, s[8:11], s27 offen sc1
    s_waitcnt vmcnt(0)
    v_cmp_gt_u32 vcc, 32, v252
    s_cbranch_vccnz Lpoll_45
Lpollx_46:
    s_mov_b64 exec, -1
    s_branch L_qok
L_pwait:
    s_mov_b64 exec, 15
    s_mov_b32 s3, 0
Lpoll_47:
    s_add_u32 s3, s3, 1
    s_cmp_gt_u32 s3, 131072
    s_cbranch_scc1 Lpollx_48
    s_sleep 8
    buffer_load_dword v201, v174, s[8:11], s27 offen sc1
    s_waitcnt vmcnt(0)
    v_cmp_gt_u32 vcc, 32, v201
    s_cbranch_vccnz Lpoll_47
Lpollx_48:
    s_mov_b64 exec, -1
    s_branch L_pok
L_gwait:
    s_mov_b64 exec, 0xffffffff
    s_mov_b32 s3, 0
Lpoll_49:
    s_add_u32 s3, s3, 1
    s_cmp_gt_u32 s3, 131072
    s_cbranch_scc1 Lpollx_50
    s_sleep 8
    buffer_load_dword v201, v196, s[8:11], s38 offen sc1
    s_waitcnt vmcnt(0)
    v_cmp_gt_u32 vcc, 32, v201
    s_cbranch_vccnz Lpoll_49
Lpollx_50:
    s_mov_b64 exec, -1
    s_branch L_gok
Lfb_25:
    v_lshrrev_b32 v4, 5, v0
    v_mul_u32_u24 v4, 272, v4
    v_and_b32 v5, 31, v0
    v_lshl_add_u32 v27, v5, 4, v4
    v_mov_b32 v4, 0xff800000
    v_mov_b32 v5, 0xff800000
    s_mov_b32 s64, 262144
L_fb1:
    buffer_load_dwordx4 v[144:147], v3, s[8:11], s64 offen offset:1088 sc1
    s_waitcnt vmcnt(0)
    v_mfma_f32_32x32x16_bf16 v[32:47], v[144:147], v[16:19], 0
    v_mfma_f32_32x32x16_bf16 v[48:63], v[144:147], v[20:23], 0
    s_nop 10
    v_max3_f32 v4, v32, v33, v4
    v_max3_f32 v5, v48, v49, v5
    v_max3_f32 v4, v34, v35, v4
    v_max3_f32 v5, v50, v51, v5
    v_max3_f32 v4, v36, v37, v4
    v_max3_f32 v5, v52, v53, v5
    v_max3_f32 v4, v38, v39, v4
    v_max3_f32 v5, v54, v55, v5
    v_max3_f32 v4, v40, v41, v4
    v_max3_f32 v5, v56, v57, v5
    v_max3_f32 v4, v42, v43, v4
    v_max3_f32 v5, v58, v59, v5
    v_max3_f32 v4, v44, v45, v4
    v_max3_f32 v5, v60, v61, v5
    v_max3_f32 v4, v46, v47, v4
    v_max3_f32 v5, v62, v63, v5
    s_add_u32 s64, s64, 2112
    s_cmp_lt_u32 s64, 397312
    s_cbranch_scc1 L_fb1
    v_mov_b32 v6, v4
    v_mov_b32 v7, v5
    s_nop 0
    v_permlane32_swap_b32 v4, v6
    v_permlane32_swap_b32 v5, v7
    v_max_f32 v4, v4, v6
    v_max_f32 v5, v5, v7
    v_sub_f32 v112, 0, v4
    v_sub_f32 v113, 0, v4
    v_sub_f32 v128, 0, v5
    v_sub_f32 v129, 0, v5
    v_mov_b64 v[114:115], v[112:113]
    v_mov_b64 v[116:117], v[112:113]
    v_mov_b64 v[118:119], v[112:113]
    v_mov_b64 v[120:121], v[112:113]
    v_mov_b64 v[122:123], v[112:113]
    v_mov_b64 v[124:125], v[112:113]
    v_mov_b64 v[126:127], v[112:113]
    v_mov_b64 v[130:131], v[128:129]
    v_mov_b64 v[132:133], v[128:129]
    v_mov_b64 v[134:135], v[128:129]
    v_mov_b64 v[136:137], v[128:129]
    v_mov_b64 v[138:139], v[128:129]
    v_mov_b64 v[140:141], v[128:129]
    v_mov_b64 v[142:143], v[128:129]
    v_mov_b32 v80, 0
    v_mov_b32 v81, 0
    v_mov_b32 v82, 0
    v_mov_b32 v83, 0
    v_mov_b32 v84, 0
    v_mov_b32 v85, 0
    v_mov_b32 v86, 0
    v_mov_b32 v87, 0
    v_mov_b32 v88, 0
    v_mov_b32 v89, 0
    v_mov_b32 v90, 0
    v_mov_b32 v91, 0
    v_mov_b32 v92, 0
    v_mov_b32 v93, 0
    v_mov_b32 v94, 0
    v_mov_b32 v95, 0
    v_mov_b32 v96, 0
    v_mov_b32 v97, 0
    v_mov_b32 v98, 0
    v_mov_b32 v99, 0
    v_mov_b32 v100, 0
    v_mov_b32 v101, 0
    v_mov_b32 v102, 0
    v_mov_b32 v103, 0
    v_mov_b32 v104, 0
    v_mov_b32 v105, 0
    v_mov_b32 v106, 0
    v_mov_b32 v107, 0
    v_mov_b32 v108, 0
    v_mov_b32 v109, 0
    v_mov_b32 v110, 0
    v_mov_b32 v111, 0
    s_mov_b32 s64, 262144
L_fb2:
    buffer_load_dwordx4 v[144:147], v3, s[8:11], s64 offen offset:1088 sc1
    buffer_load_dwordx4 v[152:155], v27, s[8:11], s64 offen sc1
    buffer_load_dwordx4 v[156:159], v27, s[8:11], s64 offen offset:544 sc1
    s_waitcnt vmcnt(0)
    v_mfma_f32_32x32x16_bf16 v[32:47], v[144:147], v[16:19], v[112:127]
    v_mfma_f32_32x32x16_bf16 v[48:63], v[144:147], v[20:23], v[128:143]
    s_nop 10
    v_exp_f32 v32, v32
    v_exp_f32 v33, v33
    v_exp_f32 v34, v34
    v_exp_f32 v35, v35
    v_exp_f32 v36, v36
    v_exp_f32 v37, v37
    v_exp_f32 v38, v38
    v_exp_f32 v39, v39
    v_exp_f32 v40, v40
    v_exp_f32 v41, v41
    v_exp_f32 v42, v42
    v_exp_f32 v43, v43
    v_exp_f32 v44, v44
    v_exp_f32 v45, v45
    v_exp_f32 v46, v46
    v_exp_f32 v47, v47
    v_exp_f32 v48, v48
    v_exp_f32 v49, v49
    v_exp_f32 v50, v50
    v_exp_f32 v51, v51
    v_exp_f32 v52, v52
    v_exp_f32 v53, v53
    v_exp_f32 v54, v54
    v_exp_f32 v55, v55
    v_exp_f32 v56, v56
    v_exp_f32 v57, v57
    v_exp_f32 v58, v58
    v_exp_f32 v59, v59
    v_exp_f32 v60, v60
    v_exp_f32 v61, v61
    v_exp_f32 v62, v62
    v_exp_f32 v63, v63
    v_smfmac_f32_32x32x32_bf16 v[80:95], v[152:155], v[32:39], v30
    v_smfmac_f32_32x32x32_bf16 v[80:95], v[156:159], v[40:47], v30
    v_smfmac_f32_32x32x32_bf16 v[96:111], v[152:155], v[48:55], v30
    v_smfmac_f32_32x32x32_bf16 v[96:111], v[156:159], v[56:63], v30
    s_add_u32 s64, s64, 2112
    s_cmp_lt_u32 s64, 397312
    s_cbranch_scc1 L_fb2
    s_nop 6
    v_mov_b32 v4, v88
    v_mov_b32 v5, v88
    v_mov_b32 v6, v104
    v_mov_b32 v7, v104
    v_permlane32_swap_b32 v4, v5
    s_nop 0
    v_permlane32_swap_b32 v6, v7
    s_branch Lok_26
L_end:
    s_endpgm
.section .rodata,"a"
.p2align 6
.amdhsa_kernel adaLN_cond__grouped_kv_mqa__mixer_gmlp__prompt_kernel
  .amdhsa_next_free_vgpr 512
  .amdhsa_next_free_sgpr 102
  .amdhsa_accum_offset 256
  .amdhsa_group_segment_fixed_size 0
  .amdhsa_kernarg_size 120
  .amdhsa_user_sgpr_count 2
  .amdhsa_user_sgpr_kernarg_segment_ptr 1
  .amdhsa_system_sgpr_workgroup_id_x 1
.end_amdhsa_kernel
```
